```python
import torch

def _softmax(x, axis=-1):
    return torch.softmax(x, dim=axis)
def _gelu(x):
    return torch.nn.functional.gelu(x, approximate="tanh")
def _silu(x):
    return torch.nn.functional.silu(x)
def _sigmoid(x):
    return torch.sigmoid(x)
def _layernorm(x, axis=-1, eps=1e-5):
    m = x.mean(dim=axis, keepdim=True)
    v = x.var(dim=axis, keepdim=True, unbiased=False)
    return (x - m) / torch.sqrt(v + eps)
def _scatter_add(tgt, idx, src, axis=0):
    return tgt.clone().index_add_(axis, idx, src)
def _segment_sum(src, seg, n):
    out = torch.zeros((n,) + src.shape[1:], dtype=src.dtype)
    return out.index_add_(0, seg, src)
def _pad(x, pw):
    flat = tuple(v for pair in reversed(pw) for v in pair)
    return torch.nn.functional.pad(x, flat)

kernel_name = 'sequential_preLN__grouped_kv_mqa__mixer_channel_mlp__prompt'

def setup_inputs():

    _w = (lambda a: (lambda t: t.to(torch.bfloat16) if t.is_floating_point() else t)(torch.as_tensor(a)))
    def _A_setup():
        B, S, D, H = 1, 2048, 640, 32
        Dh = D // H
        return {
            "x": _w((lambda *s: torch.randn(*s, dtype=torch.bfloat16) * 0.05)(B, S, D)),
            "wq": _w((lambda *s: torch.randn(*s, dtype=torch.bfloat16) * 0.05)(D, H * Dh)),
            "wk": _w((lambda *s: torch.randn(*s, dtype=torch.bfloat16) * 0.05)(D, Dh)),
            "wv": _w((lambda *s: torch.randn(*s, dtype=torch.bfloat16) * 0.05)(D, Dh)),
            "wo": _w((lambda *s: torch.randn(*s, dtype=torch.bfloat16) * 0.05)(H * Dh, D)),
        }
    _A_in = _A_setup()

    def _B_setup():
        B, S, D, F = 1, 2048, 640, 1728
        return {
            "x": _w((lambda *s: torch.randn(*s, dtype=torch.bfloat16) * 0.05)(B, S, D)),
            "w1": _w((lambda *s: torch.randn(*s, dtype=torch.bfloat16) * 3.2)(D, F) * (D ** -0.5)),
            "b1": _w((lambda *s: torch.randn(*s, dtype=torch.bfloat16) * 1.6)(F)),
            "w2": _w((lambda *s: torch.randn(*s, dtype=torch.bfloat16) * 0.2)(F, D) * (F ** -0.5)),
            "b2": _w((lambda *s: torch.randn(*s, dtype=torch.bfloat16) * 0.4)(D)),
        }
    _B_in = _B_setup()

    return {
        "A_x": _A_in["x"],
        "A_wq": _A_in["wq"],
        "A_wk": _A_in["wk"],
        "A_wv": _A_in["wv"],
        "A_wo": _A_in["wo"],
        "B_x": _B_in["x"],
        "B_w1": _B_in["w1"],
        "B_b1": _B_in["b1"],
        "B_w2": _B_in["w2"],
        "B_b2": _B_in["b2"],
    }

def reference(A_x, A_wq, A_wk, A_wv, A_wo, B_x, B_w1, B_b1, B_w2, B_b2):
    def _A_ref(x, wq, wk, wv, wo):
        B, S, D = x.shape
        H = 32
        Dh = D // H
        q = (lambda x, *d: x.permute(*d))((x @ wq).reshape(B, S, H, Dh), 0, 2, 1, 3)
        k = x @ wk
        v = x @ wv
        scores = torch.einsum("bhqd,bkd->bhqk", q, k) * (Dh ** -0.5)
        p = _softmax(scores, axis=-1)
        o = torch.einsum("bhqk,bkd->bhqd", p, v)
        return (lambda x, *d: x.permute(*d))(o, 0, 2, 1, 3).reshape(B, S, H * Dh) @ wo

    def _B_ref(x, w1, b1, w2, b2):
        y = _layernorm(x, axis=-1)
        h = _gelu(torch.einsum("bsd,df->bsf", y, w1) + b1)
        return torch.einsum("bsf,fd->bsd", h, w2) + b2

    x = A_x
    h = x + _A_ref(_layernorm(x, axis=-1), A_wq, A_wk, A_wv, A_wo)
    h2 = h + _B_ref(_layernorm(h, axis=-1), B_w1, B_b1, B_w2, B_b2)
    return h2
```

```asm
; @launch grid=(256,1,1) block=(256,1,1) lds=163840
.amdgcn_target "amdgcn-amd-amdhsa--gfx950"
.text
.globl sequential_preLN__grouped_kv_mqa__mixer_channel_mlp__prompt_kernel
.p2align 8
.type sequential_preLN__grouped_kv_mqa__mixer_channel_mlp__prompt_kernel,@function
sequential_preLN__grouped_kv_mqa__mixer_channel_mlp__prompt_kernel:
    s_load_dwordx4 s[4:7], s[0:1], 0
    s_load_dwordx2 s[80:81], s[0:1], 88
    s_cmp_ge_u32 s2, 256
    s_cbranch_scc1 K2_END
    s_getpc_b64 s[14:15]
PF_sequential_preLN__grouped_kv_mqa__mixer_channel_mlp__prompt_kernel:
    s_lshr_b32 s3, s2, 3
    s_lshl_b32 s3, s3, 11
    v_lshl_add_u32 v18, v0, 3, s3
    v_min_u32 v18, HOT_END-PF_sequential_preLN__grouped_kv_mqa__mixer_channel_mlp__prompt_kernel-4, v18
    global_load_dword v18, v18, s[14:15]
    s_and_b32 s34, s2, 7
    s_lshr_b32 s33, s2, 3
    s_lshl_b32 s34, s34, 5
    s_add_u32 s34, s34, s33
    s_mulk_i32 s34, 80
    s_mul_i32 s35, s33, 40
    v_min_u32 v2, 31, v0
    v_lshrrev_b32 v3, 2, v2
    v_mad_u32_u24 v2, v3, 6, v2
    v_add_lshl_u32 v2, v2, s34, 7
    v_xor_b32 v3, 0xff, v0
    v_min_u32_e64 v3, 39, v3
    v_add_lshl_u32 v3, v3, s35, 7
    s_waitcnt lgkmcnt(0)
    global_load_dword v18, v3, s[6:7]
    global_load_dword v18, v2, s[4:5]
    s_getreg_b32 s57, hwreg(HW_REG_XCC_ID, 0, 3)
    s_mul_i32 s57, s57, 5
    s_lshl_b64 s[14:15], 1, s57
    s_and_b32 s41, s33, 15
    s_cmp_eq_u32 s41, 15
    s_cselect_b32 s34, 0x101, 1
    s_cselect_b32 s35, -1, 0
    s_lshl_b32 s34, s34, 16
    s_or_b32 s15, s15, s34
    v_mov_b32 v22, s14
    v_mov_b32 v23, s15
    s_and_b32 s34, s2, 7
    s_lshl_b32 s34, s34, 5
    s_and_b32 s36, s33, 16
    s_add_u32 s34, s34, s36
    v_mov_b32 v21, s34
    s_load_dwordx4 s[44:47], s[0:1], 16
    s_load_dwordx2 s[12:13], s[0:1], 96
    s_load_dwordx2 s[48:49], s[0:1], 56
    s_load_dwordx4 s[8:11], s[0:1], 72
    s_load_dwordx2 s[68:69], s[0:1], 32
    s_load_dwordx2 s[70:71], s[0:1], 48
    s_load_dwordx2 s[72:73], s[0:1], 64
    v_lshrrev_b32 v2, 6, v0
    v_and_b32 v1, 63, v0
    v_readfirstlane_b32 s32, v2
    s_and_b32 s34, s2, 7
    s_lshr_b32 s33, s2, 3
    s_lshl_b32 s34, s34, 5
    s_add_u32 s3, s34, s33
    s_and_b32 s41, s33, 15
    s_lshr_b32 s58, s3, 4
    v_lshlrev_b32 v5, 4, v1
    v_lshrrev_b32 v2, 3, v1
    v_and_b32 v3, 7, v1
    v_xor_b32_e64 v4, v3, v2
    v_mul_u32_u24 v19, 1280, v2
    v_lshl_add_u32 v19, v4, 4, v19
    v_and_b32 v4, 6, v2
    v_xor_b32 v3, v3, v4
    v_lshrrev_b32 v4, 2, v2
    v_and_b32 v2, 3, v2
    v_lshl_add_u32 v2, v4, 3, v2
    v_mul_u32_u24 v20, 1280, v2
    v_lshl_add_u32 v20, v3, 4, v20
    v_mov_b32 v174, 0x1011
    s_lshl_b32 s56, s58, 9
    s_add_u32 s56, s56, 7290880
    s_lshl_b32 s59, s41, 2
    s_add_u32 s59, s59, s32
    s_add_u32 s59, s59, s56
    v_add_u32 v180, 0, v20
    v_add_u32 v176, 0, v19
    v_add_u32 v181, 19456, v20
    v_add_u32 v177, 9216, v19
    v_add_u32 v182, 3072, v20
    v_add_u32 v178, 18432, v19
    v_add_u32 v183, 22528, v20
    v_add_u32 v179, 27648, v19
    s_waitcnt lgkmcnt(0)
    s_mov_b32 s16, s4
    s_and_b32 s17, s5, 0xffff
    s_mov_b32 s18, 0x280000
    s_mov_b32 s19, 0x20000
    s_mov_b32 s28, s12
    s_and_b32 s29, s13, 0xffff
    s_mov_b32 s30, 0xf00000
    s_mov_b32 s31, 0x20000
    s_mov_b32 s20, s48
    s_and_b32 s21, s49, 0xffff
    s_mov_b32 s22, 0xd80
    s_mov_b32 s23, 0x20000
    s_cmp_ge_u32 s41, 10
    s_cbranch_scc1 P1_NQ
    s_mov_b32 s76, s6
    s_and_b32 s77, s7, 0xffff
    s_mov_b32 s78, 0xc8000
    s_mov_b32 s79, 0x20000
    s_lshl_b32 s54, s58, 2
    s_add_u32 s54, s54, s32
    s_mul_i32 s54, s54, 40960
    s_mul_i32 s55, s32, 40960
    s_lshl_b32 s34, s41, 7
    s_add_u32 s55, s55, s34
    s_lshl_b32 s60, s32, 13
    s_lshl_b32 s61, s32, 12
    s_add_u32 s61, s61, 65536
    s_add_u32 m0, s61, 0
    s_add_u32 s62, s55, 0
    buffer_load_dwordx4 v180, s[76:79], s62 offen offset:0 lds
    buffer_load_dwordx4 v181, s[76:79], s62 offen offset:1024 lds
    buffer_load_dwordx4 v182, s[76:79], s62 offen offset:2048 lds
    buffer_load_dwordx4 v183, s[76:79], s62 offen offset:3072 lds
    s_add_u32 m0, s60, 0
    s_add_u32 s62, s54, 0
    buffer_load_dwordx4 v176, s[16:19], s62 offen offset:0 lds
    buffer_load_dwordx4 v177, s[16:19], s62 offen offset:1024 lds
    buffer_load_dwordx4 v178, s[16:19], s62 offen offset:2048 lds
    buffer_load_dwordx4 v179, s[16:19], s62 offen offset:3072 lds
    s_cmp_lg_u32 s32, 0
    s_cbranch_scc1 CI_1
    s_mov_b64 exec, 1
    global_atomic_add_x2 v21, v[22:23], s[80:81] sc1
    s_mov_b64 exec, -1
CI_1:
    s_branch P1_Q
P1_NQ:
    s_cmp_ge_u32 s41, 12
    s_cbranch_scc1 P1_PF
    s_cmp_lt_u32 s32, 2
    s_cselect_b32 s6, s44, s46
    s_cselect_b32 s7, s45, s47
    s_mov_b32 s76, s6
    s_and_b32 s77, s7, 0xffff
    s_mov_b32 s78, 0x6400
    s_mov_b32 s79, 0x20000
    s_lshl_b32 s54, s58, 1
    s_add_u32 s54, s54, s41
    s_sub_u32 s54, s54, 10
    s_lshl_b32 s54, s54, 2
    s_add_u32 s54, s54, s32
    s_mul_i32 s54, s54, 20480
    s_and_b32 s55, s32, 1
    s_lshl_b32 s55, s55, 10
    s_lshr_b32 s61, s32, 1
    s_mul_i32 s61, s61, 26624
    s_add_u32 s61, s61, s55
    s_add_u32 s61, s61, 81920
    s_mul_i32 s60, s32, 20480
    v_mov_b32 v24, 0
    s_cmp_lg_u32 s32, 0
    s_cbranch_scc1 CI_2
    s_mov_b64 exec, 1
    global_atomic_add_x2 v21, v[22:23], s[80:81] sc1
    s_mov_b64 exec, -1
CI_2:
    s_add_u32 m0, s61, 0
    s_add_u32 s62, s55, 0
    buffer_load_dwordx4 v5, s[76:79], s62 offen lds
    s_add_u32 m0, s61, 2048
    s_add_u32 s62, s55, 2048
    buffer_load_dwordx4 v5, s[76:79], s62 offen lds
    s_add_u32 m0, s61, 4096
    s_add_u32 s62, s55, 4096
    buffer_load_dwordx4 v5, s[76:79], s62 offen lds
    s_add_u32 m0, s60, 0
    s_add_u32 s62, s54, 0
    buffer_load_dwordx4 v19, s[16:19], s62 offen lds
    s_add_u32 m0, s60, 1024
    s_add_u32 s62, s54, 10240
    buffer_load_dwordx4 v19, s[16:19], s62 offen lds
    s_add_u32 m0, s60, 2048
    s_add_u32 s62, s54, 128
    buffer_load_dwordx4 v19, s[16:19], s62 offen lds
    s_add_u32 m0, s60, 3072
    s_add_u32 s62, s54, 10368
    buffer_load_dwordx4 v19, s[16:19], s62 offen lds
    s_branch P1_KV
P1_PF:
    s_and_b32 s35, s58, 1
    s_sub_u32 s60, s41, 12
    s_lshl_b32 s60, s60, 2
    s_add_u32 s60, s60, s32
    s_lshl_b32 s62, s35, 4
    s_add_u32 s62, s62, s60
    s_lshl_b32 s54, s58, 4
    s_add_u32 s54, s54, s60
    s_mul_i32 s54, s54, 10240
    s_mul_i32 s34, s35, 0
    s_add_u32 s34, s34, s54
    v_lshrrev_b32 v25, 1, v1
    v_mul_u32_u24 v25, 1280, v25
    v_and_b32_e64 v26, 1, v1
    v_lshl_add_u32 v25, v26, 7, v25
    v_lshlrev_b32 v24, 7, v1
    v_mov_b32 v26, 0
    v_mov_b32_e64 v27, 0
    v_lshlrev_b32 v28, 3, v1
    s_lshl_b32 s36, s58, 8
    s_add_u32 s36, s36, 7299072
    s_cmp_eq_u32 s60, 12
    s_cselect_b32 s36, s36, 25165824
    s_cselect_b32 s55, s56, 25165824
    buffer_store_dwordx2 v[26:27], v28, s[28:31], s55 offen sc1
    s_mov_b32 exec_hi, 0
    buffer_store_dwordx2 v[26:27], v28, s[28:31], s36 offen sc1
    s_mov_b64 exec, 0xffff
    s_cmp_eq_u32 s35, 0
    s_cselect_b32 s44, s44, s46
    s_cselect_b32 s45, s45, s47
    s_mov_b32 s76, s44
    s_and_b32 s77, s45, 0xffff
    s_mov_b32 s78, 0x6400
    s_mov_b32 s79, 0x20000
    s_mul_i32 s36, s60, 1664
    buffer_load_dword v18, v24, s[76:79], s36 offen
    s_mul_i32 s55, s35, 0
    s_sub_u32 s34, s34, s55
    buffer_load_dword v18, v25, s[16:19], s34 offen offset:512
    buffer_load_dword v18, v25, s[16:19], s34 offen offset:768
    buffer_load_dword v18, v25, s[16:19], s34 offen offset:1024
    s_mov_b32 s76, s6
    s_and_b32 s77, s7, 0xffff
    s_mov_b32 s78, 0xc8000
    s_mov_b32 s79, 0x20000
    s_mul_i32 s36, s35, 491520
    s_mul_i32 s55, s60, 10240
    s_add_u32 s36, s36, s55
    s_add_u32 s36, s36, 163840
    s_add_u32 s55, s36, 8192
    s_mov_b64 exec, -1
    s_mul_i32 s55, s62, 5120
    s_mov_b32 exec_lo, -1
    s_mov_b32 exec_hi, 0xff
    s_add_u32 s34, s55, 163840
    buffer_load_dword v18, v24, s[76:79], s34 offen
    s_waitcnt vmcnt(5)
    s_mov_b64 exec, -1
    s_cmp_lg_u32 s32, 0
    s_cbranch_scc1 CI_3
    s_mov_b64 exec, 1
    global_atomic_add_x2 v21, v[22:23], s[80:81] sc1
    s_mov_b64 exec, -1
CI_3:
    s_mov_b32 exec_hi, 0xff
    s_add_u32 s34, s55, 327680
    buffer_load_dword v18, v24, s[76:79], s34 offen
    s_add_u32 s34, s55, 491520
    buffer_load_dword v18, v24, s[76:79], s34 offen
    s_add_u32 s34, s55, 655360
    buffer_load_dword v18, v24, s[76:79], s34 offen
    s_mov_b64 exec, -1
    v_and_b32 v2, 31, v1
    v_lshrrev_b32 v3, 5, v1
    v_cmp_lt_u32 vcc, 31, v1
    v_mov_b32 v4, 832
    v_mad_u32_u24 v7, v3, 21, v2
    v_cndmask_b32_e64 v6, v5, v4, vcc
    v_mul_u32_u24 v8, 320, v2
    v_add_u32 v9, 151808, v8
    v_lshlrev_b32_e64 v4, 6, v2
    v_add_u32 v4, 161792, v4
    v_cndmask_b32_e64 v9, v9, v4, vcc
    v_lshl_add_u32 v8, v3, 7, v8
    v_add_u32 v8, 151552, v8
    v_lshlrev_b32_e64 v7, 4, v7
    v_add_u32 v7, 2560, v7
    v_cmp_lt_u32_e64 vcc, 20, v2
    v_mov_b32 v4, 0x7f000000
    v_lshrrev_b32 v2, 3, v1
    v_cndmask_b32 v7, v7, v4, vcc
    v_and_b32 v4, 7, v1
    v_lshlrev_b32 v10, 8, v2
    v_lshl_add_u32 v10, v4, 4, v10
    s_mul_i32 s34, s32, 2560
    s_add_u32 s34, s34, 151552
    v_mul_u32_u24 v249, 320, v2
    v_lshl_add_u32 v249, v4, 3, v249
    v_add_u32 v249, s34, v249
    v_lshlrev_b32 v250, 3, v0
    v_add_u32 v250, 161792, v250
    v_lshrrev_b32 v2, 2, v1
    v_and_b32 v4, 3, v1
    v_lshlrev_b32_e64 v251, 7, v2
    v_lshl_add_u32 v251, v4, 4, v251
    v_lshlrev_b32 v13, 8, v1
    v_lshrrev_b32 v14, 1, v1
    v_lshlrev_b32_e64 v14, 8, v14
    v_lshl_add_u32 v14, v3, 30, v14
    v_and_b32_e64 v2, 1, v1
    v_lshl_add_u32 v14, v2, 3, v14
    v_add_u32 v14, 16384, v14
    s_lshr_b32 s34, s3, 1
    s_and_b32 s36, s3, 1
    s_lshl_b32 s36, s36, 7
    s_mul_i32 s42, s34, 55296
    s_add_u32 s42, s42, s36
    s_lshl_b32 s40, s32, 1
    s_add_u32 s34, s40, 6
    s_and_b32 s34, s34, 7
    s_lshl_b32 s35, s34, 12
    s_lshl_b32 s34, s34, 3
    s_add_u32 s35, s35, 118528
    v_add_u32 v131, s34, v8
    v_add_u32 v255, s34, v9
    v_add_u32 v248, s35, v5
    s_lshl_b32 s34, s34, 1
    v_add_u32 v13, s34, v13
    v_add_u32_e64 v14, s34, v14
    s_add_u32 s34, s40, 4
    s_and_b32 s34, s34, 7
    s_lshl_b32 s35, s34, 12
    s_lshl_b32 s34, s34, 3
    s_add_u32 s35, s35, 118528
    v_add_u32 v130, s34, v8
    v_add_u32 v254, s34, v9
    v_add_u32_e64 v247, s35, v5
    s_add_u32 s34, s40, 2
    s_and_b32 s34, s34, 7
    s_lshl_b32 s35, s34, 12
    s_lshl_b32 s34, s34, 3
    s_add_u32 s35, s35, 118528
    v_add_u32 v11, s34, v8
    v_add_u32 v12, s34, v9
    v_add_u32_e64 v246, s35, v5
    s_add_u32 s34, s40, 0
    s_and_b32 s34, s34, 7
    s_lshl_b32 s35, s34, 12
    s_lshl_b32 s34, s34, 3
    s_add_u32 s35, s35, 118528
    v_add_u32 v8, s34, v8
    v_add_u32 v9, s34, v9
    v_add_u32_e64 v15, s35, v5
P1_SETUP:
    s_mov_b32 s66, 819200
    s_mov_b32 s43, 1280
    s_mov_b32 s48, 858993460
    s_mov_b32 s49, 10223616
    s_cmp_ge_u32 s2, 40
    s_cselect_b64 s[64:65], s[70:71], s[68:69]
    s_cselect_b32 s66, 2211840, s66
    s_cselect_b32 s43, 3456, s43
    s_cselect_b32 s44, 7, 5
    s_cselect_b32 s48, 613566757, s48
    s_cselect_b32 s49, 11075584, s49
    s_cselect_b32 s50, 40, 0
    s_cmp_ge_u32 s2, 148
    s_cselect_b64 s[64:65], s[72:73], s[64:65]
    s_cselect_b32 s43, 1280, s43
    s_cselect_b32 s44, 5, s44
    s_cselect_b32 s48, 858993460, s48
    s_cselect_b32 s49, 13369344, s49
    s_cselect_b32 s50, 148, s50
    s_cselect_b32 s45, 54, 20
    s_cselect_b32 s46, 0, 1
    s_cselect_b32 s47, 1, 0
    s_and_b32 s65, s65, 0xffff
    s_mov_b32 s67, 0x20000
    s_sub_u32 s50, s2, s50
    s_lshr_b32 s52, s50, 2
    s_and_b32 s51, s50, 3
    s_mul_i32 s51, s51, 5
    s_lshr_b32 s34, s50, 1
    s_and_b32 s35, s50, 1
    s_mul_i32 s35, s35, 5
    s_cmp_ge_u32 s2, 148
    s_cselect_b32 s51, s34, s51
    s_cselect_b32 s52, s35, s52
    s_lshr_b32 s53, s32, 1
    s_mul_i32 s34, s53, s46
    s_add_u32 s51, s51, s34
    s_mul_i32 s34, s53, s47
    s_add_u32 s52, s52, s34
    s_lshl_b32 s46, s46, 1
    s_lshl_b32 s47, s47, 1
    v_lshrrev_b32 v2, 5, v1
    v_bfe_u32 v3, v1, 4, 1
    v_bfe_u32 v4, v1, 2, 2
    v_and_b32_e64 v172, 3, v1
    v_lshlrev_b32 v172, 4, v172
    s_and_b32 s34, s51, 7
    s_mul_i32 s34, s34, 80
    s_lshr_b32 s35, s51, 3
    s_lshl_b32 s35, s35, 2
    s_add_u32 s34, s34, s35
    s_mul_i32 s35, s51, 160
    s_sub_u32 s35, s35, 2544
    s_cmp_lt_u32 s51, 16
    s_cselect_b32 s34, s34, s35
    s_cselect_b32 s4, 20, 40
    s_cselect_b32 s7, 8, 20
    s_lshl_b32 s35, s51, 5
    s_cmp_lt_u32 s2, 40
    s_cselect_b32 s34, s34, s35
    s_cselect_b32 s4, s4, 8
    s_cselect_b32 s7, s7, 4
    v_mad_u32_u24 v132, v2, s4, v4
    v_mad_u32_u24 v132, v3, s7, v132
    v_mad_u32_u24 v132, v132, s43, v172
    s_mul_i32 s7, s4, s43
    s_lshl_b32 s7, s7, 1
    s_mul_i32 s34, s34, s43
    s_lshl_b32 s35, s52, 7
    s_add_u32 s34, s34, s35
    s_and_b32 s35, s32, 1
    s_lshl_b32 s35, s35, 6
    s_add_u32 s4, s34, s35
    s_add_u32 s7, s7, s4
    s_and_b32 s34, s32, 1
    s_lshl_b32 s34, s34, 1
    s_lshl_b32 s35, s52, 2
    s_add_u32 s34, s34, s35
    s_add_u32 s34, s34, 0
    s_mul_hi_u32 s35, s34, s48
    s_mul_i32 s68, s35, s44
    s_sub_u32 s34, s34, s68
    s_cmp_eq_u32 s34, 0
    s_cselect_b32 s68, s44, s34
    s_sub_u32 s68, s68, 1
    s_bitcmp1_b32 s35, 0
    s_cselect_b32 s34, s68, s34
    s_mul_i32 s68, s35, 7
    s_add_u32 s68, s68, s34
    s_lshl_b32 s68, s68, 9
    s_and_b32 s74, s50, 3
    s_lshl_b32 s74, s74, 1
    s_add_u32 s74, s74, s53
    s_lshl_b32 s74, s74, 2
    s_add_u32 s74, s74, s68
    s_add_u32 s74, s74, 7471104
    s_cmp_eq_u32 s44, 7
    s_cselect_b32 s74, s74, 25165824
    s_mul_i32 s35, s35, s45
    s_add_u32 s35, s35, s51
    s_mul_i32 s35, s35, s44
    s_add_u32 s35, s35, s34
    s_lshl_b32 s35, s35, 10
    s_add_u32 s68, s35, s49
    s_and_b32 s34, s32, 1
    s_lshl_b32 s34, s34, 1
    s_lshl_b32 s35, s52, 2
    s_add_u32 s34, s34, s35
    s_add_u32 s34, s34, 1
    s_mul_hi_u32 s35, s34, s48
    s_mul_i32 s69, s35, s44
    s_sub_u32 s34, s34, s69
    s_cmp_eq_u32 s34, 0
    s_cselect_b32 s69, s44, s34
    s_sub_u32 s69, s69, 1
    s_bitcmp1_b32 s35, 0
    s_cselect_b32 s34, s69, s34
    s_mul_i32 s69, s35, 7
    s_add_u32 s69, s69, s34
    s_lshl_b32 s69, s69, 9
    s_and_b32 s75, s50, 3
    s_lshl_b32 s75, s75, 1
    s_add_u32 s75, s75, s53
    s_lshl_b32 s75, s75, 2
    s_add_u32 s75, s75, s69
    s_add_u32 s75, s75, 7471104
    s_cmp_eq_u32 s44, 7
    s_cselect_b32 s75, s75, 25165824
    s_mul_i32 s35, s35, s45
    s_add_u32 s35, s35, s51
    s_mul_i32 s35, s35, s44
    s_add_u32 s35, s35, s34
    s_lshl_b32 s35, s35, 10
    s_add_u32 s69, s35, s49
    s_add_u32 s51, s51, s46
    s_add_u32 s52, s52, s47
    s_and_b32 s34, s51, 7
    s_mul_i32 s34, s34, 80
    s_lshr_b32 s35, s51, 3
    s_lshl_b32 s35, s35, 2
    s_add_u32 s34, s34, s35
    s_mul_i32 s35, s51, 160
    s_sub_u32 s35, s35, 2544
    s_cmp_lt_u32 s51, 16
    s_cselect_b32 s34, s34, s35
    s_cselect_b32 s5, 20, 40
    s_cselect_b32 s14, 8, 20
    s_lshl_b32 s35, s51, 5
    s_cmp_lt_u32 s2, 40
    s_cselect_b32 s34, s34, s35
    s_cselect_b32 s5, s5, 8
    s_cselect_b32 s14, s14, 4
    v_mad_u32_u24 v133, v2, s5, v4
    v_mad_u32_u24 v133, v3, s14, v133
    v_mad_u32_u24 v133, v133, s43, v172
    s_mul_i32 s14, s5, s43
    s_lshl_b32 s14, s14, 1
    s_mul_i32 s34, s34, s43
    s_lshl_b32 s35, s52, 7
    s_add_u32 s34, s34, s35
    s_and_b32 s35, s32, 1
    s_lshl_b32 s35, s35, 6
    s_add_u32 s5, s34, s35
    s_add_u32 s14, s14, s5
    s_and_b32 s34, s32, 1
    s_lshl_b32 s34, s34, 1
    s_lshl_b32 s35, s52, 2
    s_add_u32 s34, s34, s35
    s_add_u32 s34, s34, 0
    s_mul_hi_u32 s35, s34, s48
    s_mul_i32 s70, s35, s44
    s_sub_u32 s34, s34, s70
    s_cmp_eq_u32 s34, 0
    s_cselect_b32 s70, s44, s34
    s_sub_u32 s70, s70, 1
    s_bitcmp1_b32 s35, 0
    s_cselect_b32 s34, s70, s34
    s_mul_i32 s35, s35, s45
    s_add_u32 s35, s35, s51
    s_mul_i32 s35, s35, s44
    s_add_u32 s35, s35, s34
    s_lshl_b32 s35, s35, 10
    s_add_u32 s70, s35, s49
    s_and_b32 s34, s32, 1
    s_lshl_b32 s34, s34, 1
    s_lshl_b32 s35, s52, 2
    s_add_u32 s34, s34, s35
    s_add_u32 s34, s34, 1
    s_mul_hi_u32 s35, s34, s48
    s_mul_i32 s71, s35, s44
    s_sub_u32 s34, s34, s71
    s_cmp_eq_u32 s34, 0
    s_cselect_b32 s71, s44, s34
    s_sub_u32 s71, s71, 1
    s_bitcmp1_b32 s35, 0
    s_cselect_b32 s34, s71, s34
    s_mul_i32 s35, s35, s45
    s_add_u32 s35, s35, s51
    s_mul_i32 s35, s35, s44
    s_add_u32 s35, s35, s34
    s_lshl_b32 s35, s35, 10
    s_add_u32 s71, s35, s49
    s_add_u32 s51, s51, s46
    s_add_u32 s52, s52, s47
    s_and_b32 s34, s51, 7
    s_mul_i32 s34, s34, 80
    s_lshr_b32 s35, s51, 3
    s_lshl_b32 s35, s35, 2
    s_add_u32 s34, s34, s35
    s_mul_i32 s35, s51, 160
    s_sub_u32 s35, s35, 2544
    s_cmp_lt_u32 s51, 16
    s_cselect_b32 s34, s34, s35
    s_cselect_b32 s6, 20, 40
    s_cselect_b32 s15, 8, 20
    s_lshl_b32 s35, s51, 5
    s_cmp_lt_u32 s2, 40
    s_cselect_b32 s34, s34, s35
    s_cselect_b32 s6, s6, 8
    s_cselect_b32 s15, s15, 4
    v_mad_u32_u24 v134, v2, s6, v4
    v_mad_u32_u24 v134, v3, s15, v134
    v_mad_u32_u24 v134, v134, s43, v172
    s_mul_i32 s15, s6, s43
    s_lshl_b32 s15, s15, 1
    s_mul_i32 s34, s34, s43
    s_lshl_b32 s35, s52, 7
    s_add_u32 s34, s34, s35
    s_and_b32 s35, s32, 1
    s_lshl_b32 s35, s35, 6
    s_add_u32 s6, s34, s35
    s_add_u32 s15, s15, s6
    s_and_b32 s34, s32, 1
    s_lshl_b32 s34, s34, 1
    s_lshl_b32 s35, s52, 2
    s_add_u32 s34, s34, s35
    s_add_u32 s34, s34, 0
    s_mul_hi_u32 s35, s34, s48
    s_mul_i32 s72, s35, s44
    s_sub_u32 s34, s34, s72
    s_cmp_eq_u32 s34, 0
    s_cselect_b32 s72, s44, s34
    s_sub_u32 s72, s72, 1
    s_bitcmp1_b32 s35, 0
    s_cselect_b32 s34, s72, s34
    s_mul_i32 s35, s35, s45
    s_add_u32 s35, s35, s51
    s_mul_i32 s35, s35, s44
    s_add_u32 s35, s35, s34
    s_lshl_b32 s35, s35, 10
    s_add_u32 s72, s35, s49
    s_lshr_b32 s34, s2, 1
    s_mul_i32 s34, s34, 7
    s_and_b32 s35, s2, 1
    s_lshl_b32 s35, s35, 1
    s_add_u32 s34, s34, s35
    s_lshl_b32 s34, s34, 10
    s_add_u32 s34, s34, 13228032
    s_cmp_lt_u32 s2, 40
    s_cselect_b32 s34, s34, 25165824
    s_cmp_eq_u32 s32, 2
    s_cselect_b32 s34, s34, 25165824
    s_cmp_eq_u32 s53, 0
    s_cselect_b32 s72, s72, s34
    s_and_b32 s34, s32, 1
    s_lshl_b32 s34, s34, 1
    s_lshl_b32 s35, s52, 2
    s_add_u32 s34, s34, s35
    s_add_u32 s34, s34, 1
    s_mul_hi_u32 s35, s34, s48
    s_mul_i32 s73, s35, s44
    s_sub_u32 s34, s34, s73
    s_cmp_eq_u32 s34, 0
    s_cselect_b32 s73, s44, s34
    s_sub_u32 s73, s73, 1
    s_bitcmp1_b32 s35, 0
    s_cselect_b32 s34, s73, s34
    s_mul_i32 s35, s35, s45
    s_add_u32 s35, s35, s51
    s_mul_i32 s35, s35, s44
    s_add_u32 s35, s35, s34
    s_lshl_b32 s35, s35, 10
    s_add_u32 s73, s35, s49
    s_lshr_b32 s34, s2, 1
    s_mul_i32 s34, s34, 7
    s_and_b32 s35, s2, 1
    s_lshl_b32 s35, s35, 1
    s_add_u32 s34, s34, s35
    s_lshl_b32 s34, s34, 10
    s_add_u32 s34, s34, 13229056
    s_cmp_lt_u32 s2, 40
    s_cselect_b32 s34, s34, 25165824
    s_cmp_eq_u32 s32, 2
    s_cselect_b32 s34, s34, 25165824
    s_cmp_eq_u32 s53, 0
    s_cselect_b32 s73, s73, s34
    s_cmp_eq_u32 s53, 0
    s_cselect_b32 s34, 0, 0x7f000000
    s_cselect_b32 s6, s6, 0
    s_cselect_b32 s15, s15, 0
    v_or_b32 v134, s34, v134
    v_lshrrev_b32 v2, 4, v1
    v_lshl_add_u32 v2, v2, 3, v4
    v_lshl_add_u32 v135, v2, 6, v172
    s_lshl_b32 s63, s32, 12
    s_add_u32 s63, s63, 65536
    v_add_u32 v135, s63, v135
    v_lshrrev_b32 v2, 4, v1
    v_lshlrev_b32 v2, 24, v2
    v_lshl_add_u32 v172, v1, 5, v2
    v_mov_b32 v168, 0x3f803f80
    v_mov_b32 v169, 0x3f803f80
    v_mov_b32 v170, 0x3f803f80
    v_mov_b32 v171, 0x3f803f80
    s_cmp_lt_u32 s41, 12
    s_nop 0
    s_cbranch_scc1 P1_JOIN
    s_waitcnt vmcnt(1)
    v_lshlrev_b32 v24, 7, v1
    s_lshl_b32 s54, s58, 3
    s_lshr_b32 s34, s60, 1
    s_add_u32 s54, s54, s34
    s_mul_i32 s54, s54, 55296
    s_and_b32 s34, s60, 1
    s_mul_i32 s34, s34, 10240
    s_add_u32 s54, s54, s34
    buffer_load_dword v18, v24, s[28:31], s54 offen sc1
    s_mov_b64 exec, 0xffff
    s_add_u32 s34, s54, 8192
    buffer_load_dword v18, v24, s[28:31], s34 offen sc1
    s_mov_b64 exec, -1
    s_waitcnt vmcnt(0)
    v_lshlrev_b32_e64 v21, 4, v1
    v_and_b32 v21, 0xf0, v21
    global_load_dwordx2 v[22:23], v21, s[80:81] sc1
    v_and_b32 v175, 15, v1
    v_xor_b32 v175, s58, v175
    v_min_u32 v175, 2, v175
    v_lshlrev_b32 v175, 3, v175
    v_lshrrev_b32 v175, v175, v174
    v_and_b32 v175, 0x11, v175
    v_lshlrev_b32 v175, 20, v175
    s_waitcnt vmcnt(0)
    v_and_b32_e64 v173, v23, v175
    v_cmp_ne_u32 vcc, v173, v175
    s_cbranch_vccnz BT_4w
BT_4r:
    v_readlane_b32 s34, v22, s58
    v_readlane_b32 s35, v23, s58
    s_nop 3
    s_lshr_b64 s[34:35], s[34:35], s57
    s_and_b32 s34, s34, 31
    s_cmp_eq_u32 s34, 16
    s_cselect_b32 s57, 1, 2
    s_branch P1_JOIN
P1_KV:
    v_and_b32 v2, 31, v1
    v_lshrrev_b32 v3, 5, v1
    v_cmp_lt_u32_e64 vcc, 31, v1
    v_mov_b32 v4, 832
    v_mad_u32_u24 v7, v3, 21, v2
    v_cndmask_b32_e64 v6, v5, v4, vcc
    v_mul_u32_u24 v8, 320, v2
    v_add_u32 v9, 151808, v8
    v_lshlrev_b32_e64 v4, 6, v2
    v_add_u32 v4, 161792, v4
    v_cndmask_b32_e64 v9, v9, v4, vcc
    v_lshl_add_u32 v8, v3, 7, v8
    v_add_u32 v8, 151552, v8
    v_lshlrev_b32_e64 v7, 4, v7
    v_add_u32 v7, 2560, v7
    v_cmp_lt_u32_e64 vcc, 20, v2
    v_mov_b32 v4, 0x7f000000
    v_lshrrev_b32 v2, 3, v1
    v_cndmask_b32 v7, v7, v4, vcc
    v_and_b32 v4, 7, v1
    v_lshlrev_b32 v10, 8, v2
    v_lshl_add_u32 v10, v4, 4, v10
    s_mul_i32 s34, s32, 2560
    s_add_u32 s34, s34, 151552
    v_mul_u32_u24 v249, 320, v2
    v_lshl_add_u32 v249, v4, 3, v249
    v_add_u32 v249, s34, v249
    v_lshlrev_b32 v250, 3, v0
    v_add_u32 v250, 161792, v250
    v_lshrrev_b32 v2, 2, v1
    v_and_b32 v4, 3, v1
    v_lshlrev_b32_e64 v251, 7, v2
    v_lshl_add_u32 v251, v4, 4, v251
    v_lshlrev_b32 v13, 8, v1
    v_lshrrev_b32 v14, 1, v1
    v_lshlrev_b32_e64 v14, 8, v14
    v_lshl_add_u32 v14, v3, 30, v14
    v_and_b32_e64 v2, 1, v1
    v_lshl_add_u32 v14, v2, 3, v14
    v_add_u32 v14, 16384, v14
    s_lshr_b32 s34, s3, 1
    s_and_b32 s36, s3, 1
    s_lshl_b32 s36, s36, 7
    s_mul_i32 s42, s34, 55296
    s_add_u32 s42, s42, s36
    s_lshl_b32 s40, s32, 1
    s_add_u32 s34, s40, 6
    s_and_b32 s34, s34, 7
    s_lshl_b32 s35, s34, 12
    s_lshl_b32 s34, s34, 3
    s_add_u32 s35, s35, 118528
    v_add_u32 v131, s34, v8
    v_add_u32 v255, s34, v9
    v_add_u32 v248, s35, v5
    s_lshl_b32 s34, s34, 1
    v_add_u32 v13, s34, v13
    v_add_u32_e64 v14, s34, v14
    s_add_u32 s34, s40, 4
    s_and_b32 s34, s34, 7
    s_lshl_b32 s35, s34, 12
    s_lshl_b32 s34, s34, 3
    s_add_u32 s35, s35, 118528
    v_add_u32 v130, s34, v8
    v_add_u32 v254, s34, v9
    v_add_u32_e64 v247, s35, v5
    s_add_u32 s34, s40, 2
    s_and_b32 s34, s34, 7
    s_lshl_b32 s35, s34, 12
    s_lshl_b32 s34, s34, 3
    s_add_u32 s35, s35, 118528
    v_add_u32 v11, s34, v8
    v_add_u32 v12, s34, v9
    v_add_u32_e64 v246, s35, v5
    s_add_u32 s34, s40, 0
    s_and_b32 s34, s34, 7
    s_lshl_b32 s35, s34, 12
    s_lshl_b32 s34, s34, 3
    s_add_u32 s35, s35, 118528
    v_add_u32 v8, s34, v8
    v_add_u32 v9, s34, v9
    v_add_u32 v15, s35, v5
    v_and_b32 v2, 7, v1
    v_lshrrev_b32 v4, 4, v1
    v_xor_b32 v3, v4, v2
    v_lshlrev_b32_e64 v3, 4, v3
    v_lshl_add_u32 v3, v2, 7, v3
    v_bfe_u32 v2, v1, 3, 1
    v_lshl_add_u32 v3, v2, 10, v3
    v_add_u32 v24, s60, v3
    v_xor_b32 v25, 64, v24
    v_mov_b32 v168, 0x3f803f80
    v_mov_b32 v169, 0x3f803f80
    v_mov_b32 v170, 0x3f803f80
    v_mov_b32 v171, 0x3f803f80
    v_bfe_u32 v2, v1, 2, 2
    v_lshl_add_u32 v2, v4, 3, v2
    v_mul_u32_u24 v2, 40, v2
    v_and_b32 v3, 3, v1
    v_lshl_add_u32 v26, v3, 3, v2
    v_add_u32 v26, 81920, v26
    v_and_b32_e64 v3, 1, v1
    v_mul_u32_u24 v3, 26624, v3
    v_add3_u32 v27, v2, v3, 32
    v_add_u32 v27, 81920, v27
    v_and_b32 v3, 15, v1
    s_lshr_b32 s34, s32, 1
    s_and_b32 s35, s32, 1
    s_lshl_b32 s35, s35, 8
    s_add_u32 s35, s35, 135168
    s_lshl_b32 s36, s34, 10
    s_add_u32 s36, s36, s35
    s_lshl_b32 s34, s34, 3
    s_add_u32 s34, s34, s35
    v_lshlrev_b32 v121, 4, v3
    v_lshrrev_b32 v120, 1, v4
    v_lshl_add_u32 v120, v120, 9, v121
    v_and_b32_e64 v2, 1, v4
    v_lshl_add_u32 v120, v2, 3, v120
    v_add_u32 v120, s36, v120
    v_add_u32 v121, s34, v121
    s_mul_i32 s34, s32, 672
    s_add_u32 s34, s34, 137728
    v_bfe_u32 v122, v3, 2, 1
    v_mul_u32_u24 v122, 336, v122
    v_and_b32 v123, 3, v3
    v_lshrrev_b32 v2, 3, v3
    v_lshl_add_u32 v123, v2, 2, v123
    v_lshl_add_u32 v122, v123, 1, v122
    v_add_u32_e64 v122, s34, v122
    v_lshl_add_u32 v123, v4, 6, v122
    ds_write_b16 v122, v168 offset:320
    v_lshlrev_b32_e64 v124, 4, v0
    v_add_u32 v125, 135168, v124
    v_cmp_gt_u32 vcc, 72, v0
    v_mov_b32 v2, 0x7f000000
    v_add_u32 v126, 4096, v124
    v_cndmask_b32 v126, v2, v126, vcc
    v_cmp_gt_u32 vcc, 16, v1
    v_lshlrev_b32_e64 v31, 3, v1
    v_mov_b32 v127, 0x3acccccd
    v_cndmask_b32 v31, v2, v31, vcc
    s_lshl_b32 s34, s32, 2
    s_add_u32 s34, s34, 141312
    v_mov_b32 v128, s34
    s_lshl_b32 s49, s58, 1
    s_add_u32 s49, s49, s41
    s_sub_u32 s49, s49, 10
    v_lshlrev_b32 v129, 2, v4
    v_sub_u32 v129, v3, v129
    v_cmp_eq_u32 s[50:51], 0, v129
    v_cmp_eq_u32 s[52:53], 1, v129
    s_waitcnt lgkmcnt(0)
    s_add_u32 m0, s61, 6144
    s_add_u32 s62, s55, 6144
    buffer_load_dwordx4 v5, s[76:79], s62 offen lds
    s_add_u32 m0, s61, 8192
    s_add_u32 s62, s55, 8192
    buffer_load_dwordx4 v5, s[76:79], s62 offen lds
    s_add_u32 m0, s60, 4096
    s_add_u32 s62, s54, 256
    buffer_load_dwordx4 v19, s[16:19], s62 offen lds
    s_add_u32 m0, s60, 5120
    s_add_u32 s62, s54, 10496
    buffer_load_dwordx4 v19, s[16:19], s62 offen lds
    s_add_u32 m0, s60, 6144
    s_add_u32 s62, s54, 384
    buffer_load_dwordx4 v19, s[16:19], s62 offen lds
    s_add_u32 m0, s60, 7168
    s_add_u32 s62, s54, 10624
    buffer_load_dwordx4 v19, s[16:19], s62 offen lds
    s_waitcnt vmcnt(6)
    s_barrier
    ds_read_b128 v[64:67], v24 offset:0
    ds_read_b128 v[68:71], v25 offset:0
    ds_read_b128 v[72:75], v24 offset:2048
    ds_read_b128 v[76:79], v25 offset:2048
    ds_read_b64_tr_b16 v[96:97], v26 offset:0
    ds_read_b64_tr_b16 v[98:99], v26 offset:160
    ds_read_b64_tr_b16 v[100:101], v27 offset:0
    ds_read_b64_tr_b16 v[102:103], v27 offset:160
    ds_read_b64_tr_b16 v[104:105], v26 offset:26624
    ds_read_b64_tr_b16 v[106:107], v26 offset:26784
    ds_read_b64_tr_b16 v[108:109], v26 offset:1280
    ds_read_b64_tr_b16 v[110:111], v26 offset:1440
    ds_read_b64_tr_b16 v[112:113], v27 offset:1280
    ds_read_b64_tr_b16 v[114:115], v27 offset:1440
    s_waitcnt lgkmcnt(8)
    v_mfma_f32_16x16x32_bf16 v[32:35], v[96:99], v[64:67], 0
    s_add_u32 m0, s61, 10240
    s_add_u32 s62, s55, 10240
    buffer_load_dwordx4 v5, s[76:79], s62 offen lds
    ds_read_b64_tr_b16 v[116:117], v26 offset:27904
    v_mfma_f32_16x16x32_bf16 v[44:47], v[96:99], v[168:171], 0
    ds_read_b64_tr_b16 v[118:119], v26 offset:28064
    v_mfma_f32_16x16x32_bf16 v[56:59], v[168:171], v[64:67], 0
    s_waitcnt lgkmcnt(8)
    v_mfma_f32_16x16x32_bf16 v[36:39], v[100:103], v[64:67], 0
    s_add_u32 m0, s61, 12288
    s_add_u32 s62, s55, 12288
    buffer_load_dwordx4 v5, s[76:79], s62 offen lds
    ds_read_b64_tr_b16 v[96:97], v26 offset:2560
    v_mfma_f32_16x16x32_bf16 v[48:51], v[100:103], v[168:171], 0
    ds_read_b64_tr_b16 v[98:99], v26 offset:2720
    v_mfma_f32_16x16x32_bf16 v[60:63], v[64:67], v[64:67], 0
    s_waitcnt lgkmcnt(8)
    v_mfma_f32_16x16x32_bf16 v[40:43], v[104:107], v[64:67], 0
    s_add_u32 m0, s61, 14336
    s_add_u32 s62, s55, 14336
    buffer_load_dwordx4 v5, s[76:79], s62 offen lds
    ds_read_b64_tr_b16 v[100:101], v27 offset:2560
    v_mfma_f32_16x16x32_bf16 v[52:55], v[104:107], v[168:171], 0
    ds_read_b64_tr_b16 v[102:103], v27 offset:2720
    s_waitcnt lgkmcnt(8)
    v_mfma_f32_16x16x32_bf16 v[32:35], v[108:111], v[68:71], v[32:35]
    s_add_u32 m0, s60, 8192
    s_add_u32 s62, s54, 512
    buffer_load_dwordx4 v19, s[16:19], s62 offen lds
    ds_read_b64_tr_b16 v[104:105], v26 offset:29184
    v_mfma_f32_16x16x32_bf16 v[44:47], v[108:111], v[168:171], v[44:47]
    ds_read_b64_tr_b16 v[106:107], v26 offset:29344
    v_mfma_f32_16x16x32_bf16 v[56:59], v[168:171], v[68:71], v[56:59]
    s_waitcnt lgkmcnt(8)
    v_mfma_f32_16x16x32_bf16 v[36:39], v[112:115], v[68:71], v[36:39]
    s_add_u32 m0, s60, 9216
    s_add_u32 s62, s54, 10752
    buffer_load_dwordx4 v19, s[16:19], s62 offen lds
    ds_read_b64_tr_b16 v[108:109], v26 offset:3840
    v_mfma_f32_16x16x32_bf16 v[48:51], v[112:115], v[168:171], v[48:51]
    ds_read_b64_tr_b16 v[110:111], v26 offset:4000
    v_mfma_f32_16x16x32_bf16 v[60:63], v[68:71], v[68:71], v[60:63]
    s_waitcnt lgkmcnt(8)
    v_mfma_f32_16x16x32_bf16 v[40:43], v[116:119], v[68:71], v[40:43]
    s_add_u32 m0, s60, 10240
    s_add_u32 s62, s54, 640
    buffer_load_dwordx4 v19, s[16:19], s62 offen lds
    ds_read_b64_tr_b16 v[112:113], v27 offset:3840
    v_mfma_f32_16x16x32_bf16 v[52:55], v[116:119], v[168:171], v[52:55]
    ds_read_b64_tr_b16 v[114:115], v27 offset:4000
    s_waitcnt lgkmcnt(8)
    v_mfma_f32_16x16x32_bf16 v[32:35], v[96:99], v[72:75], v[32:35]
    s_add_u32 m0, s60, 11264
    s_add_u32 s62, s54, 10880
    buffer_load_dwordx4 v19, s[16:19], s62 offen lds
    ds_read_b64_tr_b16 v[116:117], v26 offset:30464
    v_mfma_f32_16x16x32_bf16 v[44:47], v[96:99], v[168:171], v[44:47]
    ds_read_b64_tr_b16 v[118:119], v26 offset:30624
    v_mfma_f32_16x16x32_bf16 v[56:59], v[168:171], v[72:75], v[56:59]
    s_waitcnt lgkmcnt(8)
    v_mfma_f32_16x16x32_bf16 v[36:39], v[100:103], v[72:75], v[36:39]
    s_waitcnt vmcnt(7)
    s_barrier
    ds_read_b64_tr_b16 v[96:97], v26 offset:5120
    v_mfma_f32_16x16x32_bf16 v[48:51], v[100:103], v[168:171], v[48:51]
    ds_read_b64_tr_b16 v[98:99], v26 offset:5280
    v_mfma_f32_16x16x32_bf16 v[60:63], v[72:75], v[72:75], v[60:63]
    s_waitcnt lgkmcnt(8)
    v_mfma_f32_16x16x32_bf16 v[40:43], v[104:107], v[72:75], v[40:43]
    ds_read_b128 v[80:83], v24 offset:4096
    ds_read_b64_tr_b16 v[100:101], v27 offset:5120
    v_mfma_f32_16x16x32_bf16 v[52:55], v[104:107], v[168:171], v[52:55]
    ds_read_b64_tr_b16 v[102:103], v27 offset:5280
    s_waitcnt lgkmcnt(9)
    v_mfma_f32_16x16x32_bf16 v[32:35], v[108:111], v[76:79], v[32:35]
    ds_read_b128 v[84:87], v25 offset:4096
    ds_read_b64_tr_b16 v[104:105], v26 offset:31744
    v_mfma_f32_16x16x32_bf16 v[44:47], v[108:111], v[168:171], v[44:47]
    ds_read_b64_tr_b16 v[106:107], v26 offset:31904
    v_mfma_f32_16x16x32_bf16 v[56:59], v[168:171], v[76:79], v[56:59]
    s_waitcnt lgkmcnt(10)
    v_mfma_f32_16x16x32_bf16 v[36:39], v[112:115], v[76:79], v[36:39]
    ds_read_b128 v[88:91], v24 offset:6144
    ds_read_b64_tr_b16 v[108:109], v26 offset:6400
    v_mfma_f32_16x16x32_bf16 v[48:51], v[112:115], v[168:171], v[48:51]
    ds_read_b64_tr_b16 v[110:111], v26 offset:6560
    v_mfma_f32_16x16x32_bf16 v[60:63], v[76:79], v[76:79], v[60:63]
    s_waitcnt lgkmcnt(11)
    v_mfma_f32_16x16x32_bf16 v[40:43], v[116:119], v[76:79], v[40:43]
    ds_read_b128 v[92:95], v25 offset:6144
    ds_read_b64_tr_b16 v[112:113], v27 offset:6400
    v_mfma_f32_16x16x32_bf16 v[52:55], v[116:119], v[168:171], v[52:55]
    ds_read_b64_tr_b16 v[114:115], v27 offset:6560
    s_waitcnt lgkmcnt(11)
    v_mfma_f32_16x16x32_bf16 v[32:35], v[96:99], v[80:83], v[32:35]
    s_add_u32 m0, s61, 16384
    s_add_u32 s62, s55, 16384
    buffer_load_dwordx4 v5, s[76:79], s62 offen lds
    ds_read_b64_tr_b16 v[116:117], v26 offset:33024
    v_mfma_f32_16x16x32_bf16 v[44:47], v[96:99], v[168:171], v[44:47]
    ds_read_b64_tr_b16 v[118:119], v26 offset:33184
    v_mfma_f32_16x16x32_bf16 v[56:59], v[168:171], v[80:83], v[56:59]
    s_waitcnt lgkmcnt(11)
    v_mfma_f32_16x16x32_bf16 v[36:39], v[100:103], v[80:83], v[36:39]
    s_add_u32 m0, s61, 18432
    s_add_u32 s62, s55, 18432
    buffer_load_dwordx4 v5, s[76:79], s62 offen lds
    ds_read_b64_tr_b16 v[96:97], v26 offset:7680
    v_mfma_f32_16x16x32_bf16 v[48:51], v[100:103], v[168:171], v[48:51]
    ds_read_b64_tr_b16 v[98:99], v26 offset:7840
    v_mfma_f32_16x16x32_bf16 v[60:63], v[80:83], v[80:83], v[60:63]
    s_waitcnt lgkmcnt(10)
    v_mfma_f32_16x16x32_bf16 v[40:43], v[104:107], v[80:83], v[40:43]
    s_add_u32 m0, s60, 12288
    s_add_u32 s62, s54, 768
    buffer_load_dwordx4 v19, s[16:19], s62 offen lds
    ds_read_b64_tr_b16 v[100:101], v27 offset:7680
    v_mfma_f32_16x16x32_bf16 v[52:55], v[104:107], v[168:171], v[52:55]
    ds_read_b64_tr_b16 v[102:103], v27 offset:7840
    s_waitcnt lgkmcnt(9)
    v_mfma_f32_16x16x32_bf16 v[32:35], v[108:111], v[84:87], v[32:35]
    s_add_u32 m0, s60, 13312
    s_add_u32 s62, s54, 11008
    buffer_load_dwordx4 v19, s[16:19], s62 offen lds
    ds_read_b64_tr_b16 v[104:105], v26 offset:34304
    v_mfma_f32_16x16x32_bf16 v[44:47], v[108:111], v[168:171], v[44:47]
    ds_read_b64_tr_b16 v[106:107], v26 offset:34464
    v_mfma_f32_16x16x32_bf16 v[56:59], v[168:171], v[84:87], v[56:59]
    s_waitcnt lgkmcnt(8)
    v_mfma_f32_16x16x32_bf16 v[36:39], v[112:115], v[84:87], v[36:39]
    s_add_u32 m0, s60, 14336
    s_add_u32 s62, s54, 896
    buffer_load_dwordx4 v19, s[16:19], s62 offen lds
    ds_read_b64_tr_b16 v[108:109], v26 offset:8960
    v_mfma_f32_16x16x32_bf16 v[48:51], v[112:115], v[168:171], v[48:51]
    ds_read_b64_tr_b16 v[110:111], v26 offset:9120
    v_mfma_f32_16x16x32_bf16 v[60:63], v[84:87], v[84:87], v[60:63]
    s_waitcnt lgkmcnt(8)
    v_mfma_f32_16x16x32_bf16 v[40:43], v[116:119], v[84:87], v[40:43]
    s_add_u32 m0, s60, 15360
    s_add_u32 s62, s54, 11136
    buffer_load_dwordx4 v19, s[16:19], s62 offen lds
    ds_read_b64_tr_b16 v[112:113], v27 offset:8960
    v_mfma_f32_16x16x32_bf16 v[52:55], v[116:119], v[168:171], v[52:55]
    ds_read_b64_tr_b16 v[114:115], v27 offset:9120
    s_waitcnt lgkmcnt(8)
    v_mfma_f32_16x16x32_bf16 v[32:35], v[96:99], v[88:91], v[32:35]
    ds_read_b64_tr_b16 v[116:117], v26 offset:35584
    v_mfma_f32_16x16x32_bf16 v[44:47], v[96:99], v[168:171], v[44:47]
    ds_read_b64_tr_b16 v[118:119], v26 offset:35744
    v_mfma_f32_16x16x32_bf16 v[56:59], v[168:171], v[88:91], v[56:59]
    s_waitcnt lgkmcnt(8)
    v_mfma_f32_16x16x32_bf16 v[36:39], v[100:103], v[88:91], v[36:39]
    s_waitcnt vmcnt(6)
    s_barrier
    ds_read_b64_tr_b16 v[96:97], v26 offset:10240
    v_mfma_f32_16x16x32_bf16 v[48:51], v[100:103], v[168:171], v[48:51]
    ds_read_b64_tr_b16 v[98:99], v26 offset:10400
    v_mfma_f32_16x16x32_bf16 v[60:63], v[88:91], v[88:91], v[60:63]
    s_waitcnt lgkmcnt(8)
    v_mfma_f32_16x16x32_bf16 v[40:43], v[104:107], v[88:91], v[40:43]
    ds_read_b128 v[64:67], v24 offset:8192
    ds_read_b64_tr_b16 v[100:101], v27 offset:10240
    v_mfma_f32_16x16x32_bf16 v[52:55], v[104:107], v[168:171], v[52:55]
    ds_read_b64_tr_b16 v[102:103], v27 offset:10400
    s_waitcnt lgkmcnt(9)
    v_mfma_f32_16x16x32_bf16 v[32:35], v[108:111], v[92:95], v[32:35]
    ds_read_b128 v[68:71], v25 offset:8192
    ds_read_b64_tr_b16 v[104:105], v26 offset:36864
    v_mfma_f32_16x16x32_bf16 v[44:47], v[108:111], v[168:171], v[44:47]
    ds_read_b64_tr_b16 v[106:107], v26 offset:37024
    v_mfma_f32_16x16x32_bf16 v[56:59], v[168:171], v[92:95], v[56:59]
    s_waitcnt lgkmcnt(10)
    v_mfma_f32_16x16x32_bf16 v[36:39], v[112:115], v[92:95], v[36:39]
    ds_read_b128 v[72:75], v24 offset:10240
    ds_read_b64_tr_b16 v[108:109], v26 offset:11520
    v_mfma_f32_16x16x32_bf16 v[48:51], v[112:115], v[168:171], v[48:51]
    ds_read_b64_tr_b16 v[110:111], v26 offset:11680
    v_mfma_f32_16x16x32_bf16 v[60:63], v[92:95], v[92:95], v[60:63]
    s_waitcnt lgkmcnt(11)
    v_mfma_f32_16x16x32_bf16 v[40:43], v[116:119], v[92:95], v[40:43]
    ds_read_b128 v[76:79], v25 offset:10240
    ds_read_b64_tr_b16 v[112:113], v27 offset:11520
    v_mfma_f32_16x16x32_bf16 v[52:55], v[116:119], v[168:171], v[52:55]
    ds_read_b64_tr_b16 v[114:115], v27 offset:11680
    s_waitcnt lgkmcnt(11)
    v_mfma_f32_16x16x32_bf16 v[32:35], v[96:99], v[64:67], v[32:35]
    s_add_u32 m0, s61, 20480
    s_add_u32 s62, s55, 20480
    buffer_load_dwordx4 v5, s[76:79], s62 offen lds
    ds_read_b64_tr_b16 v[116:117], v26 offset:38144
    v_mfma_f32_16x16x32_bf16 v[44:47], v[96:99], v[168:171], v[44:47]
    ds_read_b64_tr_b16 v[118:119], v26 offset:38304
    v_mfma_f32_16x16x32_bf16 v[56:59], v[168:171], v[64:67], v[56:59]
    s_waitcnt lgkmcnt(11)
    v_mfma_f32_16x16x32_bf16 v[36:39], v[100:103], v[64:67], v[36:39]
    s_add_u32 m0, s61, 22528
    s_add_u32 s62, s55, 22528
    buffer_load_dwordx4 v5, s[76:79], s62 offen lds
    ds_read_b64_tr_b16 v[96:97], v26 offset:12800
    v_mfma_f32_16x16x32_bf16 v[48:51], v[100:103], v[168:171], v[48:51]
    ds_read_b64_tr_b16 v[98:99], v26 offset:12960
    v_mfma_f32_16x16x32_bf16 v[60:63], v[64:67], v[64:67], v[60:63]
    s_waitcnt lgkmcnt(10)
    v_mfma_f32_16x16x32_bf16 v[40:43], v[104:107], v[64:67], v[40:43]
    s_add_u32 m0, s61, 24576
    s_add_u32 s62, s55, 24576
    buffer_load_dwordx4 v5, s[76:79], s62 offen lds
    ds_read_b64_tr_b16 v[100:101], v27 offset:12800
    v_mfma_f32_16x16x32_bf16 v[52:55], v[104:107], v[168:171], v[52:55]
    ds_read_b64_tr_b16 v[102:103], v27 offset:12960
    s_waitcnt lgkmcnt(9)
    v_mfma_f32_16x16x32_bf16 v[32:35], v[108:111], v[68:71], v[32:35]
    s_add_u32 m0, s60, 16384
    s_add_u32 s62, s54, 1024
    buffer_load_dwordx4 v19, s[16:19], s62 offen lds
    ds_read_b64_tr_b16 v[104:105], v26 offset:39424
    v_mfma_f32_16x16x32_bf16 v[44:47], v[108:111], v[168:171], v[44:47]
    ds_read_b64_tr_b16 v[106:107], v26 offset:39584
    v_mfma_f32_16x16x32_bf16 v[56:59], v[168:171], v[68:71], v[56:59]
    s_waitcnt lgkmcnt(8)
    v_mfma_f32_16x16x32_bf16 v[36:39], v[112:115], v[68:71], v[36:39]
    s_add_u32 m0, s60, 17408
    s_add_u32 s62, s54, 11264
    buffer_load_dwordx4 v19, s[16:19], s62 offen lds
    ds_read_b64_tr_b16 v[108:109], v26 offset:14080
    v_mfma_f32_16x16x32_bf16 v[48:51], v[112:115], v[168:171], v[48:51]
    ds_read_b64_tr_b16 v[110:111], v26 offset:14240
    v_mfma_f32_16x16x32_bf16 v[60:63], v[68:71], v[68:71], v[60:63]
    s_waitcnt lgkmcnt(8)
    v_mfma_f32_16x16x32_bf16 v[40:43], v[116:119], v[68:71], v[40:43]
    s_add_u32 m0, s60, 18432
    s_add_u32 s62, s54, 1152
    buffer_load_dwordx4 v19, s[16:19], s62 offen lds
    ds_read_b64_tr_b16 v[112:113], v27 offset:14080
    v_mfma_f32_16x16x32_bf16 v[52:55], v[116:119], v[168:171], v[52:55]
    ds_read_b64_tr_b16 v[114:115], v27 offset:14240
    s_waitcnt lgkmcnt(8)
    v_mfma_f32_16x16x32_bf16 v[32:35], v[96:99], v[72:75], v[32:35]
    s_add_u32 m0, s60, 19456
    s_add_u32 s62, s54, 11392
    buffer_load_dwordx4 v19, s[16:19], s62 offen lds
    ds_read_b64_tr_b16 v[116:117], v26 offset:40704
    v_mfma_f32_16x16x32_bf16 v[44:47], v[96:99], v[168:171], v[44:47]
    ds_read_b64_tr_b16 v[118:119], v26 offset:40864
    v_mfma_f32_16x16x32_bf16 v[56:59], v[168:171], v[72:75], v[56:59]
    s_waitcnt lgkmcnt(8)
    v_mfma_f32_16x16x32_bf16 v[36:39], v[100:103], v[72:75], v[36:39]
    s_waitcnt vmcnt(7)
    s_barrier
    ds_read_b64_tr_b16 v[96:97], v26 offset:15360
    v_mfma_f32_16x16x32_bf16 v[48:51], v[100:103], v[168:171], v[48:51]
    ds_read_b64_tr_b16 v[98:99], v26 offset:15520
    v_mfma_f32_16x16x32_bf16 v[60:63], v[72:75], v[72:75], v[60:63]
    s_waitcnt lgkmcnt(8)
    v_mfma_f32_16x16x32_bf16 v[40:43], v[104:107], v[72:75], v[40:43]
    ds_read_b128 v[80:83], v24 offset:12288
    ds_read_b64_tr_b16 v[100:101], v27 offset:15360
    v_mfma_f32_16x16x32_bf16 v[52:55], v[104:107], v[168:171], v[52:55]
    ds_read_b64_tr_b16 v[102:103], v27 offset:15520
    s_waitcnt lgkmcnt(9)
    v_mfma_f32_16x16x32_bf16 v[32:35], v[108:111], v[76:79], v[32:35]
    ds_read_b128 v[84:87], v25 offset:12288
    s_lshl_b32 s60, s49, 2
    s_add_u32 s60, s60, s32
    s_lshl_b32 s60, s60, 7
    s_add_u32 s60, s60, 7274496
    s_mul_i32 s61, s49, 5248
    s_add_u32 s61, s61, 7077888
    buffer_load_dword v18, v31, s[28:31], s60 offen sc1
    ds_read_b64_tr_b16 v[104:105], v26 offset:41984
    v_mfma_f32_16x16x32_bf16 v[44:47], v[108:111], v[168:171], v[44:47]
    ds_read_b64_tr_b16 v[106:107], v26 offset:42144
    v_mfma_f32_16x16x32_bf16 v[56:59], v[168:171], v[76:79], v[56:59]
    s_waitcnt lgkmcnt(10)
    v_mfma_f32_16x16x32_bf16 v[36:39], v[112:115], v[76:79], v[36:39]
    ds_read_b128 v[88:91], v24 offset:14336
    ds_read_b64_tr_b16 v[108:109], v26 offset:16640
    v_mfma_f32_16x16x32_bf16 v[48:51], v[112:115], v[168:171], v[48:51]
    ds_read_b64_tr_b16 v[110:111], v26 offset:16800
    v_mfma_f32_16x16x32_bf16 v[60:63], v[76:79], v[76:79], v[60:63]
    s_waitcnt lgkmcnt(11)
    v_mfma_f32_16x16x32_bf16 v[40:43], v[116:119], v[76:79], v[40:43]
    ds_read_b128 v[92:95], v25 offset:14336
    ds_read_b64_tr_b16 v[112:113], v27 offset:16640
    v_mfma_f32_16x16x32_bf16 v[52:55], v[116:119], v[168:171], v[52:55]
    ds_read_b64_tr_b16 v[114:115], v27 offset:16800
    s_waitcnt lgkmcnt(11)
    v_mfma_f32_16x16x32_bf16 v[32:35], v[96:99], v[80:83], v[32:35]
    ds_read_b64_tr_b16 v[116:117], v26 offset:43264
    v_mfma_f32_16x16x32_bf16 v[44:47], v[96:99], v[168:171], v[44:47]
    ds_read_b64_tr_b16 v[118:119], v26 offset:43424
    v_mfma_f32_16x16x32_bf16 v[56:59], v[168:171], v[80:83], v[56:59]
    s_waitcnt lgkmcnt(11)
    v_mfma_f32_16x16x32_bf16 v[36:39], v[100:103], v[80:83], v[36:39]
    ds_read_b64_tr_b16 v[96:97], v26 offset:17920
    v_mfma_f32_16x16x32_bf16 v[48:51], v[100:103], v[168:171], v[48:51]
    ds_read_b64_tr_b16 v[98:99], v26 offset:18080
    v_mfma_f32_16x16x32_bf16 v[60:63], v[80:83], v[80:83], v[60:63]
    s_waitcnt lgkmcnt(10)
    v_mfma_f32_16x16x32_bf16 v[40:43], v[104:107], v[80:83], v[40:43]
    ds_read_b64_tr_b16 v[100:101], v27 offset:17920
    v_mfma_f32_16x16x32_bf16 v[52:55], v[104:107], v[168:171], v[52:55]
    ds_read_b64_tr_b16 v[102:103], v27 offset:18080
    s_waitcnt lgkmcnt(9)
    v_mfma_f32_16x16x32_bf16 v[32:35], v[108:111], v[84:87], v[32:35]
    ds_read_b64_tr_b16 v[104:105], v26 offset:44544
    v_mfma_f32_16x16x32_bf16 v[44:47], v[108:111], v[168:171], v[44:47]
    ds_read_b64_tr_b16 v[106:107], v26 offset:44704
    v_mfma_f32_16x16x32_bf16 v[56:59], v[168:171], v[84:87], v[56:59]
    s_waitcnt lgkmcnt(8)
    v_mfma_f32_16x16x32_bf16 v[36:39], v[112:115], v[84:87], v[36:39]
    ds_read_b64_tr_b16 v[108:109], v26 offset:19200
    v_mfma_f32_16x16x32_bf16 v[48:51], v[112:115], v[168:171], v[48:51]
    ds_read_b64_tr_b16 v[110:111], v26 offset:19360
    v_mfma_f32_16x16x32_bf16 v[60:63], v[84:87], v[84:87], v[60:63]
    s_waitcnt lgkmcnt(8)
    v_mfma_f32_16x16x32_bf16 v[40:43], v[116:119], v[84:87], v[40:43]
    ds_read_b64_tr_b16 v[112:113], v27 offset:19200
    v_mfma_f32_16x16x32_bf16 v[52:55], v[116:119], v[168:171], v[52:55]
    ds_read_b64_tr_b16 v[114:115], v27 offset:19360
    s_waitcnt lgkmcnt(8)
    v_mfma_f32_16x16x32_bf16 v[32:35], v[96:99], v[88:91], v[32:35]
    ds_read_b64_tr_b16 v[116:117], v26 offset:45824
    v_mfma_f32_16x16x32_bf16 v[44:47], v[96:99], v[168:171], v[44:47]
    ds_read_b64_tr_b16 v[118:119], v26 offset:45984
    v_mfma_f32_16x16x32_bf16 v[56:59], v[168:171], v[88:91], v[56:59]
    s_waitcnt lgkmcnt(8)
    v_mfma_f32_16x16x32_bf16 v[36:39], v[100:103], v[88:91], v[36:39]
    s_waitcnt vmcnt(1)
    s_barrier
    ds_read_b64_tr_b16 v[96:97], v26 offset:20480
    v_mfma_f32_16x16x32_bf16 v[48:51], v[100:103], v[168:171], v[48:51]
    ds_read_b64_tr_b16 v[98:99], v26 offset:20640
    v_mfma_f32_16x16x32_bf16 v[60:63], v[88:91], v[88:91], v[60:63]
    s_waitcnt lgkmcnt(8)
    v_mfma_f32_16x16x32_bf16 v[40:43], v[104:107], v[88:91], v[40:43]
    ds_read_b128 v[64:67], v24 offset:16384
    v_lshlrev_b32 v21, 4, v1
    v_and_b32 v21, 0xf0, v21
    global_load_dwordx2 v[22:23], v21, s[80:81] sc1
    v_and_b32 v175, 15, v1
    v_xor_b32 v175, s58, v175
    v_min_u32 v175, 2, v175
    v_lshlrev_b32 v175, 3, v175
    v_lshrrev_b32 v175, v175, v174
    v_and_b32 v175, 0x11, v175
    v_lshlrev_b32_e64 v175, 20, v175
    ds_read_b64_tr_b16 v[100:101], v27 offset:20480
    v_mfma_f32_16x16x32_bf16 v[52:55], v[104:107], v[168:171], v[52:55]
    ds_read_b64_tr_b16 v[102:103], v27 offset:20640
    s_waitcnt lgkmcnt(9)
    v_mfma_f32_16x16x32_bf16 v[32:35], v[108:111], v[92:95], v[32:35]
    ds_read_b128 v[68:71], v25 offset:16384
    ds_read_b64_tr_b16 v[104:105], v26 offset:47104
    v_mfma_f32_16x16x32_bf16 v[44:47], v[108:111], v[168:171], v[44:47]
    ds_read_b64_tr_b16 v[106:107], v26 offset:47264
    v_mfma_f32_16x16x32_bf16 v[56:59], v[168:171], v[92:95], v[56:59]
    s_waitcnt lgkmcnt(10)
    v_mfma_f32_16x16x32_bf16 v[36:39], v[112:115], v[92:95], v[36:39]
    ds_read_b128 v[72:75], v24 offset:18432
    ds_read_b64_tr_b16 v[108:109], v26 offset:21760
    v_mfma_f32_16x16x32_bf16 v[48:51], v[112:115], v[168:171], v[48:51]
    ds_read_b64_tr_b16 v[110:111], v26 offset:21920
    v_mfma_f32_16x16x32_bf16 v[60:63], v[92:95], v[92:95], v[60:63]
    s_waitcnt lgkmcnt(11)
    v_mfma_f32_16x16x32_bf16 v[40:43], v[116:119], v[92:95], v[40:43]
    ds_read_b128 v[76:79], v25 offset:18432
    v_cmp_eq_u32 s[54:55], 2, v129
    v_cmp_eq_u32 vcc, 3, v129
    ds_read_b64_tr_b16 v[112:113], v27 offset:21760
    v_mfma_f32_16x16x32_bf16 v[52:55], v[116:119], v[168:171], v[52:55]
    ds_read_b64_tr_b16 v[114:115], v27 offset:21920
    s_waitcnt lgkmcnt(8)
    v_mfma_f32_16x16x32_bf16 v[32:35], v[96:99], v[64:67], v[32:35]
    ds_read_b64_tr_b16 v[116:117], v26 offset:48384
    v_mfma_f32_16x16x32_bf16 v[44:47], v[96:99], v[168:171], v[44:47]
    ds_read_b64_tr_b16 v[118:119], v26 offset:48544
    v_mfma_f32_16x16x32_bf16 v[56:59], v[168:171], v[64:67], v[56:59]
    v_mfma_f32_16x16x32_bf16 v[60:63], v[64:67], v[64:67], v[60:63]
    v_mfma_f32_16x16x32_bf16 v[56:59], v[168:171], v[68:71], v[56:59]
    v_mfma_f32_16x16x32_bf16 v[60:63], v[68:71], v[68:71], v[60:63]
    s_waitcnt lgkmcnt(4)
    v_mfma_f32_16x16x32_bf16 v[36:39], v[100:103], v[64:67], v[36:39]
    ds_read_b64_tr_b16 v[96:97], v26 offset:23040
    v_mfma_f32_16x16x32_bf16 v[48:51], v[100:103], v[168:171], v[48:51]
    ds_read_b64_tr_b16 v[98:99], v26 offset:23200
    v_mfma_f32_16x16x32_bf16 v[56:59], v[168:171], v[72:75], v[56:59]
    v_mfma_f32_16x16x32_bf16 v[60:63], v[72:75], v[72:75], v[60:63]
    v_mfma_f32_16x16x32_bf16 v[56:59], v[168:171], v[76:79], v[56:59]
    v_mfma_f32_16x16x32_bf16 v[60:63], v[76:79], v[76:79], v[60:63]
    v_mfma_f32_16x16x32_bf16 v[40:43], v[104:107], v[64:67], v[40:43]
    ds_read_b64_tr_b16 v[100:101], v27 offset:23040
    v_mfma_f32_16x16x32_bf16 v[52:55], v[104:107], v[168:171], v[52:55]
    ds_read_b64_tr_b16 v[102:103], v27 offset:23200
    v_mfma_f32_16x16x32_bf16 v[32:35], v[108:111], v[68:71], v[32:35]
    s_nop 2
    v_cndmask_b32 v30, 0, v60, s[50:51]
    v_cndmask_b32 v2, 0, v61, s[52:53]
    v_cndmask_b32 v30, v30, v62, s[54:55]
    v_cndmask_b32 v2, v2, v63, vcc
    v_add_f32 v30, v30, v2
    v_mov_b32 v2, v30
    ds_read_b64_tr_b16 v[104:105], v26 offset:49664
    v_mfma_f32_16x16x32_bf16 v[44:47], v[108:111], v[168:171], v[44:47]
    ds_read_b64_tr_b16 v[106:107], v26 offset:49824
    s_waitcnt lgkmcnt(8)
    v_mfma_f32_16x16x32_bf16 v[36:39], v[112:115], v[68:71], v[36:39]
    v_permlane16_swap_b32 v30, v2
    v_mul_f32 v28, 0x3acccccd, v56
    v_add_f32 v30, v30, v2
    v_mov_b32 v2, v30
    ds_read_b64_tr_b16 v[108:109], v26 offset:24320
    v_mfma_f32_16x16x32_bf16 v[48:51], v[112:115], v[168:171], v[48:51]
    ds_read_b64_tr_b16 v[110:111], v26 offset:24480
    s_waitcnt lgkmcnt(8)
    v_mfma_f32_16x16x32_bf16 v[40:43], v[116:119], v[68:71], v[40:43]
    v_permlane32_swap_b32 v30, v2
    v_mul_f32 v3, v28, v28
    v_add_f32 v30, v30, v2
    v_fma_f32 v2, v30, v127, -v3
    v_max_f32_e64 v2, 0, v2
    v_add_f32 v2, 0x3727c5ac, v2
    v_rsq_f32 v29, v2
    v_mov_b32 v30, 0
    buffer_store_dwordx2 v[28:29], v31, s[28:31], s60 offen
    ds_read_b64_tr_b16 v[112:113], v27 offset:24320
    v_mfma_f32_16x16x32_bf16 v[52:55], v[116:119], v[168:171], v[52:55]
    ds_read_b64_tr_b16 v[114:115], v27 offset:24480
    s_waitcnt lgkmcnt(8)
    v_mfma_f32_16x16x32_bf16 v[32:35], v[96:99], v[72:75], v[32:35]
    ds_read_b64_tr_b16 v[116:117], v26 offset:50944
    v_mfma_f32_16x16x32_bf16 v[44:47], v[96:99], v[168:171], v[44:47]
    ds_read_b64_tr_b16 v[118:119], v26 offset:51104
    s_waitcnt lgkmcnt(8)
    v_mfma_f32_16x16x32_bf16 v[36:39], v[100:103], v[72:75], v[36:39]
    v_mfma_f32_16x16x32_bf16 v[48:51], v[100:103], v[168:171], v[48:51]
    s_waitcnt lgkmcnt(6)
    v_mfma_f32_16x16x32_bf16 v[40:43], v[104:107], v[72:75], v[40:43]
    v_mfma_f32_16x16x32_bf16 v[52:55], v[104:107], v[168:171], v[52:55]
    s_waitcnt lgkmcnt(4)
    v_mfma_f32_16x16x32_bf16 v[32:35], v[108:111], v[76:79], v[32:35]
    s_waitcnt vmcnt(1)
    v_and_b32 v173, v23, v175
    v_cmp_ne_u32 vcc, v173, v175
    s_cbranch_vccnz BT_5w
BT_5r:
    v_readlane_b32 s34, v22, s58
    v_readlane_b32 s35, v23, s58
    s_nop 3
    s_lshr_b64 s[34:35], s[34:35], s57
    s_and_b32 s34, s34, 31
    s_cmp_eq_u32 s34, 16
    s_cselect_b32 s57, 1, 2
    v_mfma_f32_16x16x32_bf16 v[44:47], v[108:111], v[168:171], v[44:47]
    s_waitcnt lgkmcnt(2)
    v_mfma_f32_16x16x32_bf16 v[36:39], v[112:115], v[76:79], v[36:39]
    v_mfma_f32_16x16x32_bf16 v[48:51], v[112:115], v[168:171], v[48:51]
    s_waitcnt lgkmcnt(0)
    v_mfma_f32_16x16x32_bf16 v[40:43], v[116:119], v[76:79], v[40:43]
    v_mfma_f32_16x16x32_bf16 v[52:55], v[116:119], v[168:171], v[52:55]
    v_mov_b32 v2, s57
    v_lshlrev_b32 v3, 24, v1
    s_cmp_eq_u32 s57, 1
    s_waitcnt vmcnt(0)
    s_cbranch_scc0 K2_SS0
    buffer_store_byte v2, v3, s[28:31], s59 offen offset:0
K2_SR0:
    v_pk_fma_f32 v[32:33], v[44:45], v[28:29], v[32:33] op_sel_hi:[1,0,1] neg_lo:[0,1,0] neg_hi:[0,1,0]
    v_pk_fma_f32 v[34:35], v[46:47], v[28:29], v[34:35] op_sel_hi:[1,0,1] neg_lo:[0,1,0] neg_hi:[0,1,0]
    v_pk_fma_f32 v[36:37], v[48:49], v[28:29], v[36:37] op_sel_hi:[1,0,1] neg_lo:[0,1,0] neg_hi:[0,1,0]
    v_pk_fma_f32 v[38:39], v[50:51], v[28:29], v[38:39] op_sel_hi:[1,0,1] neg_lo:[0,1,0] neg_hi:[0,1,0]
    v_pk_fma_f32 v[40:41], v[52:53], v[28:29], v[40:41] op_sel_hi:[1,0,1] neg_lo:[0,1,0] neg_hi:[0,1,0]
    v_pk_fma_f32 v[42:43], v[54:55], v[28:29], v[42:43] op_sel_hi:[1,0,1] neg_lo:[0,1,0] neg_hi:[0,1,0]
    v_pk_mul_f32 v[32:33], v[32:33], v[28:29] op_sel:[0,1] op_sel_hi:[1,1]
    v_pk_mul_f32 v[34:35], v[34:35], v[28:29] op_sel:[0,1] op_sel_hi:[1,1]
    v_pk_mul_f32 v[36:37], v[36:37], v[28:29] op_sel:[0,1] op_sel_hi:[1,1]
    v_pk_mul_f32 v[38:39], v[38:39], v[28:29] op_sel:[0,1] op_sel_hi:[1,1]
    v_pk_mul_f32 v[40:41], v[40:41], v[28:29] op_sel:[0,1] op_sel_hi:[1,1]
    v_pk_mul_f32 v[42:43], v[42:43], v[28:29] op_sel:[0,1] op_sel_hi:[1,1]
    v_cvt_pk_bf16_f32 v44, v32, v33
    v_cvt_pk_bf16_f32 v45, v34, v35
    v_cvt_pk_bf16_f32 v46, v36, v37
    v_cvt_pk_bf16_f32 v47, v38, v39
    v_cvt_pk_bf16_f32 v48, v40, v41
    v_cvt_pk_bf16_f32 v49, v42, v43
    ds_write_b64 v120, v[44:45]
    ds_write_b16 v123, v48 offset:0
    ds_write_b16_d16_hi v123, v48 offset:16
    ds_write_b16 v123, v49 offset:32
    ds_write_b16_d16_hi v123, v49 offset:48
    v_dot2c_f32_bf16 v30, v44, v44
    v_dot2c_f32_bf16 v30, v45, v45
    s_mov_b64 exec, 0xffff
    ds_write_b64 v121, v[46:47] offset:2048
    v_dot2c_f32_bf16 v30, v46, v46
    v_dot2c_f32_bf16 v30, v47, v47
    s_mov_b32 exec_lo, 0xffff0000
    ds_write_b16 v122, v46 offset:256
    ds_write_b16_d16_hi v122, v46 offset:272
    ds_write_b16 v122, v47 offset:288
    ds_write_b16_d16_hi v122, v47 offset:304
    s_mov_b64 exec, -1
    s_waitcnt lgkmcnt(0)
    s_barrier
    ds_read_b128 v[32:35], v125
    ds_read_b128 v[36:39], v125 offset:4096
    v_mov_b32 v2, v30
    s_nop 1
    v_permlane16_swap_b32 v30, v2
    v_add_f32 v30, v30, v2
    v_mov_b32 v2, v30
    s_nop 1
    v_permlane32_swap_b32 v30, v2
    v_add_f32 v30, v30, v2
    s_waitcnt lgkmcnt(1)
    buffer_store_dwordx4 v[32:35], v124, s[28:31], s61 offen sc1
    s_waitcnt lgkmcnt(0)
    buffer_store_dwordx4 v[36:39], v126, s[28:31], s61 offen sc1
    v_max_f32_dpp v30, v30, v30 row_ror:8 row_mask:0xf bank_mask:0xf
    s_nop 1
    v_max_f32_dpp v30, v30, v30 row_ror:4 row_mask:0xf bank_mask:0xf
    s_nop 1
    v_max_f32_dpp v30, v30, v30 row_ror:2 row_mask:0xf bank_mask:0xf
    s_nop 1
    v_max_f32_dpp v30, v30, v30 row_ror:1 row_mask:0xf bank_mask:0xf
    ds_write_b32 v128, v30
    v_mov_b32 v26, 141312
    v_lshlrev_b32 v41, 9, v1
    s_lshl_b32 s62, s49, 2
    s_add_u32 s62, s62, 7299200
    s_cmp_lg_u32 s32, 1
    s_cbranch_scc1 P1_KB
    v_lshlrev_b32_e64 v21, 4, v1
    v_and_b32 v21, 0xf0, v21
    global_load_dwordx2 v[22:23], v21, s[80:81] sc1
    v_mov_b32 v175, 0x1000000
    s_waitcnt vmcnt(0)
    v_and_b32 v173, v23, v175
    v_cmp_ne_u32 vcc, v173, v175
    s_cbranch_vccnz BT_6w
BT_6r:
P1_KB:
    s_waitcnt vmcnt(0) lgkmcnt(0)
    s_barrier
    s_cmp_lg_u32 s32, 0
    s_cbranch_scc1 P1_SETUP
    ds_read_b128 v[44:47], v26
    s_waitcnt lgkmcnt(0)
    v_max3_f32 v40, v44, v45, v46
    v_max_f32 v40, v40, v47
    v_or_b32_e64 v40, 1, v40
    s_mov_b64 exec, 0xff
    buffer_store_dword v40, v41, s[28:31], s62 offen sc1
    s_mov_b64 exec, -1
    s_branch P1_SETUP
P1_Q:
    v_and_b32 v2, 7, v1
    v_lshrrev_b32 v4, 4, v1
    v_xor_b32 v3, v4, v2
    v_lshlrev_b32 v3, 4, v3
    v_lshl_add_u32 v3, v2, 7, v3
    v_bfe_u32 v2, v1, 3, 1
    v_lshl_add_u32 v3, v2, 10, v3
    v_add_u32 v24, s60, v3
    v_xor_b32 v25, 64, v24
    v_mov_b32 v168, 0x3f803f80
    v_mov_b32 v169, 0x3f803f80
    v_mov_b32 v170, 0x3f803f80
    v_mov_b32 v171, 0x3f803f80
    v_lshrrev_b32 v2, 2, v1
    v_and_b32 v3, 3, v1
    v_lshlrev_b32_e64 v3, 3, v3
    v_lshl_add_u32 v3, v2, 7, v3
    v_bfe_u32 v2, v1, 3, 2
    v_lshl_add_u32 v3, v2, 5, v3
    v_add_u32 v3, 65536, v3
    s_xor_b32 s24, s32, 0
    s_lshl_b32 s34, s24, 5
    v_xor_b32_e64 v26, s34, v3
    v_add_u32 v124, 0x10000, v26
    s_xor_b32 s25, s32, 1
    s_lshl_b32 s34, s25, 5
    v_xor_b32_e64 v27, s34, v3
    v_add_u32 v125, 0x10000, v27
    s_xor_b32 s26, s32, 2
    s_lshl_b32 s34, s26, 5
    v_xor_b32_e64 v28, s34, v3
    v_add_u32 v126, 0x10000, v28
    s_xor_b32 s27, s32, 3
    s_lshl_b32 s34, s27, 5
    v_xor_b32_e64 v29, s34, v3
    v_add_u32 v127, 0x10000, v29
    v_and_b32_e64 v128, 48, v1
    v_add_u32 v128, 147456, v128
    s_lshl_b32 s34, s32, 6
    v_add_u32 v129, s34, v128
    s_mov_b32 s66, 819200
    s_mov_b32 s43, 1280
    s_mov_b32 s48, 858993460
    s_mov_b32 s49, 10223616
    s_cmp_ge_u32 s2, 40
    s_cselect_b64 s[64:65], s[70:71], s[68:69]
    s_cselect_b32 s66, 2211840, s66
    s_cselect_b32 s43, 3456, s43
    s_cselect_b32 s44, 7, 5
    s_cselect_b32 s48, 613566757, s48
    s_cselect_b32 s49, 11075584, s49
    s_cselect_b32 s50, 40, 0
    s_cmp_ge_u32 s2, 148
    s_cselect_b64 s[64:65], s[72:73], s[64:65]
    s_cselect_b32 s43, 1280, s43
    s_cselect_b32 s44, 5, s44
    s_cselect_b32 s48, 858993460, s48
    s_cselect_b32 s49, 13369344, s49
    s_cselect_b32 s50, 148, s50
    s_cselect_b32 s45, 54, 20
    s_cselect_b32 s46, 0, 1
    s_cselect_b32 s47, 1, 0
    s_and_b32 s65, s65, 0xffff
    s_mov_b32 s67, 0x20000
    s_sub_u32 s50, s2, s50
    s_lshr_b32 s52, s50, 2
    s_and_b32 s51, s50, 3
    s_mul_i32 s51, s51, 5
    s_lshr_b32 s34, s50, 1
    s_and_b32 s35, s50, 1
    s_mul_i32 s35, s35, 5
    s_cmp_ge_u32 s2, 148
    s_cselect_b32 s51, s34, s51
    s_cselect_b32 s52, s35, s52
    s_lshr_b32 s53, s32, 1
    s_mul_i32 s34, s53, s46
    s_add_u32 s51, s51, s34
    s_mul_i32 s34, s53, s47
    s_add_u32 s52, s52, s34
    s_lshl_b32 s46, s46, 1
    s_lshl_b32 s47, s47, 1
    v_lshrrev_b32 v2, 5, v1
    v_bfe_u32 v3, v1, 4, 1
    v_bfe_u32 v4, v1, 2, 2
    v_and_b32_e64 v172, 3, v1
    v_lshlrev_b32 v172, 4, v172
    s_and_b32 s34, s51, 7
    s_mul_i32 s34, s34, 80
    s_lshr_b32 s35, s51, 3
    s_lshl_b32 s35, s35, 2
    s_add_u32 s34, s34, s35
    s_mul_i32 s35, s51, 160
    s_sub_u32 s35, s35, 2544
    s_cmp_lt_u32 s51, 16
    s_cselect_b32 s34, s34, s35
    s_cselect_b32 s4, 20, 40
    s_cselect_b32 s7, 8, 20
    s_lshl_b32 s35, s51, 5
    s_cmp_lt_u32 s2, 40
    s_cselect_b32 s34, s34, s35
    s_cselect_b32 s4, s4, 8
    s_cselect_b32 s7, s7, 4
    v_mad_u32_u24 v132, v2, s4, v4
    v_mad_u32_u24 v132, v3, s7, v132
    v_mad_u32_u24 v132, v132, s43, v172
    s_mul_i32 s7, s4, s43
    s_lshl_b32 s7, s7, 1
    s_mul_i32 s34, s34, s43
    s_lshl_b32 s35, s52, 7
    s_add_u32 s34, s34, s35
    s_and_b32 s35, s32, 1
    s_lshl_b32 s35, s35, 6
    s_add_u32 s4, s34, s35
    s_add_u32 s7, s7, s4
    s_and_b32 s34, s32, 1
    s_lshl_b32 s34, s34, 1
    s_lshl_b32 s35, s52, 2
    s_add_u32 s34, s34, s35
    s_add_u32 s34, s34, 0
    s_mul_hi_u32 s35, s34, s48
    s_mul_i32 s68, s35, s44
    s_sub_u32 s34, s34, s68
    s_cmp_eq_u32 s34, 0
    s_cselect_b32 s68, s44, s34
    s_sub_u32 s68, s68, 1
    s_bitcmp1_b32 s35, 0
    s_cselect_b32 s34, s68, s34
    s_mul_i32 s68, s35, 7
    s_add_u32 s68, s68, s34
    s_lshl_b32 s68, s68, 9
    s_and_b32 s74, s50, 3
    s_lshl_b32 s74, s74, 1
    s_add_u32 s74, s74, s53
    s_lshl_b32 s74, s74, 2
    s_add_u32 s74, s74, s68
    s_add_u32 s74, s74, 7471104
    s_cmp_eq_u32 s44, 7
    s_cselect_b32 s74, s74, 25165824
    s_mul_i32 s35, s35, s45
    s_add_u32 s35, s35, s51
    s_mul_i32 s35, s35, s44
    s_add_u32 s35, s35, s34
    s_lshl_b32 s35, s35, 10
    s_add_u32 s68, s35, s49
    s_and_b32 s34, s32, 1
    s_lshl_b32 s34, s34, 1
    s_lshl_b32 s35, s52, 2
    s_add_u32 s34, s34, s35
    s_add_u32 s34, s34, 1
    s_mul_hi_u32 s35, s34, s48
    s_mul_i32 s69, s35, s44
    s_sub_u32 s34, s34, s69
    s_cmp_eq_u32 s34, 0
    s_cselect_b32 s69, s44, s34
    s_sub_u32 s69, s69, 1
    s_bitcmp1_b32 s35, 0
    s_cselect_b32 s34, s69, s34
    s_mul_i32 s69, s35, 7
    s_add_u32 s69, s69, s34
    s_lshl_b32 s69, s69, 9
    s_and_b32 s75, s50, 3
    s_lshl_b32 s75, s75, 1
    s_add_u32 s75, s75, s53
    s_lshl_b32 s75, s75, 2
    s_add_u32 s75, s75, s69
    s_add_u32 s75, s75, 7471104
    s_cmp_eq_u32 s44, 7
    s_cselect_b32 s75, s75, 25165824
    s_mul_i32 s35, s35, s45
    s_add_u32 s35, s35, s51
    s_mul_i32 s35, s35, s44
    s_add_u32 s35, s35, s34
    s_lshl_b32 s35, s35, 10
    s_add_u32 s69, s35, s49
    s_add_u32 s51, s51, s46
    s_add_u32 s52, s52, s47
    s_and_b32 s34, s51, 7
    s_mul_i32 s34, s34, 80
    s_lshr_b32 s35, s51, 3
    s_lshl_b32 s35, s35, 2
    s_add_u32 s34, s34, s35
    s_mul_i32 s35, s51, 160
    s_sub_u32 s35, s35, 2544
    s_cmp_lt_u32 s51, 16
    s_cselect_b32 s34, s34, s35
    s_cselect_b32 s5, 20, 40
    s_cselect_b32 s14, 8, 20
    s_lshl_b32 s35, s51, 5
    s_cmp_lt_u32 s2, 40
    s_cselect_b32 s34, s34, s35
    s_cselect_b32 s5, s5, 8
    s_cselect_b32 s14, s14, 4
    v_mad_u32_u24 v133, v2, s5, v4
    v_mad_u32_u24 v133, v3, s14, v133
    v_mad_u32_u24 v133, v133, s43, v172
    s_mul_i32 s14, s5, s43
    s_lshl_b32 s14, s14, 1
    s_mul_i32 s34, s34, s43
    s_lshl_b32 s35, s52, 7
    s_add_u32 s34, s34, s35
    s_and_b32 s35, s32, 1
    s_lshl_b32 s35, s35, 6
    s_add_u32 s5, s34, s35
    s_add_u32 s14, s14, s5
    s_and_b32 s34, s32, 1
    s_lshl_b32 s34, s34, 1
    s_lshl_b32 s35, s52, 2
    s_add_u32 s34, s34, s35
    s_add_u32 s34, s34, 0
    s_mul_hi_u32 s35, s34, s48
    s_mul_i32 s70, s35, s44
    s_sub_u32 s34, s34, s70
    s_cmp_eq_u32 s34, 0
    s_cselect_b32 s70, s44, s34
    s_sub_u32 s70, s70, 1
    s_bitcmp1_b32 s35, 0
    s_cselect_b32 s34, s70, s34
    s_mul_i32 s35, s35, s45
    s_add_u32 s35, s35, s51
    s_mul_i32 s35, s35, s44
    s_add_u32 s35, s35, s34
    s_lshl_b32 s35, s35, 10
    s_add_u32 s70, s35, s49
    s_and_b32 s34, s32, 1
    s_lshl_b32 s34, s34, 1
    s_lshl_b32 s35, s52, 2
    s_add_u32 s34, s34, s35
    s_add_u32 s34, s34, 1
    s_mul_hi_u32 s35, s34, s48
    s_mul_i32 s71, s35, s44
    s_sub_u32 s34, s34, s71
    s_cmp_eq_u32 s34, 0
    s_cselect_b32 s71, s44, s34
    s_sub_u32 s71, s71, 1
    s_bitcmp1_b32 s35, 0
    s_cselect_b32 s34, s71, s34
    s_mul_i32 s35, s35, s45
    s_add_u32 s35, s35, s51
    s_mul_i32 s35, s35, s44
    s_add_u32 s35, s35, s34
    s_lshl_b32 s35, s35, 10
    s_add_u32 s71, s35, s49
    s_add_u32 s51, s51, s46
    s_add_u32 s52, s52, s47
    s_and_b32 s34, s51, 7
    s_mul_i32 s34, s34, 80
    s_lshr_b32 s35, s51, 3
    s_lshl_b32 s35, s35, 2
    s_add_u32 s34, s34, s35
    s_mul_i32 s35, s51, 160
    s_sub_u32 s35, s35, 2544
    s_cmp_lt_u32 s51, 16
    s_cselect_b32 s34, s34, s35
    s_cselect_b32 s6, 20, 40
    s_cselect_b32 s15, 8, 20
    s_lshl_b32 s35, s51, 5
    s_cmp_lt_u32 s2, 40
    s_cselect_b32 s34, s34, s35
    s_cselect_b32 s6, s6, 8
    s_cselect_b32 s15, s15, 4
    v_mad_u32_u24 v134, v2, s6, v4
    v_mad_u32_u24 v134, v3, s15, v134
    v_mad_u32_u24 v134, v134, s43, v172
    s_mul_i32 s15, s6, s43
    s_lshl_b32 s15, s15, 1
    s_mul_i32 s34, s34, s43
    s_lshl_b32 s35, s52, 7
    s_add_u32 s34, s34, s35
    s_and_b32 s35, s32, 1
    s_lshl_b32 s35, s35, 6
    s_add_u32 s6, s34, s35
    s_add_u32 s15, s15, s6
    s_and_b32 s34, s32, 1
    s_lshl_b32 s34, s34, 1
    s_lshl_b32 s35, s52, 2
    s_add_u32 s34, s34, s35
    s_add_u32 s34, s34, 0
    s_mul_hi_u32 s35, s34, s48
    s_mul_i32 s72, s35, s44
    s_sub_u32 s34, s34, s72
    s_cmp_eq_u32 s34, 0
    s_cselect_b32 s72, s44, s34
    s_sub_u32 s72, s72, 1
    s_bitcmp1_b32 s35, 0
    s_cselect_b32 s34, s72, s34
    s_mul_i32 s35, s35, s45
    s_add_u32 s35, s35, s51
    s_mul_i32 s35, s35, s44
    s_add_u32 s35, s35, s34
    s_lshl_b32 s35, s35, 10
    s_add_u32 s72, s35, s49
    s_lshr_b32 s34, s2, 1
    s_mul_i32 s34, s34, 7
    s_and_b32 s35, s2, 1
    s_lshl_b32 s35, s35, 1
    s_add_u32 s34, s34, s35
    s_lshl_b32 s34, s34, 10
    s_add_u32 s34, s34, 13228032
    s_cmp_lt_u32 s2, 40
    s_cselect_b32 s34, s34, 25165824
    s_cmp_eq_u32 s32, 2
    s_cselect_b32 s34, s34, 25165824
    s_cmp_eq_u32 s53, 0
    s_cselect_b32 s72, s72, s34
    s_and_b32 s34, s32, 1
    s_lshl_b32 s34, s34, 1
    s_lshl_b32 s35, s52, 2
    s_add_u32 s34, s34, s35
    s_add_u32 s34, s34, 1
    s_mul_hi_u32 s35, s34, s48
    s_mul_i32 s73, s35, s44
    s_sub_u32 s34, s34, s73
    s_cmp_eq_u32 s34, 0
    s_cselect_b32 s73, s44, s34
    s_sub_u32 s73, s73, 1
    s_bitcmp1_b32 s35, 0
    s_cselect_b32 s34, s73, s34
    s_mul_i32 s35, s35, s45
    s_add_u32 s35, s35, s51
    s_mul_i32 s35, s35, s44
    s_add_u32 s35, s35, s34
    s_lshl_b32 s35, s35, 10
    s_add_u32 s73, s35, s49
    s_lshr_b32 s34, s2, 1
    s_mul_i32 s34, s34, 7
    s_and_b32 s35, s2, 1
    s_lshl_b32 s35, s35, 1
    s_add_u32 s34, s34, s35
    s_lshl_b32 s34, s34, 10
    s_add_u32 s34, s34, 13229056
    s_cmp_lt_u32 s2, 40
    s_cselect_b32 s34, s34, 25165824
    s_cmp_eq_u32 s32, 2
    s_cselect_b32 s34, s34, 25165824
    s_cmp_eq_u32 s53, 0
    s_cselect_b32 s73, s73, s34
    s_cmp_eq_u32 s53, 0
    s_cselect_b32 s34, 0, 0x7f000000
    s_cselect_b32 s6, s6, 0
    s_cselect_b32 s15, s15, 0
    v_or_b32 v134, s34, v134
    v_lshrrev_b32 v2, 4, v1
    v_lshl_add_u32 v2, v2, 3, v4
    v_lshl_add_u32 v135, v2, 6, v172
    s_lshl_b32 s63, s32, 12
    s_add_u32 s63, s63, 65536
    v_add_u32 v135, s63, v135
    v_lshrrev_b32 v2, 4, v1
    v_lshlrev_b32 v2, 24, v2
    v_lshl_add_u32 v172, v1, 5, v2
    s_add_u32 m0, s60, 4096
    s_add_u32 s62, s54, 128
    buffer_load_dwordx4 v176, s[16:19], s62 offen offset:0 lds
    buffer_load_dwordx4 v177, s[16:19], s62 offen offset:1024 lds
    buffer_load_dwordx4 v178, s[16:19], s62 offen offset:2048 lds
    buffer_load_dwordx4 v179, s[16:19], s62 offen offset:3072 lds
    s_add_u32 m0, s61, 16384
    s_add_u32 s62, s55, 163840
    buffer_load_dwordx4 v180, s[76:79], s62 offen offset:0 lds
    buffer_load_dwordx4 v181, s[76:79], s62 offen offset:1024 lds
    buffer_load_dwordx4 v182, s[76:79], s62 offen offset:2048 lds
    buffer_load_dwordx4 v183, s[76:79], s62 offen offset:3072 lds
    s_add_u32 m0, s60, 32768
    s_add_u32 s62, s54, 256
    buffer_load_dwordx4 v176, s[16:19], s62 offen offset:0 lds
    buffer_load_dwordx4 v177, s[16:19], s62 offen offset:1024 lds
    v_and_b32 v2, 31, v1
    v_lshrrev_b32 v3, 5, v1
    v_cmp_lt_u32_e64 vcc, 31, v1
    v_mov_b32 v4, 832
    v_mad_u32_u24 v7, v3, 21, v2
    v_cndmask_b32_e64 v6, v5, v4, vcc
    v_mul_u32_u24 v8, 320, v2
    v_add_u32 v9, 151808, v8
    v_lshlrev_b32_e64 v4, 6, v2
    v_add_u32 v4, 161792, v4
    v_cndmask_b32_e64 v9, v9, v4, vcc
    v_lshl_add_u32 v8, v3, 7, v8
    v_add_u32 v8, 151552, v8
    v_lshlrev_b32_e64 v7, 4, v7
    v_add_u32 v7, 2560, v7
    v_cmp_lt_u32_e64 vcc, 20, v2
    v_mov_b32 v4, 0x7f000000
    v_lshrrev_b32 v2, 3, v1
    v_cndmask_b32 v7, v7, v4, vcc
    v_and_b32 v4, 7, v1
    v_lshlrev_b32 v10, 8, v2
    v_lshl_add_u32 v10, v4, 4, v10
    s_mul_i32 s34, s32, 2560
    s_add_u32 s34, s34, 151552
    v_mul_u32_u24 v249, 320, v2
    v_lshl_add_u32 v249, v4, 3, v249
    v_add_u32 v249, s34, v249
    v_lshlrev_b32 v250, 3, v0
    v_add_u32 v250, 161792, v250
    v_lshrrev_b32 v2, 2, v1
    v_and_b32 v4, 3, v1
    v_lshlrev_b32_e64 v251, 7, v2
    v_lshl_add_u32 v251, v4, 4, v251
    v_lshlrev_b32 v13, 8, v1
    v_lshrrev_b32 v14, 1, v1
    v_lshlrev_b32_e64 v14, 8, v14
    v_lshl_add_u32 v14, v3, 30, v14
    v_and_b32_e64 v2, 1, v1
    v_lshl_add_u32 v14, v2, 3, v14
    v_add_u32 v14, 16384, v14
    s_lshr_b32 s34, s3, 1
    s_and_b32 s36, s3, 1
    s_lshl_b32 s36, s36, 7
    s_mul_i32 s42, s34, 55296
    s_add_u32 s42, s42, s36
    s_lshl_b32 s40, s32, 1
    s_add_u32 s34, s40, 6
    s_and_b32 s34, s34, 7
    s_lshl_b32 s35, s34, 12
    s_lshl_b32 s34, s34, 3
    s_add_u32 s35, s35, 118528
    v_add_u32 v131, s34, v8
    v_add_u32 v255, s34, v9
    v_add_u32 v248, s35, v5
    s_lshl_b32 s34, s34, 1
    v_add_u32 v13, s34, v13
    v_add_u32_e64 v14, s34, v14
    s_add_u32 s34, s40, 4
    s_and_b32 s34, s34, 7
    s_lshl_b32 s35, s34, 12
    s_lshl_b32 s34, s34, 3
    s_add_u32 s35, s35, 118528
    v_add_u32 v130, s34, v8
    v_add_u32 v254, s34, v9
    v_add_u32_e64 v247, s35, v5
    s_add_u32 s34, s40, 2
    s_and_b32 s34, s34, 7
    s_lshl_b32 s35, s34, 12
    s_lshl_b32 s34, s34, 3
    s_add_u32 s35, s35, 118528
    v_add_u32 v11, s34, v8
    v_add_u32 v12, s34, v9
    v_add_u32_e64 v246, s35, v5
    s_add_u32 s34, s40, 0
    s_and_b32 s34, s34, 7
    s_lshl_b32 s35, s34, 12
    s_lshl_b32 s34, s34, 3
    s_add_u32 s35, s35, 118528
    v_add_u32 v8, s34, v8
    v_add_u32 v9, s34, v9
    v_add_u32_e64 v15, s35, v5
    s_waitcnt vmcnt(6)
    s_barrier
    ds_read_b128 v[184:187], v24 offset:0
    ds_read_b128 v[188:191], v24 offset:2048
    ds_read_b128 v[192:195], v25 offset:0
    ds_read_b128 v[196:199], v25 offset:2048
    ds_read_b64_tr_b16 v[68:69], v26 offset:0
    ds_read_b64_tr_b16 v[70:71], v26 offset:2048
    ds_read_b64_tr_b16 v[72:73], v27 offset:0
    ds_read_b64_tr_b16 v[74:75], v27 offset:2048
    ds_read_b64_tr_b16 v[76:77], v28 offset:0
    ds_read_b64_tr_b16 v[78:79], v28 offset:2048
    ds_read_b64_tr_b16 v[80:81], v29 offset:0
    ds_read_b64_tr_b16 v[82:83], v29 offset:2048
    ds_read_b64_tr_b16 v[84:85], v26 offset:4096
    ds_read_b64_tr_b16 v[86:87], v26 offset:6144
    s_waitcnt lgkmcnt(8)
    v_mfma_f32_16x16x32_bf16 v[32:35], v[68:71], v[184:187], 0
    ds_read_b128 v[200:203], v24 offset:4096
    buffer_load_dwordx4 v178, s[16:19], s62 offen offset:2048 lds
    buffer_load_dwordx4 v179, s[16:19], s62 offen offset:3072 lds
    ds_read_b64_tr_b16 v[88:89], v27 offset:4096
    v_mfma_f32_16x16x32_bf16 v[48:51], v[68:71], v[188:191], 0
    ds_read_b64_tr_b16 v[90:91], v27 offset:6144
    v_mfma_f32_16x16x32_bf16 v[64:67], v[68:71], v[168:171], 0
    s_waitcnt lgkmcnt(9)
    v_mfma_f32_16x16x32_bf16 v[36:39], v[72:75], v[184:187], 0
    ds_read_b128 v[204:207], v24 offset:6144
    s_add_u32 m0, s60, 36864
    s_add_u32 s62, s54, 384
    buffer_load_dwordx4 v176, s[16:19], s62 offen offset:0 lds
    buffer_load_dwordx4 v177, s[16:19], s62 offen offset:1024 lds
    ds_read_b64_tr_b16 v[68:69], v28 offset:4096
    v_mfma_f32_16x16x32_bf16 v[52:55], v[72:75], v[188:191], 0
    ds_read_b64_tr_b16 v[70:71], v28 offset:6144
    s_waitcnt lgkmcnt(10)
    v_mfma_f32_16x16x32_bf16 v[40:43], v[76:79], v[184:187], 0
    ds_read_b128 v[208:211], v25 offset:4096
    buffer_load_dwordx4 v178, s[16:19], s62 offen offset:2048 lds
    buffer_load_dwordx4 v179, s[16:19], s62 offen offset:3072 lds
    ds_read_b64_tr_b16 v[72:73], v29 offset:4096
    v_mfma_f32_16x16x32_bf16 v[56:59], v[76:79], v[188:191], 0
    ds_read_b64_tr_b16 v[74:75], v29 offset:6144
    s_waitcnt lgkmcnt(11)
    v_mfma_f32_16x16x32_bf16 v[44:47], v[80:83], v[184:187], 0
    ds_read_b128 v[212:215], v25 offset:6144
    s_add_u32 m0, s61, 32768
    s_add_u32 s62, s55, 327680
    buffer_load_dwordx4 v180, s[76:79], s62 offen offset:0 lds
    ds_read_b64_tr_b16 v[76:77], v26 offset:8192
    v_mfma_f32_16x16x32_bf16 v[60:63], v[80:83], v[188:191], 0
    ds_read_b64_tr_b16 v[78:79], v26 offset:10240
    s_waitcnt lgkmcnt(12)
    v_mfma_f32_16x16x32_bf16 v[32:35], v[84:87], v[192:195], v[32:35]
    buffer_load_dwordx4 v181, s[76:79], s62 offen offset:1024 lds
    ds_read_b64_tr_b16 v[80:81], v27 offset:8192
    v_mfma_f32_16x16x32_bf16 v[48:51], v[84:87], v[196:199], v[48:51]
    ds_read_b64_tr_b16 v[82:83], v27 offset:10240
    v_mfma_f32_16x16x32_bf16 v[64:67], v[84:87], v[168:171], v[64:67]
    s_waitcnt lgkmcnt(11)
    v_mfma_f32_16x16x32_bf16 v[36:39], v[88:91], v[192:195], v[36:39]
    buffer_load_dwordx4 v182, s[76:79], s62 offen offset:2048 lds
    ds_read_b64_tr_b16 v[84:85], v28 offset:8192
    v_mfma_f32_16x16x32_bf16 v[52:55], v[88:91], v[196:199], v[52:55]
    ds_read_b64_tr_b16 v[86:87], v28 offset:10240
    s_waitcnt lgkmcnt(10)
    v_mfma_f32_16x16x32_bf16 v[40:43], v[68:71], v[192:195], v[40:43]
    buffer_load_dwordx4 v183, s[76:79], s62 offen offset:3072 lds
    ds_read_b64_tr_b16 v[88:89], v29 offset:8192
    v_mfma_f32_16x16x32_bf16 v[56:59], v[68:71], v[196:199], v[56:59]
    ds_read_b64_tr_b16 v[90:91], v29 offset:10240
    s_waitcnt lgkmcnt(9)
    v_mfma_f32_16x16x32_bf16 v[44:47], v[72:75], v[192:195], v[44:47]
    ds_read_b64_tr_b16 v[68:69], v26 offset:12288
    v_mfma_f32_16x16x32_bf16 v[60:63], v[72:75], v[196:199], v[60:63]
    ds_read_b64_tr_b16 v[70:71], v26 offset:14336
    s_waitcnt lgkmcnt(8)
    v_mfma_f32_16x16x32_bf16 v[32:35], v[76:79], v[200:203], v[32:35]
    ds_read_b64_tr_b16 v[72:73], v27 offset:12288
    v_mfma_f32_16x16x32_bf16 v[48:51], v[76:79], v[204:207], v[48:51]
    ds_read_b64_tr_b16 v[74:75], v27 offset:14336
    v_mfma_f32_16x16x32_bf16 v[64:67], v[76:79], v[168:171], v[64:67]
    s_waitcnt lgkmcnt(8)
    v_mfma_f32_16x16x32_bf16 v[36:39], v[80:83], v[200:203], v[36:39]
    s_add_u32 m0, s60, 0
    s_add_u32 s62, s54, 512
    buffer_load_dwordx4 v176, s[16:19], s62 offen offset:0 lds
    ds_read_b64_tr_b16 v[76:77], v28 offset:12288
    v_mfma_f32_16x16x32_bf16 v[52:55], v[80:83], v[204:207], v[52:55]
    ds_read_b64_tr_b16 v[78:79], v28 offset:14336
    s_waitcnt lgkmcnt(8)
    v_mfma_f32_16x16x32_bf16 v[40:43], v[84:87], v[200:203], v[40:43]
    buffer_load_dwordx4 v177, s[16:19], s62 offen offset:1024 lds
    ds_read_b64_tr_b16 v[80:81], v29 offset:12288
    v_mfma_f32_16x16x32_bf16 v[56:59], v[84:87], v[204:207], v[56:59]
    ds_read_b64_tr_b16 v[82:83], v29 offset:14336
    s_waitcnt lgkmcnt(8)
    v_mfma_f32_16x16x32_bf16 v[44:47], v[88:91], v[200:203], v[44:47]
    buffer_load_dwordx4 v178, s[16:19], s62 offen offset:2048 lds
    s_waitcnt vmcnt(7)
    s_barrier
    ds_read_b64_tr_b16 v[84:85], v26 offset:16384
    v_mfma_f32_16x16x32_bf16 v[60:63], v[88:91], v[204:207], v[60:63]
    ds_read_b64_tr_b16 v[86:87], v26 offset:18432
    s_waitcnt lgkmcnt(8)
    v_mfma_f32_16x16x32_bf16 v[32:35], v[68:71], v[208:211], v[32:35]
    buffer_load_dwordx4 v179, s[16:19], s62 offen offset:3072 lds
    ds_read_b128 v[92:95], v24 offset:32768
    ds_read_b64_tr_b16 v[88:89], v27 offset:16384
    v_mfma_f32_16x16x32_bf16 v[48:51], v[68:71], v[212:215], v[48:51]
    ds_read_b64_tr_b16 v[90:91], v27 offset:18432
    v_mfma_f32_16x16x32_bf16 v[64:67], v[68:71], v[168:171], v[64:67]
    s_waitcnt lgkmcnt(9)
    v_mfma_f32_16x16x32_bf16 v[36:39], v[72:75], v[208:211], v[36:39]
    s_add_u32 m0, s60, 4096
    s_add_u32 s62, s54, 640
    buffer_load_dwordx4 v176, s[16:19], s62 offen offset:0 lds
    ds_read_b128 v[96:99], v24 offset:34816
    ds_read_b64_tr_b16 v[68:69], v28 offset:16384
    v_mfma_f32_16x16x32_bf16 v[52:55], v[72:75], v[212:215], v[52:55]
    ds_read_b64_tr_b16 v[70:71], v28 offset:18432
    s_waitcnt lgkmcnt(10)
    v_mfma_f32_16x16x32_bf16 v[40:43], v[76:79], v[208:211], v[40:43]
    buffer_load_dwordx4 v177, s[16:19], s62 offen offset:1024 lds
    ds_read_b128 v[100:103], v25 offset:32768
    ds_read_b64_tr_b16 v[72:73], v29 offset:16384
    v_mfma_f32_16x16x32_bf16 v[56:59], v[76:79], v[212:215], v[56:59]
    ds_read_b64_tr_b16 v[74:75], v29 offset:18432
    s_waitcnt lgkmcnt(11)
    v_mfma_f32_16x16x32_bf16 v[44:47], v[80:83], v[208:211], v[44:47]
    buffer_load_dwordx4 v178, s[16:19], s62 offen offset:2048 lds
    ds_read_b128 v[104:107], v25 offset:34816
    ds_read_b64_tr_b16 v[76:77], v26 offset:20480
    v_mfma_f32_16x16x32_bf16 v[60:63], v[80:83], v[212:215], v[60:63]
    ds_read_b64_tr_b16 v[78:79], v26 offset:22528
    s_waitcnt lgkmcnt(8)
    v_mfma_f32_16x16x32_bf16 v[32:35], v[84:87], v[92:95], v[32:35]
    buffer_load_dwordx4 v179, s[16:19], s62 offen offset:3072 lds
    ds_read_b128 v[108:111], v24 offset:36864
    ds_read_b64_tr_b16 v[80:81], v27 offset:20480
    v_mfma_f32_16x16x32_bf16 v[48:51], v[84:87], v[96:99], v[48:51]
    ds_read_b64_tr_b16 v[82:83], v27 offset:22528
    v_mfma_f32_16x16x32_bf16 v[64:67], v[84:87], v[168:171], v[64:67]
    v_mfma_f32_16x16x32_bf16 v[36:39], v[88:91], v[92:95], v[36:39]
    ds_read_b128 v[112:115], v24 offset:38912
    ds_read_b64_tr_b16 v[84:85], v28 offset:20480
    v_mfma_f32_16x16x32_bf16 v[52:55], v[88:91], v[96:99], v[52:55]
    ds_read_b64_tr_b16 v[86:87], v28 offset:22528
    s_waitcnt lgkmcnt(12)
    v_mfma_f32_16x16x32_bf16 v[40:43], v[68:71], v[92:95], v[40:43]
    ds_read_b128 v[116:119], v25 offset:36864
    ds_read_b64_tr_b16 v[88:89], v29 offset:20480
    v_mfma_f32_16x16x32_bf16 v[56:59], v[68:71], v[96:99], v[56:59]
    ds_read_b64_tr_b16 v[90:91], v29 offset:22528
    s_waitcnt lgkmcnt(12)
    v_mfma_f32_16x16x32_bf16 v[44:47], v[72:75], v[92:95], v[44:47]
    ds_read_b128 v[120:123], v25 offset:38912
    s_add_u32 m0, s61, 49152
    s_add_u32 s62, s55, 491520
    buffer_load_dwordx4 v180, s[76:79], s62 offen offset:0 lds
    ds_read_b64_tr_b16 v[68:69], v26 offset:24576
    v_mfma_f32_16x16x32_bf16 v[60:63], v[72:75], v[96:99], v[60:63]
    ds_read_b64_tr_b16 v[70:71], v26 offset:26624
    s_waitcnt lgkmcnt(12)
    v_mfma_f32_16x16x32_bf16 v[32:35], v[76:79], v[100:103], v[32:35]
    buffer_load_dwordx4 v181, s[76:79], s62 offen offset:1024 lds
    ds_read_b64_tr_b16 v[72:73], v27 offset:24576
    v_mfma_f32_16x16x32_bf16 v[48:51], v[76:79], v[104:107], v[48:51]
    ds_read_b64_tr_b16 v[74:75], v27 offset:26624
    v_mfma_f32_16x16x32_bf16 v[64:67], v[76:79], v[168:171], v[64:67]
    s_waitcnt lgkmcnt(11)
    v_mfma_f32_16x16x32_bf16 v[36:39], v[80:83], v[100:103], v[36:39]
    buffer_load_dwordx4 v182, s[76:79], s62 offen offset:2048 lds
    ds_read_b64_tr_b16 v[76:77], v28 offset:24576
    v_mfma_f32_16x16x32_bf16 v[52:55], v[80:83], v[104:107], v[52:55]
    ds_read_b64_tr_b16 v[78:79], v28 offset:26624
    s_waitcnt lgkmcnt(10)
    v_mfma_f32_16x16x32_bf16 v[40:43], v[84:87], v[100:103], v[40:43]
    buffer_load_dwordx4 v183, s[76:79], s62 offen offset:3072 lds
    ds_read_b64_tr_b16 v[80:81], v29 offset:24576
    v_mfma_f32_16x16x32_bf16 v[56:59], v[84:87], v[104:107], v[56:59]
    ds_read_b64_tr_b16 v[82:83], v29 offset:26624
    s_waitcnt lgkmcnt(9)
    v_mfma_f32_16x16x32_bf16 v[44:47], v[88:91], v[100:103], v[44:47]
    ds_read_b64_tr_b16 v[84:85], v26 offset:28672
    v_mfma_f32_16x16x32_bf16 v[60:63], v[88:91], v[104:107], v[60:63]
    ds_read_b64_tr_b16 v[86:87], v26 offset:30720
    s_waitcnt lgkmcnt(8)
    v_mfma_f32_16x16x32_bf16 v[32:35], v[68:71], v[108:111], v[32:35]
    ds_read_b64_tr_b16 v[88:89], v27 offset:28672
    v_mfma_f32_16x16x32_bf16 v[48:51], v[68:71], v[112:115], v[48:51]
    ds_read_b64_tr_b16 v[90:91], v27 offset:30720
    v_mfma_f32_16x16x32_bf16 v[64:67], v[68:71], v[168:171], v[64:67]
    s_waitcnt lgkmcnt(8)
    v_mfma_f32_16x16x32_bf16 v[36:39], v[72:75], v[108:111], v[36:39]
    s_add_u32 m0, s60, 32768
    s_add_u32 s62, s54, 768
    buffer_load_dwordx4 v176, s[16:19], s62 offen offset:0 lds
    ds_read_b64_tr_b16 v[68:69], v28 offset:28672
    v_mfma_f32_16x16x32_bf16 v[52:55], v[72:75], v[112:115], v[52:55]
    ds_read_b64_tr_b16 v[70:71], v28 offset:30720
    s_waitcnt lgkmcnt(8)
    v_mfma_f32_16x16x32_bf16 v[40:43], v[76:79], v[108:111], v[40:43]
    buffer_load_dwordx4 v177, s[16:19], s62 offen offset:1024 lds
    ds_read_b64_tr_b16 v[72:73], v29 offset:28672
    v_mfma_f32_16x16x32_bf16 v[56:59], v[76:79], v[112:115], v[56:59]
    ds_read_b64_tr_b16 v[74:75], v29 offset:30720
    s_waitcnt lgkmcnt(8)
    v_mfma_f32_16x16x32_bf16 v[44:47], v[80:83], v[108:111], v[44:47]
    buffer_load_dwordx4 v178, s[16:19], s62 offen offset:2048 lds
    s_waitcnt vmcnt(7)
    s_barrier
    ds_read_b64_tr_b16 v[76:77], v26 offset:32768
    v_mfma_f32_16x16x32_bf16 v[60:63], v[80:83], v[112:115], v[60:63]
    ds_read_b64_tr_b16 v[78:79], v26 offset:34816
    s_waitcnt lgkmcnt(8)
    v_mfma_f32_16x16x32_bf16 v[32:35], v[84:87], v[116:119], v[32:35]
    buffer_load_dwordx4 v179, s[16:19], s62 offen offset:3072 lds
    ds_read_b128 v[184:187], v24 offset:0
    ds_read_b64_tr_b16 v[80:81], v27 offset:32768
    v_mfma_f32_16x16x32_bf16 v[48:51], v[84:87], v[120:123], v[48:51]
    ds_read_b64_tr_b16 v[82:83], v27 offset:34816
    v_mfma_f32_16x16x32_bf16 v[64:67], v[84:87], v[168:171], v[64:67]
    s_waitcnt lgkmcnt(9)
    v_mfma_f32_16x16x32_bf16 v[36:39], v[88:91], v[116:119], v[36:39]
    s_add_u32 m0, s60, 36864
    s_add_u32 s62, s54, 896
    buffer_load_dwordx4 v176, s[16:19], s62 offen offset:0 lds
    ds_read_b128 v[188:191], v24 offset:2048
    ds_read_b64_tr_b16 v[84:85], v28 offset:32768
    v_mfma_f32_16x16x32_bf16 v[52:55], v[88:91], v[120:123], v[52:55]
    ds_read_b64_tr_b16 v[86:87], v28 offset:34816
    s_waitcnt lgkmcnt(10)
    v_mfma_f32_16x16x32_bf16 v[40:43], v[68:71], v[116:119], v[40:43]
    buffer_load_dwordx4 v177, s[16:19], s62 offen offset:1024 lds
    ds_read_b128 v[192:195], v25 offset:0
    ds_read_b64_tr_b16 v[88:89], v29 offset:32768
    v_mfma_f32_16x16x32_bf16 v[56:59], v[68:71], v[120:123], v[56:59]
    ds_read_b64_tr_b16 v[90:91], v29 offset:34816
    s_waitcnt lgkmcnt(11)
    v_mfma_f32_16x16x32_bf16 v[44:47], v[72:75], v[116:119], v[44:47]
    buffer_load_dwordx4 v178, s[16:19], s62 offen offset:2048 lds
    ds_read_b128 v[196:199], v25 offset:2048
    ds_read_b64_tr_b16 v[68:69], v26 offset:36864
    v_mfma_f32_16x16x32_bf16 v[60:63], v[72:75], v[120:123], v[60:63]
    ds_read_b64_tr_b16 v[70:71], v26 offset:38912
    s_waitcnt lgkmcnt(8)
    v_mfma_f32_16x16x32_bf16 v[32:35], v[76:79], v[184:187], v[32:35]
    buffer_load_dwordx4 v179, s[16:19], s62 offen offset:3072 lds
    ds_read_b128 v[200:203], v24 offset:4096
    ds_read_b64_tr_b16 v[72:73], v27 offset:36864
    v_mfma_f32_16x16x32_bf16 v[48:51], v[76:79], v[188:191], v[48:51]
    ds_read_b64_tr_b16 v[74:75], v27 offset:38912
    v_mfma_f32_16x16x32_bf16 v[64:67], v[76:79], v[168:171], v[64:67]
    v_mfma_f32_16x16x32_bf16 v[36:39], v[80:83], v[184:187], v[36:39]
    ds_read_b128 v[204:207], v24 offset:6144
    ds_read_b64_tr_b16 v[76:77], v28 offset:36864
    v_mfma_f32_16x16x32_bf16 v[52:55], v[80:83], v[188:191], v[52:55]
    ds_read_b64_tr_b16 v[78:79], v28 offset:38912
    s_waitcnt lgkmcnt(12)
    v_mfma_f32_16x16x32_bf16 v[40:43], v[84:87], v[184:187], v[40:43]
    ds_read_b128 v[208:211], v25 offset:4096
    ds_read_b64_tr_b16 v[80:81], v29 offset:36864
    v_mfma_f32_16x16x32_bf16 v[56:59], v[84:87], v[188:191], v[56:59]
    ds_read_b64_tr_b16 v[82:83], v29 offset:38912
    s_waitcnt lgkmcnt(12)
    v_mfma_f32_16x16x32_bf16 v[44:47], v[88:91], v[184:187], v[44:47]
    ds_read_b128 v[212:215], v25 offset:6144
    s_add_u32 m0, s61, 65536
    s_add_u32 s62, s55, 655360
    buffer_load_dwordx4 v180, s[76:79], s62 offen offset:0 lds
    ds_read_b64_tr_b16 v[84:85], v26 offset:40960
    v_mfma_f32_16x16x32_bf16 v[60:63], v[88:91], v[188:191], v[60:63]
    ds_read_b64_tr_b16 v[86:87], v26 offset:43008
    s_waitcnt lgkmcnt(12)
    v_mfma_f32_16x16x32_bf16 v[32:35], v[68:71], v[192:195], v[32:35]
    buffer_load_dwordx4 v181, s[76:79], s62 offen offset:1024 lds
    ds_read_b64_tr_b16 v[88:89], v27 offset:40960
    v_mfma_f32_16x16x32_bf16 v[48:51], v[68:71], v[196:199], v[48:51]
    ds_read_b64_tr_b16 v[90:91], v27 offset:43008
    v_mfma_f32_16x16x32_bf16 v[64:67], v[68:71], v[168:171], v[64:67]
    s_waitcnt lgkmcnt(11)
    v_mfma_f32_16x16x32_bf16 v[36:39], v[72:75], v[192:195], v[36:39]
    buffer_load_dwordx4 v182, s[76:79], s62 offen offset:2048 lds
    ds_read_b64_tr_b16 v[68:69], v28 offset:40960
    v_mfma_f32_16x16x32_bf16 v[52:55], v[72:75], v[196:199], v[52:55]
    ds_read_b64_tr_b16 v[70:71], v28 offset:43008
    s_waitcnt lgkmcnt(10)
    v_mfma_f32_16x16x32_bf16 v[40:43], v[76:79], v[192:195], v[40:43]
    buffer_load_dwordx4 v183, s[76:79], s62 offen offset:3072 lds
    ds_read_b64_tr_b16 v[72:73], v29 offset:40960
    v_mfma_f32_16x16x32_bf16 v[56:59], v[76:79], v[196:199], v[56:59]
    ds_read_b64_tr_b16 v[74:75], v29 offset:43008
    s_waitcnt lgkmcnt(9)
    v_mfma_f32_16x16x32_bf16 v[44:47], v[80:83], v[192:195], v[44:47]
    ds_read_b64_tr_b16 v[76:77], v26 offset:45056
    v_mfma_f32_16x16x32_bf16 v[60:63], v[80:83], v[196:199], v[60:63]
    ds_read_b64_tr_b16 v[78:79], v26 offset:47104
    s_waitcnt lgkmcnt(8)
    v_mfma_f32_16x16x32_bf16 v[32:35], v[84:87], v[200:203], v[32:35]
    ds_read_b64_tr_b16 v[80:81], v27 offset:45056
    v_mfma_f32_16x16x32_bf16 v[48:51], v[84:87], v[204:207], v[48:51]
    ds_read_b64_tr_b16 v[82:83], v27 offset:47104
    v_mfma_f32_16x16x32_bf16 v[64:67], v[84:87], v[168:171], v[64:67]
    s_waitcnt lgkmcnt(8)
    v_mfma_f32_16x16x32_bf16 v[36:39], v[88:91], v[200:203], v[36:39]
    s_add_u32 m0, s60, 0
    s_add_u32 s62, s54, 1024
    buffer_load_dwordx4 v176, s[16:19], s62 offen offset:0 lds
    ds_read_b64_tr_b16 v[84:85], v28 offset:45056
    v_mfma_f32_16x16x32_bf16 v[52:55], v[88:91], v[204:207], v[52:55]
    ds_read_b64_tr_b16 v[86:87], v28 offset:47104
    s_waitcnt lgkmcnt(8)
    v_mfma_f32_16x16x32_bf16 v[40:43], v[68:71], v[200:203], v[40:43]
    buffer_load_dwordx4 v177, s[16:19], s62 offen offset:1024 lds
    ds_read_b64_tr_b16 v[88:89], v29 offset:45056
    v_mfma_f32_16x16x32_bf16 v[56:59], v[68:71], v[204:207], v[56:59]
    ds_read_b64_tr_b16 v[90:91], v29 offset:47104
    s_waitcnt lgkmcnt(8)
    v_mfma_f32_16x16x32_bf16 v[44:47], v[72:75], v[200:203], v[44:47]
    buffer_load_dwordx4 v178, s[16:19], s62 offen offset:2048 lds
    s_waitcnt vmcnt(7)
    s_barrier
    ds_read_b64_tr_b16 v[68:69], v26 offset:49152
    v_mfma_f32_16x16x32_bf16 v[60:63], v[72:75], v[204:207], v[60:63]
    ds_read_b64_tr_b16 v[70:71], v26 offset:51200
    s_waitcnt lgkmcnt(8)
    v_mfma_f32_16x16x32_bf16 v[32:35], v[76:79], v[208:211], v[32:35]
    buffer_load_dwordx4 v179, s[16:19], s62 offen offset:3072 lds
    ds_read_b128 v[92:95], v24 offset:32768
    ds_read_b64_tr_b16 v[72:73], v27 offset:49152
    v_mfma_f32_16x16x32_bf16 v[48:51], v[76:79], v[212:215], v[48:51]
    ds_read_b64_tr_b16 v[74:75], v27 offset:51200
    v_mfma_f32_16x16x32_bf16 v[64:67], v[76:79], v[168:171], v[64:67]
    s_waitcnt lgkmcnt(9)
    v_mfma_f32_16x16x32_bf16 v[36:39], v[80:83], v[208:211], v[36:39]
    s_add_u32 m0, s60, 4096
    s_add_u32 s62, s54, 1152
    buffer_load_dwordx4 v176, s[16:19], s62 offen offset:0 lds
    ds_read_b128 v[96:99], v24 offset:34816
    ds_read_b64_tr_b16 v[76:77], v28 offset:49152
    v_mfma_f32_16x16x32_bf16 v[52:55], v[80:83], v[212:215], v[52:55]
    ds_read_b64_tr_b16 v[78:79], v28 offset:51200
    s_waitcnt lgkmcnt(10)
    v_mfma_f32_16x16x32_bf16 v[40:43], v[84:87], v[208:211], v[40:43]
    buffer_load_dwordx4 v177, s[16:19], s62 offen offset:1024 lds
    ds_read_b128 v[100:103], v25 offset:32768
    ds_read_b64_tr_b16 v[80:81], v29 offset:49152
    v_mfma_f32_16x16x32_bf16 v[56:59], v[84:87], v[212:215], v[56:59]
    ds_read_b64_tr_b16 v[82:83], v29 offset:51200
    s_waitcnt lgkmcnt(11)
    v_mfma_f32_16x16x32_bf16 v[44:47], v[88:91], v[208:211], v[44:47]
    buffer_load_dwordx4 v178, s[16:19], s62 offen offset:2048 lds
    ds_read_b128 v[104:107], v25 offset:34816
    ds_read_b64_tr_b16 v[84:85], v26 offset:53248
    v_mfma_f32_16x16x32_bf16 v[60:63], v[88:91], v[212:215], v[60:63]
    ds_read_b64_tr_b16 v[86:87], v26 offset:55296
    s_waitcnt lgkmcnt(8)
    v_mfma_f32_16x16x32_bf16 v[32:35], v[68:71], v[92:95], v[32:35]
    buffer_load_dwordx4 v179, s[16:19], s62 offen offset:3072 lds
    ds_read_b128 v[108:111], v24 offset:36864
    ds_read_b64_tr_b16 v[88:89], v27 offset:53248
    v_mfma_f32_16x16x32_bf16 v[48:51], v[68:71], v[96:99], v[48:51]
    ds_read_b64_tr_b16 v[90:91], v27 offset:55296
    v_mfma_f32_16x16x32_bf16 v[64:67], v[68:71], v[168:171], v[64:67]
    v_mfma_f32_16x16x32_bf16 v[36:39], v[72:75], v[92:95], v[36:39]
    ds_read_b128 v[112:115], v24 offset:38912
    ds_read_b64_tr_b16 v[68:69], v28 offset:53248
    v_mfma_f32_16x16x32_bf16 v[52:55], v[72:75], v[96:99], v[52:55]
    ds_read_b64_tr_b16 v[70:71], v28 offset:55296
    s_waitcnt lgkmcnt(12)
    v_mfma_f32_16x16x32_bf16 v[40:43], v[76:79], v[92:95], v[40:43]
    ds_read_b128 v[116:119], v25 offset:36864
    v_lshlrev_b32_e64 v21, 4, v1
    v_and_b32 v21, 0xf0, v21
    global_load_dwordx2 v[22:23], v21, s[80:81] sc1
    v_and_b32 v175, 15, v1
    v_xor_b32 v175, s58, v175
    v_min_u32 v175, 2, v175
    v_lshlrev_b32 v175, 3, v175
    v_lshrrev_b32 v175, v175, v174
    v_and_b32 v175, 0x11, v175
    v_lshlrev_b32_e64 v175, 20, v175
    ds_read_b64_tr_b16 v[72:73], v29 offset:53248
    v_mfma_f32_16x16x32_bf16 v[56:59], v[76:79], v[96:99], v[56:59]
    ds_read_b64_tr_b16 v[74:75], v29 offset:55296
    s_waitcnt lgkmcnt(12)
    v_mfma_f32_16x16x32_bf16 v[44:47], v[80:83], v[92:95], v[44:47]
    ds_read_b128 v[120:123], v25 offset:38912
    ds_read_b64_tr_b16 v[76:77], v26 offset:57344
    v_mfma_f32_16x16x32_bf16 v[60:63], v[80:83], v[96:99], v[60:63]
    ds_read_b64_tr_b16 v[78:79], v26 offset:59392
    s_waitcnt lgkmcnt(12)
    v_mfma_f32_16x16x32_bf16 v[32:35], v[84:87], v[100:103], v[32:35]
    ds_read_b64_tr_b16 v[80:81], v27 offset:57344
    v_mfma_f32_16x16x32_bf16 v[48:51], v[84:87], v[104:107], v[48:51]
    ds_read_b64_tr_b16 v[82:83], v27 offset:59392
    v_mfma_f32_16x16x32_bf16 v[64:67], v[84:87], v[168:171], v[64:67]
    s_waitcnt lgkmcnt(11)
    v_mfma_f32_16x16x32_bf16 v[36:39], v[88:91], v[100:103], v[36:39]
    ds_read_b64_tr_b16 v[84:85], v28 offset:57344
    v_mfma_f32_16x16x32_bf16 v[52:55], v[88:91], v[104:107], v[52:55]
    ds_read_b64_tr_b16 v[86:87], v28 offset:59392
    s_waitcnt lgkmcnt(10)
    v_mfma_f32_16x16x32_bf16 v[40:43], v[68:71], v[100:103], v[40:43]
    ds_read_b64_tr_b16 v[88:89], v29 offset:57344
    v_mfma_f32_16x16x32_bf16 v[56:59], v[68:71], v[104:107], v[56:59]
    ds_read_b64_tr_b16 v[90:91], v29 offset:59392
    s_waitcnt lgkmcnt(9)
    v_mfma_f32_16x16x32_bf16 v[44:47], v[72:75], v[100:103], v[44:47]
    ds_read_b64_tr_b16 v[68:69], v26 offset:61440
    v_mfma_f32_16x16x32_bf16 v[60:63], v[72:75], v[104:107], v[60:63]
    ds_read_b64_tr_b16 v[70:71], v26 offset:63488
    s_waitcnt lgkmcnt(8)
    v_mfma_f32_16x16x32_bf16 v[32:35], v[76:79], v[108:111], v[32:35]
    ds_read_b64_tr_b16 v[72:73], v27 offset:61440
    v_mfma_f32_16x16x32_bf16 v[48:51], v[76:79], v[112:115], v[48:51]
    ds_read_b64_tr_b16 v[74:75], v27 offset:63488
    v_mfma_f32_16x16x32_bf16 v[64:67], v[76:79], v[168:171], v[64:67]
    s_waitcnt lgkmcnt(8)
    v_mfma_f32_16x16x32_bf16 v[36:39], v[80:83], v[108:111], v[36:39]
    ds_read_b64_tr_b16 v[76:77], v28 offset:61440
    v_mfma_f32_16x16x32_bf16 v[52:55], v[80:83], v[112:115], v[52:55]
    ds_read_b64_tr_b16 v[78:79], v28 offset:63488
    s_waitcnt lgkmcnt(8)
    v_mfma_f32_16x16x32_bf16 v[40:43], v[84:87], v[108:111], v[40:43]
    ds_read_b64_tr_b16 v[80:81], v29 offset:61440
    v_mfma_f32_16x16x32_bf16 v[56:59], v[84:87], v[112:115], v[56:59]
    ds_read_b64_tr_b16 v[82:83], v29 offset:63488
    s_waitcnt lgkmcnt(8)
    v_mfma_f32_16x16x32_bf16 v[44:47], v[88:91], v[108:111], v[44:47]
    s_waitcnt vmcnt(1)
    s_barrier
    ds_read_b128 v[184:187], v24 offset:0
    ds_read_b128 v[188:191], v24 offset:2048
    s_waitcnt vmcnt(0)
    v_and_b32_e64 v173, v23, v175
    v_cmp_ne_u32 vcc, v173, v175
    s_cbranch_vccnz BT_7w
BT_7r:
    v_readlane_b32 s34, v22, s58
    v_readlane_b32 s35, v23, s58
    s_nop 3
    s_lshr_b64 s[34:35], s[34:35], s57
    s_and_b32 s34, s34, 31
    s_cmp_eq_u32 s34, 16
    s_cselect_b32 s57, 1, 2
    ds_read_b64_tr_b16 v[84:85], v124 offset:0
    v_mfma_f32_16x16x32_bf16 v[60:63], v[88:91], v[112:115], v[60:63]
    ds_read_b64_tr_b16 v[86:87], v124 offset:2048
    s_waitcnt lgkmcnt(10)
    v_mfma_f32_16x16x32_bf16 v[32:35], v[68:71], v[116:119], v[32:35]
    ds_read_b128 v[192:195], v25 offset:0
    ds_read_b128 v[196:199], v25 offset:2048
    s_lshl_b32 s34, s32, 1
    s_add_u32 s34, s34, 40
    v_and_or_b32 v17, v1, 1, s34
    ds_read_b64_tr_b16 v[88:89], v124 offset:4096
    v_mfma_f32_16x16x32_bf16 v[48:51], v[68:71], v[120:123], v[48:51]
    ds_read_b64_tr_b16 v[90:91], v124 offset:6144
    v_mfma_f32_16x16x32_bf16 v[64:67], v[68:71], v[168:171], v[64:67]
    s_waitcnt lgkmcnt(12)
    v_mfma_f32_16x16x32_bf16 v[36:39], v[72:75], v[116:119], v[36:39]
    ds_read_b128 v[200:203], v24 offset:4096
    s_lshl_b32 s62, s58, 2
    s_add_u32 s62, s62, s32
    s_lshl_b32 s36, s62, 8
    s_add_u32 s36, s36, 7274496
    ds_read_b64_tr_b16 v[68:69], v124 offset:8192
    v_mfma_f32_16x16x32_bf16 v[52:55], v[72:75], v[120:123], v[52:55]
    ds_read_b64_tr_b16 v[70:71], v124 offset:10240
    s_waitcnt lgkmcnt(13)
    v_mfma_f32_16x16x32_bf16 v[40:43], v[76:79], v[116:119], v[40:43]
    ds_read_b128 v[204:207], v24 offset:6144
    ds_read_b128 v[208:211], v25 offset:4096
    v_and_b32 v4, 15, v1
    v_lshlrev_b32 v4, 3, v4
    s_waitcnt lgkmcnt(13)
    ds_read_b64_tr_b16 v[72:73], v124 offset:12288
    v_mfma_f32_16x16x32_bf16 v[56:59], v[76:79], v[120:123], v[56:59]
    ds_read_b64_tr_b16 v[74:75], v124 offset:14336
    v_mfma_f32_16x16x32_bf16 v[44:47], v[80:83], v[116:119], v[44:47]
    s_waitcnt lgkmcnt(13)
    ds_read_b128 v[212:215], v25 offset:6144
    ds_read_b64_tr_b16 v[76:77], v125 offset:0
    v_mfma_f32_16x16x32_bf16 v[60:63], v[80:83], v[120:123], v[60:63]
    s_waitcnt lgkmcnt(13)
    ds_read_b64_tr_b16 v[78:79], v125 offset:2048
    v_mfma_f32_16x16x32_bf16 v[32:35], v[84:87], v[184:187], v[32:35]
    buffer_load_ubyte v156, v17, s[28:31], s56 offen sc1
    ds_read_b64_tr_b16 v[80:81], v125 offset:4096
    v_mfma_f32_16x16x32_bf16 v[48:51], v[84:87], v[188:191], v[48:51]
    s_waitcnt lgkmcnt(13)
    ds_read_b64_tr_b16 v[82:83], v125 offset:6144
    v_mfma_f32_16x16x32_bf16 v[64:67], v[84:87], v[168:171], v[64:67]
    s_waitcnt lgkmcnt(12)
    v_mfma_f32_16x16x32_bf16 v[32:35], v[88:91], v[192:195], v[32:35]
    ds_read_b64_tr_b16 v[84:85], v125 offset:8192
    v_mfma_f32_16x16x32_bf16 v[48:51], v[88:91], v[196:199], v[48:51]
    ds_read_b64_tr_b16 v[86:87], v125 offset:10240
    v_mfma_f32_16x16x32_bf16 v[64:67], v[88:91], v[168:171], v[64:67]
    s_waitcnt lgkmcnt(10)
    v_mfma_f32_16x16x32_bf16 v[32:35], v[68:71], v[200:203], v[32:35]
    ds_read_b64_tr_b16 v[88:89], v125 offset:12288
    v_mfma_f32_16x16x32_bf16 v[48:51], v[68:71], v[204:207], v[48:51]
    ds_read_b64_tr_b16 v[90:91], v125 offset:14336
    v_mfma_f32_16x16x32_bf16 v[64:67], v[68:71], v[168:171], v[64:67]
    s_waitcnt lgkmcnt(8)
    v_mfma_f32_16x16x32_bf16 v[32:35], v[72:75], v[208:211], v[32:35]
    ds_read_b64_tr_b16 v[68:69], v126 offset:0
    v_mfma_f32_16x16x32_bf16 v[48:51], v[72:75], v[212:215], v[48:51]
    ds_read_b64_tr_b16 v[70:71], v126 offset:2048
    v_mfma_f32_16x16x32_bf16 v[64:67], v[72:75], v[168:171], v[64:67]
    s_waitcnt lgkmcnt(8)
    v_mfma_f32_16x16x32_bf16 v[36:39], v[76:79], v[184:187], v[36:39]
    ds_read_b64_tr_b16 v[72:73], v126 offset:4096
    v_mfma_f32_16x16x32_bf16 v[52:55], v[76:79], v[188:191], v[52:55]
    ds_read_b64_tr_b16 v[74:75], v126 offset:6144
    s_waitcnt lgkmcnt(8)
    v_mfma_f32_16x16x32_bf16 v[36:39], v[80:83], v[192:195], v[36:39]
    ds_read_b64_tr_b16 v[76:77], v126 offset:8192
    v_mfma_f32_16x16x32_bf16 v[52:55], v[80:83], v[196:199], v[52:55]
    ds_read_b64_tr_b16 v[78:79], v126 offset:10240
    s_waitcnt lgkmcnt(8)
    v_mfma_f32_16x16x32_bf16 v[36:39], v[84:87], v[200:203], v[36:39]
    ds_write_b128 v129, v[64:67]
    ds_read_b64_tr_b16 v[80:81], v126 offset:12288
    v_mfma_f32_16x16x32_bf16 v[52:55], v[84:87], v[204:207], v[52:55]
    ds_read_b64_tr_b16 v[82:83], v126 offset:14336
    s_waitcnt lgkmcnt(9)
    v_mfma_f32_16x16x32_bf16 v[36:39], v[88:91], v[208:211], v[36:39]
    ds_read_b64_tr_b16 v[84:85], v127 offset:0
    v_mfma_f32_16x16x32_bf16 v[52:55], v[88:91], v[212:215], v[52:55]
    ds_read_b64_tr_b16 v[86:87], v127 offset:2048
    s_waitcnt lgkmcnt(9)
    v_mfma_f32_16x16x32_bf16 v[40:43], v[68:71], v[184:187], v[40:43]
    s_waitcnt vmcnt(0)
    v_cmp_ne_u32 vcc, 1, v156
    s_cbranch_vccz SQ_8
    s_mov_b32 s60, 0x100000
PL_9:
    buffer_load_ubyte v2, v17, s[28:31], s56 offen offset:0 sc1
    s_sub_u32 s60, s60, 1
    s_nop 0
    s_cbranch_scc1 PL_9x
    s_waitcnt vmcnt(0)
    v_cmp_eq_u32 vcc, 0, v2
    s_cbranch_vccnz PL_9
    v_cmp_ne_u32 vcc, 1, v2
    s_cbranch_vccnz PL_9a
PL_9x:
SQ_8:
    buffer_load_dwordx2 v[152:153], v4, s[28:31], s36 offen sc1
    buffer_load_dwordx2 v[154:155], v4, s[28:31], s36 offen offset:128 sc1
    ds_read_b64_tr_b16 v[88:89], v127 offset:4096
    v_mfma_f32_16x16x32_bf16 v[56:59], v[68:71], v[188:191], v[56:59]
    ds_read_b64_tr_b16 v[90:91], v127 offset:6144
    s_waitcnt lgkmcnt(9)
    v_mfma_f32_16x16x32_bf16 v[40:43], v[72:75], v[192:195], v[40:43]
    ds_read_b64_tr_b16 v[68:69], v127 offset:8192
    v_mfma_f32_16x16x32_bf16 v[56:59], v[72:75], v[196:199], v[56:59]
    ds_read_b64_tr_b16 v[70:71], v127 offset:10240
    s_waitcnt lgkmcnt(9)
    v_mfma_f32_16x16x32_bf16 v[40:43], v[76:79], v[200:203], v[40:43]
    ds_read_b64_tr_b16 v[72:73], v127 offset:12288
    v_mfma_f32_16x16x32_bf16 v[56:59], v[76:79], v[204:207], v[56:59]
    ds_read_b64_tr_b16 v[74:75], v127 offset:14336
    s_waitcnt lgkmcnt(8)
    v_mfma_f32_16x16x32_bf16 v[40:43], v[80:83], v[208:211], v[40:43]
    s_waitcnt lgkmcnt(0)
    s_barrier
    v_mfma_f32_16x16x32_bf16 v[56:59], v[80:83], v[212:215], v[56:59]
    v_mfma_f32_16x16x32_bf16 v[44:47], v[84:87], v[184:187], v[44:47]
    s_lshl_b32 s34, s24, 6
    v_add_u32_e64 v2, s34, v128
    ds_read_b128 v[136:139], v2
    v_mfma_f32_16x16x32_bf16 v[60:63], v[84:87], v[188:191], v[60:63]
    v_mfma_f32_16x16x32_bf16 v[44:47], v[88:91], v[192:195], v[44:47]
    s_lshl_b32 s34, s25, 6
    v_add_u32 v2, s34, v128
    ds_read_b128 v[140:143], v2
    v_mfma_f32_16x16x32_bf16 v[60:63], v[88:91], v[196:199], v[60:63]
    v_mfma_f32_16x16x32_bf16 v[44:47], v[68:71], v[200:203], v[44:47]
    s_lshl_b32 s34, s26, 6
    v_add_u32 v2, s34, v128
    ds_read_b128 v[144:147], v2
    v_mfma_f32_16x16x32_bf16 v[60:63], v[68:71], v[204:207], v[60:63]
    v_mfma_f32_16x16x32_bf16 v[44:47], v[72:75], v[208:211], v[44:47]
    s_lshl_b32 s34, s27, 6
    v_add_u32 v2, s34, v128
    ds_read_b128 v[148:151], v2
    v_mfma_f32_16x16x32_bf16 v[60:63], v[72:75], v[212:215], v[60:63]
    s_mul_i32 s62, s62, 110592
    s_lshl_b32 s34, s41, 11
    s_add_u32 s62, s62, s34
    v_lshlrev_b32 v4, 3, v1
    s_waitcnt vmcnt(0)
    v_mul_f32 v153, 0x3ea52b5c, v153
    v_mul_f32 v155, 0x3ea52b5c, v155
    s_waitcnt lgkmcnt(0)
    s_lshl_b32 s34, s24, 9
    s_add_u32 s34, s34, s62
    s_add_u32 s35, s34, 55296
    v_pk_fma_f32 v[32:33], v[136:137], v[152:153], v[32:33] op_sel_hi:[1,0,1] neg_lo:[0,1,0] neg_hi:[0,1,0]
    v_pk_fma_f32 v[34:35], v[138:139], v[152:153], v[34:35] op_sel_hi:[1,0,1] neg_lo:[0,1,0] neg_hi:[0,1,0]
    v_pk_fma_f32 v[48:49], v[136:137], v[154:155], v[48:49] op_sel_hi:[1,0,1] neg_lo:[0,1,0] neg_hi:[0,1,0]
    v_pk_fma_f32 v[50:51], v[138:139], v[154:155], v[50:51] op_sel_hi:[1,0,1] neg_lo:[0,1,0] neg_hi:[0,1,0]
    v_pk_mul_f32 v[32:33], v[32:33], v[152:153] op_sel:[0,1] op_sel_hi:[1,1]
    v_pk_mul_f32 v[34:35], v[34:35], v[152:153] op_sel:[0,1] op_sel_hi:[1,1]
    v_pk_mul_f32 v[48:49], v[48:49], v[154:155] op_sel:[0,1] op_sel_hi:[1,1]
    v_pk_mul_f32 v[50:51], v[50:51], v[154:155] op_sel:[0,1] op_sel_hi:[1,1]
    v_cvt_pk_bf16_f32 v92, v32, v33
    v_cvt_pk_bf16_f32 v93, v34, v35
    buffer_store_dwordx2 v[92:93], v4, s[28:31], s34 offen
    v_cvt_pk_bf16_f32 v94, v48, v49
    v_cvt_pk_bf16_f32 v95, v50, v51
    buffer_store_dwordx2 v[94:95], v4, s[28:31], s35 offen
    s_lshl_b32 s34, s25, 9
    s_add_u32 s34, s34, s62
    s_add_u32 s35, s34, 55296
    v_pk_fma_f32 v[36:37], v[140:141], v[152:153], v[36:37] op_sel_hi:[1,0,1] neg_lo:[0,1,0] neg_hi:[0,1,0]
    v_pk_fma_f32 v[38:39], v[142:143], v[152:153], v[38:39] op_sel_hi:[1,0,1] neg_lo:[0,1,0] neg_hi:[0,1,0]
    v_pk_fma_f32 v[52:53], v[140:141], v[154:155], v[52:53] op_sel_hi:[1,0,1] neg_lo:[0,1,0] neg_hi:[0,1,0]
    v_pk_fma_f32 v[54:55], v[142:143], v[154:155], v[54:55] op_sel_hi:[1,0,1] neg_lo:[0,1,0] neg_hi:[0,1,0]
    v_pk_mul_f32 v[36:37], v[36:37], v[152:153] op_sel:[0,1] op_sel_hi:[1,1]
    v_pk_mul_f32 v[38:39], v[38:39], v[152:153] op_sel:[0,1] op_sel_hi:[1,1]
    v_pk_mul_f32 v[52:53], v[52:53], v[154:155] op_sel:[0,1] op_sel_hi:[1,1]
    v_pk_mul_f32 v[54:55], v[54:55], v[154:155] op_sel:[0,1] op_sel_hi:[1,1]
    v_cvt_pk_bf16_f32 v96, v36, v37
    v_cvt_pk_bf16_f32 v97, v38, v39
    buffer_store_dwordx2 v[96:97], v4, s[28:31], s34 offen
    v_cvt_pk_bf16_f32 v98, v52, v53
    v_cvt_pk_bf16_f32 v99, v54, v55
    buffer_store_dwordx2 v[98:99], v4, s[28:31], s35 offen
    s_lshl_b32 s34, s26, 9
    s_add_u32 s34, s34, s62
    s_add_u32 s35, s34, 55296
    v_pk_fma_f32 v[40:41], v[144:145], v[152:153], v[40:41] op_sel_hi:[1,0,1] neg_lo:[0,1,0] neg_hi:[0,1,0]
    v_pk_fma_f32 v[42:43], v[146:147], v[152:153], v[42:43] op_sel_hi:[1,0,1] neg_lo:[0,1,0] neg_hi:[0,1,0]
    v_pk_fma_f32 v[56:57], v[144:145], v[154:155], v[56:57] op_sel_hi:[1,0,1] neg_lo:[0,1,0] neg_hi:[0,1,0]
    v_pk_fma_f32 v[58:59], v[146:147], v[154:155], v[58:59] op_sel_hi:[1,0,1] neg_lo:[0,1,0] neg_hi:[0,1,0]
    v_pk_mul_f32 v[40:41], v[40:41], v[152:153] op_sel:[0,1] op_sel_hi:[1,1]
    v_pk_mul_f32 v[42:43], v[42:43], v[152:153] op_sel:[0,1] op_sel_hi:[1,1]
    v_pk_mul_f32 v[56:57], v[56:57], v[154:155] op_sel:[0,1] op_sel_hi:[1,1]
    v_pk_mul_f32 v[58:59], v[58:59], v[154:155] op_sel:[0,1] op_sel_hi:[1,1]
    v_cvt_pk_bf16_f32 v100, v40, v41
    v_cvt_pk_bf16_f32 v101, v42, v43
    buffer_store_dwordx2 v[100:101], v4, s[28:31], s34 offen
    v_cvt_pk_bf16_f32 v102, v56, v57
    v_cvt_pk_bf16_f32 v103, v58, v59
    buffer_store_dwordx2 v[102:103], v4, s[28:31], s35 offen
    s_lshl_b32 s34, s27, 9
    s_add_u32 s34, s34, s62
    s_add_u32 s35, s34, 55296
    v_pk_fma_f32 v[44:45], v[148:149], v[152:153], v[44:45] op_sel_hi:[1,0,1] neg_lo:[0,1,0] neg_hi:[0,1,0]
    v_pk_fma_f32 v[46:47], v[150:151], v[152:153], v[46:47] op_sel_hi:[1,0,1] neg_lo:[0,1,0] neg_hi:[0,1,0]
    v_pk_fma_f32 v[60:61], v[148:149], v[154:155], v[60:61] op_sel_hi:[1,0,1] neg_lo:[0,1,0] neg_hi:[0,1,0]
    v_pk_fma_f32 v[62:63], v[150:151], v[154:155], v[62:63] op_sel_hi:[1,0,1] neg_lo:[0,1,0] neg_hi:[0,1,0]
    v_pk_mul_f32 v[44:45], v[44:45], v[152:153] op_sel:[0,1] op_sel_hi:[1,1]
    v_pk_mul_f32 v[46:47], v[46:47], v[152:153] op_sel:[0,1] op_sel_hi:[1,1]
    v_pk_mul_f32 v[60:61], v[60:61], v[154:155] op_sel:[0,1] op_sel_hi:[1,1]
    v_pk_mul_f32 v[62:63], v[62:63], v[154:155] op_sel:[0,1] op_sel_hi:[1,1]
    v_cvt_pk_bf16_f32 v104, v44, v45
    v_cvt_pk_bf16_f32 v105, v46, v47
    buffer_store_dwordx2 v[104:105], v4, s[28:31], s34 offen
    v_cvt_pk_bf16_f32 v106, v60, v61
    v_cvt_pk_bf16_f32 v107, v62, v63
    buffer_store_dwordx2 v[106:107], v4, s[28:31], s35 offen
P1_JOIN:
    s_cmp_lt_u32 s41, 10
    s_cbranch_scc0 KV_NS
    v_mov_b32 v2, s57
    v_lshlrev_b32 v3, 24, v1
    s_cmp_eq_u32 s57, 1
    s_waitcnt vmcnt(0)
    s_cbranch_scc0 K2_SS1
    buffer_store_byte v2, v3, s[28:31], s59 offen offset:0
K2_SR1:
    s_barrier
KV_NS:
    s_and_b32 s62, s2, 7
    s_lshl_b32 s62, s62, 9
    s_add_u32 s62, s62, 7299200
    v_and_b32 v26, 31, v1
    v_lshlrev_b32 v26, 2, v26
    s_mov_b32 s24, s10
    s_and_b32 s25, s11, 0xffff
    s_mov_b32 s26, 0x280000
    s_mov_b32 s27, 0x20000
    s_and_b32 s43, s33, 7
    s_lshr_b32 s44, s3, 3
    s_lshl_b32 s44, s44, 2
    s_and_b32 s48, s33, 15
    s_lshr_b32 s49, s3, 4
    s_lshl_b32 s49, s49, 2
    s_add_u32 s49, s49, s32
    s_lshl_b32 s49, s49, 1
    s_lshl_b32 s54, s32, 10
    s_mul_i32 s53, s48, 143360
    s_add_u32 s53, s53, 11075584
    s_mul_i32 s55, s43, 54
    s_mul_i32 s34, s32, 14
    s_add_u32 s55, s55, s34
    s_mul_i32 s55, s55, 5120
    s_add_u32 s55, s55, 13369344
    s_mul_i32 s34, s43, 5
    s_add_u32 s45, s34, 1
    s_lshr_b32 s45, s45, 1
    s_lshr_b32 s46, s34, 1
    s_add_u32 s34, s46, 2
    s_and_b32 s47, s43, 1
    s_cselect_b32 s46, s46, s34
    s_mul_i32 s34, s48, 7
    s_add_u32 s50, s34, 1
    s_lshr_b32 s50, s50, 1
    s_lshr_b32 s51, s34, 1
    s_add_u32 s34, s51, 3
    s_and_b32 s52, s48, 1
    s_cselect_b32 s51, s51, s34
    v_lshlrev_b32_e64 v112, 6, v1
    v_min_u32 v113, 3068, v112
    v_lshlrev_b32 v117, 24, v1
    v_mov_b32 v241, 1
    v_and_b32_e64 v114, 15, v1
    v_mul_u32_u24 v114, 1280, v114
    v_and_or_b32 v114, v1, 48, v114
    v_lshlrev_b32 v16, 5, v1
    s_lshl_b32 s34, s50, 1
    s_lshl_b32 s35, s51, 1
    s_add_u32 s35, s35, s52
    v_lshrrev_b32 v2, 4, v0
    v_cmp_lt_u32 vcc, 5, v2
    v_add_u32 v2, s34, v2
    v_mov_b32 v3, s35
    v_cndmask_b32 v2, v2, v3, vcc
    v_and_b32 v3, 1, v2
    v_lshrrev_b32 v2, 1, v2
    v_lshlrev_b32 v2, 6, v2
    v_lshl_add_u32 v2, v3, 3, v2
    v_and_b32_e64 v3, 12, v0
    v_lshl_add_u32 v2, v3, 2, v2
    v_and_b32_e64 v3, 3, v0
    v_lshl_add_u32 v115, v3, 1, v2
    v_min_u32 v116, 111, v0
    v_lshlrev_b32 v116, 5, v116
    v_and_b32 v118, 15, v1
    v_lshlrev_b32_e64 v118, 8, v118
    v_add_u32 v118, 7299072, v118
    v_lshlrev_b32_e64 v245, 5, v0
    v_min_u32 v119, 448, v112
    s_lshl_b32 s39, s32, 3
    s_add_u32 s39, s39, s33
    s_add_u32 s37, s39, 0
    s_and_b32 s37, s37, 31
    s_mul_i32 s37, s37, 5248
    s_add_u32 s37, s37, 7077888
    s_add_u32 s38, s39, 1
    s_and_b32 s38, s38, 31
    s_mul_i32 s38, s38, 5248
    s_add_u32 s38, s38, 7077888
    s_add_u32 s76, s39, 2
    s_and_b32 s76, s76, 31
    s_mul_i32 s76, s76, 5248
    s_add_u32 s76, s76, 7077888
    s_add_u32 s77, s39, 3
    s_and_b32 s77, s77, 31
    s_mul_i32 s77, s77, 5248
    s_add_u32 s77, s77, 7077888
    s_add_u32 s78, s39, 4
    s_and_b32 s78, s78, 31
    s_mul_i32 s78, s78, 5248
    s_add_u32 s78, s78, 7077888
    s_add_u32 s79, s39, 5
    s_and_b32 s79, s79, 31
    s_mul_i32 s79, s79, 5248
    s_add_u32 s79, s79, 7077888
    s_add_u32 s80, s39, 6
    s_and_b32 s80, s80, 31
    s_mul_i32 s80, s80, 5248
    s_add_u32 s80, s80, 7077888
    s_add_u32 s81, s39, 7
    s_and_b32 s81, s81, 31
    s_mul_i32 s81, s81, 5248
    s_add_u32 s81, s81, 7077888
    v_min_u32 v17, 9, v1
    s_lshr_b32 s36, s41, 2
    v_lshl_add_u32 v17, v17, 2, s36
    s_and_b32 s36, s3, 1
    s_lshl_b32 s36, s36, 6
    s_sub_u32 s60, s42, s36
    s_mul_i32 s36, s32, 5120
    s_add_u32 s60, s60, s36
    s_mul_i32 s36, s32, 2560
    s_add_u32 m0, s36, 151552
    v_mov_b32 v28, 0
    v_mov_b32 v31, 0
    s_mov_b32 s34, 0x42200000
    s_lshl_b32 s35, s32, 2
    s_add_u32 s35, s35, 151296
    v_mov_b32 v3, s35
    v_mov_b32_e64 v4, -1
    ds_write_b32 v15, v4 offset:3072
    ds_write_b32 v15, v4 offset:7168
    v_mov_b32 v4, 151296
    s_mov_b32 s61, 0x100000
PL_10:
    buffer_load_ubyte v2, v17, s[28:31], s56 offen offset:0 sc1
    s_sub_u32 s61, s61, 1
    s_cbranch_scc1 PL_10x
    s_waitcnt vmcnt(0)
    v_cmp_eq_u32 vcc, 0, v2
    s_cbranch_vccnz PL_10
    v_cmp_ne_u32 vcc, 1, v2
    s_cbranch_vccnz PL_10a
PL_10x:
    buffer_load_dword v24, v26, s[28:31], s62 offen sc1
    buffer_load_dwordx4 v251, s[28:31], s60 offen sc1 lds
    s_addk_i32 m0, 1024
    s_add_u32 s60, s60, 2048
    buffer_load_dwordx4 v251, s[28:31], s60 offen sc1 lds
    s_addk_i32 m0, 1024
    s_add_u32 s60, s60, 2048
    s_mov_b32 exec_hi, 0
    buffer_load_dwordx4 v251, s[28:31], s60 offen sc1 lds
    s_mov_b64 exec, -1
    s_waitcnt vmcnt(3)
    v_cmp_eq_u32 vcc, 0, v24
    s_cbranch_vccnz KV_SL
KV_PY:
    buffer_load_dwordx4 a[0:3], v5, s[28:31], s37 offen sc1
    buffer_load_dwordx4 a[64:67], v6, s[28:31], s37 offen offset:2048 sc1
    buffer_load_dwordx4 a[4:7], v5, s[28:31], s37 offen offset:1024 sc1
    s_waitcnt vmcnt(3)
    ds_read_b64 v[32:33], v249 offset:0
    ds_read_b64 v[34:35], v249 offset:64
    ds_read_b64 v[36:37], v249 offset:128
    ds_read_b64 v[38:39], v249 offset:192
    ds_read_b64 v[40:41], v249 offset:256
    v_max_f32_dpp v24, v24, v24 row_ror:8 row_mask:0xf bank_mask:0xf
    buffer_load_dwordx4 a[96:99], v7, s[28:31], s37 offen offset:0 sc1
    s_nop 0
    v_max_f32_dpp v24, v24, v24 row_ror:4 row_mask:0xf bank_mask:0xf
    buffer_load_dwordx4 a[100:103], v7, s[28:31], s37 offen offset:672 sc1
    s_nop 0
    v_max_f32_dpp v24, v24, v24 row_ror:2 row_mask:0xf bank_mask:0xf
    buffer_load_dwordx4 a[104:107], v7, s[28:31], s37 offen offset:1344 sc1
    s_nop 0
    v_max_f32_dpp v24, v24, v24 row_ror:1 row_mask:0xf bank_mask:0xf
    buffer_load_dwordx4 a[108:111], v7, s[28:31], s37 offen offset:2016 sc1
    v_mov_b32 v25, v24
    v_mov_b32 v29, 0
    s_waitcnt lgkmcnt(0)
    v_permlane16_swap_b32 v24, v25
    v_dot2c_f32_bf16 v28, v32, v32
    v_dot2c_f32_bf16 v29, v33, v33
    v_dot2c_f32_bf16 v28, v34, v34
    v_dot2c_f32_bf16 v29, v35, v35
    v_dot2c_f32_bf16 v28, v36, v36
    v_dot2c_f32_bf16 v29, v37, v37
    v_dot2c_f32_bf16 v28, v38, v38
    v_dot2c_f32_bf16 v29, v39, v39
    v_dot2c_f32_bf16 v28, v40, v40
    v_dot2c_f32_bf16 v29, v41, v41
    v_max_f32 v24, v24, v25
    s_nop 1
    v_add_f32 v28, v28, v29
    v_mul_f32 v28, v28, v24
    v_sqrt_f32 v28, v28
    s_nop 0
    v_add_u32 v30, 0x1ffff, v28
    v_cmp_nge_f32 vcc, s34, v28
    v_lshrrev_b32 v30, 16, v30
    v_or_b32 v30, 0x8000, v30
    ds_write_b64 v250, v[30:31]
    s_or_b32 s34, vcc_lo, vcc_hi
    v_mov_b32 v29, s34
    ds_write_b32 v3, v29
    buffer_load_dwordx4 a[8:11], v5, s[28:31], s38 offen sc1
    buffer_load_dwordx4 a[68:71], v6, s[28:31], s38 offen offset:2048 sc1
    buffer_load_dwordx4 a[12:15], v5, s[28:31], s38 offen offset:1024 sc1
    s_waitcnt lgkmcnt(0)
    s_barrier
    ds_read2_b64 v[18:21], v8 offset0:0 offset1:8
    ds_read_b64 v[22:23], v9
    ds_read_b128 v[28:31], v4
    s_waitcnt lgkmcnt(0)
    v_or3_b32 v28, v28, v29, v30
    v_or_b32 v28, v28, v31
    v_cmp_ne_u32_e64 vcc, 0, v28
    s_cbranch_vccnz K2_FALLBACK
    s_waitcnt vmcnt(8)
    v_mfma_f32_32x32x16_bf16 v[32:47], a[0:3], v[18:21], 0
    v_mfma_f32_32x32x8_bf16 v[32:47], a[64:65], v[22:23], v[32:47]
    buffer_load_dwordx4 a[112:115], v7, s[28:31], s38 offen offset:0 sc1
    buffer_load_dwordx4 a[116:119], v7, s[28:31], s38 offen offset:672 sc1
    buffer_load_dwordx4 a[120:123], v7, s[28:31], s38 offen offset:1344 sc1
    buffer_load_dwordx4 a[124:127], v7, s[28:31], s38 offen offset:2016 sc1
    buffer_load_dwordx4 a[16:19], v5, s[28:31], s76 offen sc1
    s_nop 6
    v_exp_f32 v32, v32
    v_exp_f32 v33, v33
    v_exp_f32 v34, v34
    v_exp_f32 v35, v35
    s_waitcnt vmcnt(12)
    v_mfma_f32_32x32x16_bf16 v[48:63], a[4:7], v[18:21], 0
    buffer_load_dwordx4 a[72:75], v6, s[28:31], s76 offen offset:2048 sc1
    v_cvt_pk_bf16_f32 v64, v32, v33
    v_cvt_pk_bf16_f32 v65, v34, v35
    v_exp_f32 v36, v36
    v_exp_f32 v37, v37
    v_exp_f32 v38, v38
    v_exp_f32 v39, v39
    v_mfma_f32_32x32x8_bf16 v[48:63], a[66:67], v[22:23], v[48:63]
    buffer_load_dwordx4 a[20:23], v5, s[28:31], s76 offen offset:1024 sc1
    v_cvt_pk_bf16_f32 v66, v36, v37
    v_cvt_pk_bf16_f32 v67, v38, v39
    v_exp_f32 v40, v40
    v_exp_f32 v41, v41
    v_exp_f32 v42, v42
    v_exp_f32 v43, v43
    buffer_load_dwordx4 a[128:131], v7, s[28:31], s76 offen offset:0 sc1
    v_cvt_pk_bf16_f32 v68, v40, v41
    v_cvt_pk_bf16_f32 v69, v42, v43
    v_exp_f32 v44, v44
    v_exp_f32 v45, v45
    v_exp_f32_e64 v46, v46
    v_exp_f32 v47, v47
    s_waitcnt vmcnt(11)
    v_mfma_f32_32x32x16_bf16 v[80:95], a[96:99], v[64:67], 0
    buffer_load_dwordx4 a[132:135], v7, s[28:31], s76 offen offset:672 sc1
    v_cvt_pk_bf16_f32 v70, v44, v45
    v_cvt_pk_bf16_f32 v71, v46, v47
    v_exp_f32 v48, v48
    v_exp_f32 v49, v49
    v_exp_f32_e64 v50, v50
    v_exp_f32 v51, v51
    s_waitcnt vmcnt(9)
    v_mfma_f32_32x32x16_bf16 v[32:47], a[8:11], v[18:21], 0
    buffer_load_dwordx4 a[136:139], v7, s[28:31], s76 offen offset:1344 sc1
    v_cvt_pk_bf16_f32 v72, v48, v49
    v_cvt_pk_bf16_f32 v73, v50, v51
    v_exp_f32 v52, v52
    v_exp_f32 v53, v53
    v_exp_f32 v54, v54
    v_exp_f32 v55, v55
    v_mfma_f32_32x32x8_bf16 v[32:47], a[68:69], v[22:23], v[32:47]
    buffer_load_dwordx4 a[140:143], v7, s[28:31], s76 offen offset:2016 sc1
    v_cvt_pk_bf16_f32 v74, v52, v53
    v_cvt_pk_bf16_f32 v75, v54, v55
    v_exp_f32 v56, v56
    v_exp_f32 v57, v57
    v_exp_f32 v58, v58
    v_exp_f32 v59, v59
    v_mfma_f32_32x32x16_bf16 v[80:95], a[100:103], v[68:71], v[80:95]
    buffer_load_dwordx4 a[24:27], v5, s[28:31], s77 offen sc1
    v_cvt_pk_bf16_f32 v76, v56, v57
    v_cvt_pk_bf16_f32 v77, v58, v59
    v_exp_f32 v60, v60
    v_exp_f32 v61, v61
    v_exp_f32 v62, v62
    v_exp_f32 v63, v63
    v_mfma_f32_32x32x16_bf16 v[80:95], a[104:107], v[72:75], v[80:95]
    buffer_load_dwordx4 a[76:79], v6, s[28:31], s77 offen offset:2048 sc1
    v_cvt_pk_bf16_f32 v78, v60, v61
    v_cvt_pk_bf16_f32 v79, v62, v63
    v_exp_f32 v32, v32
    v_exp_f32 v33, v33
    v_exp_f32 v34, v34
    v_exp_f32 v35, v35
    v_mfma_f32_32x32x16_bf16 v[48:63], a[12:15], v[18:21], 0
    buffer_load_dwordx4 a[28:31], v5, s[28:31], s77 offen offset:1024 sc1
    v_cvt_pk_bf16_f32 v64, v32, v33
    v_cvt_pk_bf16_f32 v65, v34, v35
    v_exp_f32 v36, v36
    v_exp_f32 v37, v37
    v_exp_f32 v38, v38
    v_exp_f32 v39, v39
    v_mfma_f32_32x32x8_bf16 v[48:63], a[70:71], v[22:23], v[48:63]
    buffer_load_dwordx4 a[144:147], v7, s[28:31], s77 offen offset:0 sc1
    v_cvt_pk_bf16_f32 v66, v36, v37
    v_cvt_pk_bf16_f32 v67, v38, v39
    v_exp_f32 v40, v40
    v_exp_f32 v41, v41
    v_exp_f32 v42, v42
    v_exp_f32 v43, v43
    v_mfma_f32_32x32x16_bf16 v[80:95], a[108:111], v[76:79], v[80:95]
    buffer_load_dwordx4 a[148:151], v7, s[28:31], s77 offen offset:672 sc1
    v_cvt_pk_bf16_f32 v68, v40, v41
    v_cvt_pk_bf16_f32 v69, v42, v43
    v_exp_f32 v44, v44
    v_exp_f32 v45, v45
    v_exp_f32_e64 v46, v46
    v_exp_f32 v47, v47
    s_waitcnt vmcnt(12)
    v_mfma_f32_32x32x16_bf16 v[80:95], a[112:115], v[64:67], v[80:95]
    buffer_load_dwordx4 a[152:155], v7, s[28:31], s77 offen offset:1344 sc1
    v_cvt_pk_bf16_f32 v70, v44, v45
    v_cvt_pk_bf16_f32 v71, v46, v47
    v_exp_f32 v48, v48
    v_exp_f32 v49, v49
    v_exp_f32_e64 v50, v50
    v_exp_f32 v51, v51
    s_waitcnt vmcnt(10)
    v_mfma_f32_32x32x16_bf16 v[32:47], a[16:19], v[18:21], 0
    buffer_load_dwordx4 a[156:159], v7, s[28:31], s77 offen offset:2016 sc1
    v_cvt_pk_bf16_f32 v72, v48, v49
    v_cvt_pk_bf16_f32 v73, v50, v51
    v_exp_f32 v52, v52
    v_exp_f32 v53, v53
    v_exp_f32 v54, v54
    v_exp_f32 v55, v55
    v_mfma_f32_32x32x8_bf16 v[32:47], a[72:73], v[22:23], v[32:47]
    buffer_load_dwordx4 a[32:35], v5, s[28:31], s78 offen sc1
    v_cvt_pk_bf16_f32 v74, v52, v53
    v_cvt_pk_bf16_f32 v75, v54, v55
    v_exp_f32 v56, v56
    v_exp_f32 v57, v57
    v_exp_f32 v58, v58
    v_exp_f32 v59, v59
    v_mfma_f32_32x32x16_bf16 v[80:95], a[116:119], v[68:71], v[80:95]
    buffer_load_dwordx4 a[80:83], v6, s[28:31], s78 offen offset:2048 sc1
    v_cvt_pk_bf16_f32 v76, v56, v57
    v_cvt_pk_bf16_f32 v77, v58, v59
    v_exp_f32 v60, v60
    v_exp_f32 v61, v61
    v_exp_f32 v62, v62
    v_exp_f32 v63, v63
    v_mfma_f32_32x32x16_bf16 v[80:95], a[120:123], v[72:75], v[80:95]
    buffer_load_dwordx4 a[36:39], v5, s[28:31], s78 offen offset:1024 sc1
    v_cvt_pk_bf16_f32 v78, v60, v61
    v_cvt_pk_bf16_f32 v79, v62, v63
    v_exp_f32 v32, v32
    v_exp_f32 v33, v33
    v_exp_f32 v34, v34
    v_exp_f32 v35, v35
    v_mfma_f32_32x32x16_bf16 v[48:63], a[20:23], v[18:21], 0
    buffer_load_dwordx4 a[160:163], v7, s[28:31], s78 offen offset:0 sc1
    v_cvt_pk_bf16_f32 v64, v32, v33
    v_cvt_pk_bf16_f32 v65, v34, v35
    v_exp_f32 v36, v36
    v_exp_f32 v37, v37
    v_exp_f32 v38, v38
    v_exp_f32 v39, v39
    v_mfma_f32_32x32x8_bf16 v[48:63], a[74:75], v[22:23], v[48:63]
    buffer_load_dwordx4 a[164:167], v7, s[28:31], s78 offen offset:672 sc1
    v_cvt_pk_bf16_f32 v66, v36, v37
    v_cvt_pk_bf16_f32 v67, v38, v39
    v_exp_f32 v40, v40
    v_exp_f32 v41, v41
    v_exp_f32 v42, v42
    v_exp_f32 v43, v43
    v_mfma_f32_32x32x16_bf16 v[80:95], a[124:127], v[76:79], v[80:95]
    buffer_load_dwordx4 a[168:171], v7, s[28:31], s78 offen offset:1344 sc1
    v_cvt_pk_bf16_f32 v68, v40, v41
    v_cvt_pk_bf16_f32 v69, v42, v43
    v_exp_f32 v44, v44
    v_exp_f32 v45, v45
    v_exp_f32_e64 v46, v46
    v_exp_f32 v47, v47
    s_waitcnt vmcnt(13)
    v_mfma_f32_32x32x16_bf16 v[80:95], a[128:131], v[64:67], v[80:95]
    buffer_load_dwordx4 a[172:175], v7, s[28:31], s78 offen offset:2016 sc1
    v_cvt_pk_bf16_f32 v70, v44, v45
    v_cvt_pk_bf16_f32 v71, v46, v47
    v_exp_f32 v48, v48
    v_exp_f32 v49, v49
    v_exp_f32_e64 v50, v50
    v_exp_f32 v51, v51
    s_waitcnt vmcnt(11)
    v_mfma_f32_32x32x16_bf16 v[32:47], a[24:27], v[18:21], 0
    buffer_load_dwordx4 a[40:43], v5, s[28:31], s79 offen sc1
    v_cvt_pk_bf16_f32 v72, v48, v49
    v_cvt_pk_bf16_f32 v73, v50, v51
    v_exp_f32 v52, v52
    v_exp_f32 v53, v53
    v_exp_f32 v54, v54
    v_exp_f32 v55, v55
    v_mfma_f32_32x32x8_bf16 v[32:47], a[76:77], v[22:23], v[32:47]
    buffer_load_dwordx4 a[84:87], v6, s[28:31], s79 offen offset:2048 sc1
    v_cvt_pk_bf16_f32 v74, v52, v53
    v_cvt_pk_bf16_f32 v75, v54, v55
    v_exp_f32 v56, v56
    v_exp_f32 v57, v57
    v_exp_f32 v58, v58
    v_exp_f32 v59, v59
    v_mfma_f32_32x32x16_bf16 v[80:95], a[132:135], v[68:71], v[80:95]
    buffer_load_dwordx4 a[44:47], v5, s[28:31], s79 offen offset:1024 sc1
    v_cvt_pk_bf16_f32 v76, v56, v57
    v_cvt_pk_bf16_f32 v77, v58, v59
    v_exp_f32 v60, v60
    v_exp_f32 v61, v61
    v_exp_f32 v62, v62
    v_exp_f32 v63, v63
    v_mfma_f32_32x32x16_bf16 v[80:95], a[136:139], v[72:75], v[80:95]
    buffer_load_dwordx4 a[176:179], v7, s[28:31], s79 offen offset:0 sc1
    v_cvt_pk_bf16_f32 v78, v60, v61
    v_cvt_pk_bf16_f32 v79, v62, v63
    v_exp_f32 v32, v32
    v_exp_f32 v33, v33
    v_exp_f32 v34, v34
    v_exp_f32 v35, v35
    v_mfma_f32_32x32x16_bf16 v[48:63], a[28:31], v[18:21], 0
    buffer_load_dwordx4 a[180:183], v7, s[28:31], s79 offen offset:672 sc1
    v_cvt_pk_bf16_f32 v64, v32, v33
    v_cvt_pk_bf16_f32 v65, v34, v35
    v_exp_f32 v36, v36
    v_exp_f32 v37, v37
    v_exp_f32 v38, v38
    v_exp_f32 v39, v39
    v_mfma_f32_32x32x8_bf16 v[48:63], a[78:79], v[22:23], v[48:63]
    buffer_load_dwordx4 a[184:187], v7, s[28:31], s79 offen offset:1344 sc1
    v_cvt_pk_bf16_f32 v66, v36, v37
    v_cvt_pk_bf16_f32 v67, v38, v39
    v_exp_f32 v40, v40
    v_exp_f32 v41, v41
    v_exp_f32 v42, v42
    v_exp_f32 v43, v43
    v_mfma_f32_32x32x16_bf16 v[80:95], a[140:143], v[76:79], v[80:95]
    buffer_load_dwordx4 a[188:191], v7, s[28:31], s79 offen offset:2016 sc1
    v_cvt_pk_bf16_f32 v68, v40, v41
    v_cvt_pk_bf16_f32 v69, v42, v43
    v_exp_f32 v44, v44
    v_exp_f32 v45, v45
    v_exp_f32_e64 v46, v46
    v_exp_f32 v47, v47
    s_waitcnt vmcnt(14)
    v_mfma_f32_32x32x16_bf16 v[80:95], a[144:147], v[64:67], v[80:95]
    buffer_load_dwordx4 a[48:51], v5, s[28:31], s80 offen sc1
    v_cvt_pk_bf16_f32 v70, v44, v45
    v_cvt_pk_bf16_f32 v71, v46, v47
    v_exp_f32 v48, v48
    v_exp_f32 v49, v49
    v_exp_f32_e64 v50, v50
    v_exp_f32 v51, v51
    s_waitcnt vmcnt(12)
    v_mfma_f32_32x32x16_bf16 v[32:47], a[32:35], v[18:21], 0
    buffer_load_dwordx4 a[88:91], v6, s[28:31], s80 offen offset:2048 sc1
    v_cvt_pk_bf16_f32 v72, v48, v49
    v_cvt_pk_bf16_f32 v73, v50, v51
    v_exp_f32 v52, v52
    v_exp_f32 v53, v53
    v_exp_f32 v54, v54
    v_exp_f32 v55, v55
    v_mfma_f32_32x32x8_bf16 v[32:47], a[80:81], v[22:23], v[32:47]
    buffer_load_dwordx4 a[52:55], v5, s[28:31], s80 offen offset:1024 sc1
    v_cvt_pk_bf16_f32 v74, v52, v53
    v_cvt_pk_bf16_f32 v75, v54, v55
    v_exp_f32 v56, v56
    v_exp_f32 v57, v57
    v_exp_f32 v58, v58
    v_exp_f32 v59, v59
    v_mfma_f32_32x32x16_bf16 v[80:95], a[148:151], v[68:71], v[80:95]
    buffer_load_dwordx4 a[192:195], v7, s[28:31], s80 offen offset:0 sc1
    v_cvt_pk_bf16_f32 v76, v56, v57
    v_cvt_pk_bf16_f32 v77, v58, v59
    v_exp_f32 v60, v60
    v_exp_f32 v61, v61
    v_exp_f32 v62, v62
    v_exp_f32 v63, v63
    v_mfma_f32_32x32x16_bf16 v[80:95], a[152:155], v[72:75], v[80:95]
    buffer_load_dwordx4 a[196:199], v7, s[28:31], s80 offen offset:672 sc1
    v_cvt_pk_bf16_f32 v78, v60, v61
    v_cvt_pk_bf16_f32 v79, v62, v63
    v_exp_f32 v32, v32
    v_exp_f32 v33, v33
    v_exp_f32 v34, v34
    v_exp_f32 v35, v35
    v_mfma_f32_32x32x16_bf16 v[48:63], a[36:39], v[18:21], 0
    buffer_load_dwordx4 a[200:203], v7, s[28:31], s80 offen offset:1344 sc1
    v_cvt_pk_bf16_f32 v64, v32, v33
    v_cvt_pk_bf16_f32 v65, v34, v35
    v_exp_f32 v36, v36
    v_exp_f32 v37, v37
    v_exp_f32 v38, v38
    v_exp_f32 v39, v39
    v_mfma_f32_32x32x8_bf16 v[48:63], a[82:83], v[22:23], v[48:63]
    buffer_load_dwordx4 a[204:207], v7, s[28:31], s80 offen offset:2016 sc1
    v_cvt_pk_bf16_f32 v66, v36, v37
    v_cvt_pk_bf16_f32 v67, v38, v39
    v_exp_f32 v40, v40
    v_exp_f32 v41, v41
    v_exp_f32 v42, v42
    v_exp_f32 v43, v43
    v_mfma_f32_32x32x16_bf16 v[80:95], a[156:159], v[76:79], v[80:95]
    buffer_load_dwordx4 a[56:59], v5, s[28:31], s81 offen sc1
    v_cvt_pk_bf16_f32 v68, v40, v41
    v_cvt_pk_bf16_f32 v69, v42, v43
    v_exp_f32 v44, v44
    v_exp_f32 v45, v45
    v_exp_f32_e64 v46, v46
    v_exp_f32 v47, v47
    s_waitcnt vmcnt(15)
    v_mfma_f32_32x32x16_bf16 v[96:111], a[160:163], v[64:67], v[80:95]
    buffer_load_dwordx4 a[92:95], v6, s[28:31], s81 offen offset:2048 sc1
    v_cvt_pk_bf16_f32 v70, v44, v45
    v_cvt_pk_bf16_f32 v71, v46, v47
    v_exp_f32 v48, v48
    v_exp_f32 v49, v49
    v_exp_f32_e64 v50, v50
    v_exp_f32 v51, v51
    s_waitcnt vmcnt(13)
    v_mfma_f32_32x32x16_bf16 v[32:47], a[40:43], v[18:21], 0
    buffer_load_dwordx4 a[60:63], v5, s[28:31], s81 offen offset:1024 sc1
    v_cvt_pk_bf16_f32 v72, v48, v49
    v_cvt_pk_bf16_f32 v73, v50, v51
    v_exp_f32 v52, v52
    v_exp_f32 v53, v53
    v_exp_f32 v54, v54
    v_exp_f32 v55, v55
    v_mfma_f32_32x32x8_bf16 v[32:47], a[84:85], v[22:23], v[32:47]
    buffer_load_dwordx4 a[208:211], v7, s[28:31], s81 offen offset:0 sc1
    v_cvt_pk_bf16_f32 v74, v52, v53
    v_cvt_pk_bf16_f32 v75, v54, v55
    v_exp_f32 v56, v56
    v_exp_f32 v57, v57
    v_exp_f32 v58, v58
    v_exp_f32 v59, v59
    v_mfma_f32_32x32x16_bf16 v[96:111], a[164:167], v[68:71], v[96:111]
    buffer_load_dwordx4 a[212:215], v7, s[28:31], s81 offen offset:672 sc1
    v_cvt_pk_bf16_f32 v76, v56, v57
    v_cvt_pk_bf16_f32 v77, v58, v59
    v_exp_f32 v60, v60
    v_exp_f32 v61, v61
    v_exp_f32 v62, v62
    v_exp_f32 v63, v63
    v_mfma_f32_32x32x16_bf16 v[96:111], a[168:171], v[72:75], v[96:111]
    buffer_load_dwordx4 a[216:219], v7, s[28:31], s81 offen offset:1344 sc1
    v_cvt_pk_bf16_f32 v78, v60, v61
    v_cvt_pk_bf16_f32 v79, v62, v63
    v_exp_f32 v32, v32
    v_exp_f32 v33, v33
    v_exp_f32 v34, v34
    v_exp_f32 v35, v35
    v_mfma_f32_32x32x16_bf16 v[48:63], a[44:47], v[18:21], 0
    buffer_load_dwordx4 a[220:223], v7, s[28:31], s81 offen offset:2016 sc1
    v_cvt_pk_bf16_f32 v64, v32, v33
    v_cvt_pk_bf16_f32 v65, v34, v35
    v_exp_f32 v36, v36
    v_exp_f32 v37, v37
    v_exp_f32 v38, v38
    v_exp_f32 v39, v39
    v_mfma_f32_32x32x8_bf16 v[48:63], a[86:87], v[22:23], v[48:63]
    v_cvt_pk_bf16_f32 v66, v36, v37
    v_cvt_pk_bf16_f32 v67, v38, v39
    v_exp_f32 v40, v40
    v_exp_f32 v41, v41
    v_exp_f32 v42, v42
    v_exp_f32 v43, v43
    v_mfma_f32_32x32x16_bf16 v[96:111], a[172:175], v[76:79], v[96:111]
    v_cvt_pk_bf16_f32 v68, v40, v41
    v_cvt_pk_bf16_f32 v69, v42, v43
    v_exp_f32 v44, v44
    v_exp_f32 v45, v45
    v_exp_f32_e64 v46, v46
    v_exp_f32 v47, v47
    s_waitcnt vmcnt(14)
    v_mfma_f32_32x32x16_bf16 v[96:111], a[176:179], v[64:67], v[96:111]
    s_add_u32 m0, s63, 0
    v_cvt_pk_bf16_f32 v70, v44, v45
    v_cvt_pk_bf16_f32 v71, v46, v47
    v_exp_f32 v48, v48
    v_exp_f32 v49, v49
    v_exp_f32 v50, v50
    v_exp_f32 v51, v51
    s_waitcnt vmcnt(11)
    v_mfma_f32_32x32x16_bf16 v[32:47], a[48:51], v[18:21], 0
    buffer_load_dwordx4 v132, s[64:67], s4 offen lds
    v_cvt_pk_bf16_f32 v72, v48, v49
    v_cvt_pk_bf16_f32 v73, v50, v51
    v_exp_f32 v52, v52
    v_exp_f32 v53, v53
    v_exp_f32 v54, v54
    v_exp_f32 v55, v55
    v_mfma_f32_32x32x8_bf16 v[32:47], a[88:89], v[22:23], v[32:47]
    v_cvt_pk_bf16_f32 v74, v52, v53
    v_cvt_pk_bf16_f32 v75, v54, v55
    v_exp_f32 v56, v56
    v_exp_f32 v57, v57
    v_exp_f32 v58, v58
    v_exp_f32 v59, v59
    v_mfma_f32_32x32x16_bf16 v[96:111], a[180:183], v[68:71], v[96:111]
    s_add_u32 m0, s63, 1024
    v_cvt_pk_bf16_f32 v76, v56, v57
    v_cvt_pk_bf16_f32 v77, v58, v59
    v_exp_f32 v60, v60
    v_exp_f32 v61, v61
    v_exp_f32 v62, v62
    v_exp_f32 v63, v63
    v_mfma_f32_32x32x16_bf16 v[96:111], a[184:187], v[72:75], v[96:111]
    buffer_load_dwordx4 v132, s[64:67], s7 offen lds
    v_cvt_pk_bf16_f32 v78, v60, v61
    v_cvt_pk_bf16_f32 v79, v62, v63
    v_exp_f32 v32, v32
    v_exp_f32 v33, v33
    v_exp_f32 v34, v34
    v_exp_f32 v35, v35
    v_mfma_f32_32x32x16_bf16 v[48:63], a[52:55], v[18:21], 0
    s_add_u32 m0, s63, 2048
    v_cvt_pk_bf16_f32 v64, v32, v33
    v_cvt_pk_bf16_f32 v65, v34, v35
    v_exp_f32 v36, v36
    v_exp_f32 v37, v37
    v_exp_f32 v38, v38
    v_exp_f32 v39, v39
    v_mfma_f32_32x32x8_bf16 v[48:63], a[90:91], v[22:23], v[48:63]
    v_cvt_pk_bf16_f32 v66, v36, v37
    v_cvt_pk_bf16_f32 v67, v38, v39
    v_exp_f32 v40, v40
    v_exp_f32 v41, v41
    v_exp_f32 v42, v42
    v_exp_f32 v43, v43
    v_mfma_f32_32x32x16_bf16 v[96:111], a[188:191], v[76:79], v[96:111]
    buffer_load_dwordx4 v133, s[64:67], s5 offen lds
    v_cvt_pk_bf16_f32 v68, v40, v41
    v_cvt_pk_bf16_f32 v69, v42, v43
    v_exp_f32 v44, v44
    v_exp_f32 v45, v45
    v_exp_f32_e64 v46, v46
    v_exp_f32 v47, v47
    s_waitcnt vmcnt(10)
    v_mfma_f32_32x32x16_bf16 v[96:111], a[192:195], v[64:67], v[96:111]
    s_add_u32 m0, s63, 3072
    v_cvt_pk_bf16_f32 v70, v44, v45
    v_cvt_pk_bf16_f32 v71, v46, v47
    v_exp_f32 v48, v48
    v_exp_f32 v49, v49
    v_exp_f32_e64 v50, v50
    v_exp_f32 v51, v51
    s_waitcnt vmcnt(7)
    v_mfma_f32_32x32x16_bf16 v[32:47], a[56:59], v[18:21], 0
    buffer_load_dwordx4 v133, s[64:67], s14 offen lds
    v_cvt_pk_bf16_f32 v72, v48, v49
    v_cvt_pk_bf16_f32 v73, v50, v51
    v_exp_f32 v52, v52
    v_exp_f32 v53, v53
    v_exp_f32 v54, v54
    v_exp_f32 v55, v55
    v_mfma_f32_32x32x8_bf16 v[32:47], a[92:93], v[22:23], v[32:47]
    v_cvt_pk_bf16_f32 v74, v52, v53
    v_cvt_pk_bf16_f32 v75, v54, v55
    v_exp_f32 v56, v56
    v_exp_f32 v57, v57
    v_exp_f32 v58, v58
    v_exp_f32 v59, v59
    v_mfma_f32_32x32x16_bf16 v[96:111], a[196:199], v[68:71], v[96:111]
    s_add_u32 m0, s63, 16384
    v_cvt_pk_bf16_f32 v76, v56, v57
    v_cvt_pk_bf16_f32 v77, v58, v59
    v_exp_f32 v60, v60
    v_exp_f32 v61, v61
    v_exp_f32 v62, v62
    v_exp_f32 v63, v63
    v_mfma_f32_32x32x16_bf16 v[96:111], a[200:203], v[72:75], v[96:111]
    buffer_load_dwordx4 v134, s[64:67], s6 offen lds
    v_cvt_pk_bf16_f32 v78, v60, v61
    v_cvt_pk_bf16_f32 v79, v62, v63
    v_exp_f32 v32, v32
    v_exp_f32 v33, v33
    v_exp_f32 v34, v34
    v_exp_f32 v35, v35
    v_mfma_f32_32x32x16_bf16 v[48:63], a[60:63], v[18:21], 0
    ds_read2_b64 v[18:21], v8 offset0:1 offset1:9
    s_add_u32 m0, s63, 17408
    v_cvt_pk_bf16_f32 v64, v32, v33
    v_cvt_pk_bf16_f32 v65, v34, v35
    v_exp_f32 v36, v36
    v_exp_f32 v37, v37
    v_exp_f32 v38, v38
    v_exp_f32 v39, v39
    v_mfma_f32_32x32x8_bf16 v[48:63], a[94:95], v[22:23], v[48:63]
    buffer_load_dwordx4 v134, s[64:67], s15 offen lds
    v_cvt_pk_bf16_f32 v66, v36, v37
    v_cvt_pk_bf16_f32 v67, v38, v39
    v_exp_f32 v40, v40
    v_exp_f32 v41, v41
    v_exp_f32 v42, v42
    v_exp_f32 v43, v43
    v_mfma_f32_32x32x16_bf16 v[96:111], a[204:207], v[76:79], v[96:111]
    ds_read_b64 v[22:23], v9 offset:8
    v_cvt_pk_bf16_f32 v68, v40, v41
    v_cvt_pk_bf16_f32 v69, v42, v43
    v_exp_f32 v44, v44
    v_exp_f32 v45, v45
    v_exp_f32_e64 v46, v46
    v_exp_f32 v47, v47
    s_waitcnt vmcnt(6)
    v_mfma_f32_32x32x16_bf16 v[96:111], a[208:211], v[64:67], v[96:111]
    s_waitcnt lgkmcnt(1)
    v_cvt_pk_bf16_f32 v70, v44, v45
    v_cvt_pk_bf16_f32 v71, v46, v47
    v_exp_f32 v48, v48
    v_exp_f32 v49, v49
    v_exp_f32 v50, v50
    v_exp_f32_e64 v51, v51
    v_mfma_f32_32x32x16_bf16 v[32:47], a[0:3], v[18:21], 0
    s_waitcnt lgkmcnt(0)
    v_cvt_pk_bf16_f32 v72, v48, v49
    v_cvt_pk_bf16_f32 v73, v50, v51
    v_exp_f32 v52, v52
    v_exp_f32 v53, v53
    v_exp_f32 v54, v54
    v_exp_f32_e64 v55, v55
    v_mfma_f32_32x32x8_bf16 v[32:47], a[64:65], v[22:23], v[32:47]
    v_cvt_pk_bf16_f32 v74, v52, v53
    v_cvt_pk_bf16_f32 v75, v54, v55
    v_exp_f32 v56, v56
    v_exp_f32 v57, v57
    v_exp_f32 v58, v58
    v_exp_f32 v59, v59
    v_mfma_f32_32x32x16_bf16 v[96:111], a[212:215], v[68:71], v[96:111]
    s_min_u32 s78, s50, s51
    v_cvt_pk_bf16_f32 v76, v56, v57
    v_cvt_pk_bf16_f32 v77, v58, v59
    v_exp_f32 v60, v60
    v_exp_f32 v61, v61
    v_exp_f32 v62, v62
    v_exp_f32_e64 v63, v63
    v_mfma_f32_32x32x16_bf16 v[96:111], a[216:219], v[72:75], v[96:111]
    s_mul_i32 s34, s49, 54
    v_cvt_pk_bf16_f32 v78, v60, v61
    v_cvt_pk_bf16_f32 v79, v62, v63
    v_exp_f32 v32, v32
    v_exp_f32 v33, v33
    v_exp_f32 v34, v34
    v_exp_f32_e64 v35, v35
    v_mfma_f32_32x32x16_bf16 v[48:63], a[4:7], v[18:21], 0
    s_add_u32 s78, s78, s34
    s_lshl_b32 s78, s78, 10
    v_cvt_pk_bf16_f32 v64, v32, v33
    v_cvt_pk_bf16_f32 v65, v34, v35
    v_exp_f32 v36, v36
    v_exp_f32 v37, v37
    v_exp_f32 v38, v38
    v_exp_f32 v39, v39
    v_mfma_f32_32x32x8_bf16 v[48:63], a[66:67], v[22:23], v[48:63]
    s_min_u32 s79, s45, s46
    v_cvt_pk_bf16_f32 v66, v36, v37
    v_cvt_pk_bf16_f32 v67, v38, v39
    v_exp_f32 v40, v40
    v_exp_f32 v41, v41
    v_exp_f32 v42, v42
    v_exp_f32_e64 v43, v43
    v_mfma_f32_32x32x16_bf16 v[96:111], a[220:223], v[76:79], v[96:111]
    s_add_u32 s35, s44, s32
    s_mul_i32 s34, s35, 20
    v_cvt_pk_bf16_f32 v68, v40, v41
    v_cvt_pk_bf16_f32 v69, v42, v43
    v_exp_f32 v44, v44
    v_exp_f32 v45, v45
    v_exp_f32 v46, v46
    v_exp_f32 v47, v47
    v_mfma_f32_32x32x16_bf16 v[80:95], a[96:99], v[64:67], 0
    s_add_u32 s79, s79, s34
    s_lshl_b32 s79, s79, 10
    v_cvt_pk_bf16_f32 v70, v44, v45
    v_cvt_pk_bf16_f32 v71, v46, v47
    v_exp_f32 v48, v48
    v_exp_f32 v49, v49
    v_exp_f32 v50, v50
    v_exp_f32 v51, v51
    v_mfma_f32_32x32x16_bf16 v[32:47], a[8:11], v[18:21], 0
    s_add_u32 s79, s79, 0
    s_lshl_b32 s80, s35, 3
    v_cvt_pk_bf16_f32 v72, v48, v49
    v_cvt_pk_bf16_f32 v73, v50, v51
    v_exp_f32 v52, v52
    v_exp_f32 v53, v53
    v_exp_f32 v54, v54
    v_exp_f32 v55, v55
    v_mfma_f32_32x32x8_bf16 v[32:47], a[68:69], v[22:23], v[32:47]
    s_add_u32 s80, s80, s43
    v_cvt_pk_bf16_f32 v74, v52, v53
    v_cvt_pk_bf16_f32 v75, v54, v55
    v_exp_f32 v56, v56
    v_exp_f32 v57, v57
    v_exp_f32 v58, v58
    v_exp_f32_e64 v59, v59
    v_mfma_f32_32x32x16_bf16 v[80:95], a[100:103], v[68:71], v[80:95]
    s_lshl_b32 s80, s80, 7
    s_add_u32 s80, s80, 7340032
    v_cvt_pk_bf16_f32 v76, v56, v57
    v_cvt_pk_bf16_f32 v77, v58, v59
    v_exp_f32 v60, v60
    v_exp_f32 v61, v61
    v_exp_f32 v62, v62
    v_exp_f32_e64 v63, v63
    v_mfma_f32_32x32x16_bf16 v[80:95], a[104:107], v[72:75], v[80:95]
    ds_write_b128 v15, v[96:99] offset:0
    s_lshl_b32 s39, s58, 8
    v_cvt_pk_bf16_f32 v78, v60, v61
    v_cvt_pk_bf16_f32 v79, v62, v63
    v_exp_f32 v32, v32
    v_exp_f32 v33, v33
    v_exp_f32 v34, v34
    v_exp_f32_e64 v35, v35
    v_mfma_f32_32x32x16_bf16 v[48:63], a[12:15], v[18:21], 0
    ds_write_b128 v15, v[100:103] offset:1024
    s_add_u32 s39, s39, 7299072
    v_cvt_pk_bf16_f32 v64, v32, v33
    v_cvt_pk_bf16_f32 v65, v34, v35
    v_exp_f32 v36, v36
    v_exp_f32 v37, v37
    v_exp_f32 v38, v38
    v_exp_f32 v39, v39
    v_mfma_f32_32x32x8_bf16 v[48:63], a[70:71], v[22:23], v[48:63]
    v_cvt_pk_bf16_f32 v66, v36, v37
    v_cvt_pk_bf16_f32 v67, v38, v39
    v_exp_f32 v40, v40
    v_exp_f32 v41, v41
    v_exp_f32 v42, v42
    v_exp_f32 v43, v43
    v_mfma_f32_32x32x16_bf16 v[80:95], a[108:111], v[76:79], v[80:95]
    ds_write_b128 v15, v[104:107] offset:2048
    v_cvt_pk_bf16_f32 v68, v40, v41
    v_cvt_pk_bf16_f32 v69, v42, v43
    v_exp_f32 v44, v44
    v_exp_f32 v45, v45
    v_exp_f32 v46, v46
    v_exp_f32 v47, v47
    v_mfma_f32_32x32x16_bf16 v[80:95], a[112:115], v[64:67], v[80:95]
    ds_write_b32 v15, v5 offset:3072
    v_cvt_pk_bf16_f32 v70, v44, v45
    v_cvt_pk_bf16_f32 v71, v46, v47
    v_exp_f32 v48, v48
    v_exp_f32 v49, v49
    v_exp_f32 v50, v50
    v_exp_f32 v51, v51
    v_mfma_f32_32x32x16_bf16 v[32:47], a[16:19], v[18:21], 0
    s_lshl_b32 s34, s34, 10
    v_cvt_pk_bf16_f32 v72, v48, v49
    v_cvt_pk_bf16_f32 v73, v50, v51
    v_exp_f32 v52, v52
    v_exp_f32 v53, v53
    v_exp_f32 v54, v54
    v_exp_f32_e64 v55, v55
    v_mfma_f32_32x32x8_bf16 v[32:47], a[72:73], v[22:23], v[32:47]
    v_cvt_pk_bf16_f32 v74, v52, v53
    v_cvt_pk_bf16_f32 v75, v54, v55
    v_exp_f32 v56, v56
    v_exp_f32 v57, v57
    v_exp_f32 v58, v58
    v_exp_f32 v59, v59
    v_mfma_f32_32x32x16_bf16 v[80:95], a[116:119], v[68:71], v[80:95]
    s_lshl_b32 s81, s45, 6
    v_cvt_pk_bf16_f32 v76, v56, v57
    v_cvt_pk_bf16_f32 v77, v58, v59
    v_exp_f32 v60, v60
    v_exp_f32 v61, v61
    v_exp_f32 v62, v62
    v_exp_f32_e64 v63, v63
    v_mfma_f32_32x32x16_bf16 v[80:95], a[120:123], v[72:75], v[80:95]
    s_add_u32 s81, s81, s34
    v_cvt_pk_bf16_f32 v78, v60, v61
    v_cvt_pk_bf16_f32 v79, v62, v63
    v_exp_f32 v32, v32
    v_exp_f32 v33, v33
    v_exp_f32 v34, v34
    v_exp_f32_e64 v35, v35
    v_mfma_f32_32x32x16_bf16 v[48:63], a[20:23], v[18:21], 0
    s_lshl_b32 s60, s46, 3
    v_cvt_pk_bf16_f32 v64, v32, v33
    v_cvt_pk_bf16_f32 v65, v34, v35
    v_exp_f32 v36, v36
    v_exp_f32 v37, v37
    v_exp_f32 v38, v38
    v_exp_f32_e64 v39, v39
    v_mfma_f32_32x32x8_bf16 v[48:63], a[74:75], v[22:23], v[48:63]
    v_cvt_pk_bf16_f32 v66, v36, v37
    v_cvt_pk_bf16_f32 v67, v38, v39
    v_exp_f32 v40, v40
    v_exp_f32 v41, v41
    v_exp_f32 v42, v42
    v_exp_f32 v43, v43
    v_mfma_f32_32x32x16_bf16 v[80:95], a[124:127], v[76:79], v[80:95]
    s_add_u32 s60, s60, s47
    v_cvt_pk_bf16_f32 v68, v40, v41
    v_cvt_pk_bf16_f32 v69, v42, v43
    v_exp_f32 v44, v44
    v_exp_f32 v45, v45
    v_exp_f32 v46, v46
    v_exp_f32_e64 v47, v47
    v_mfma_f32_32x32x16_bf16 v[80:95], a[128:131], v[64:67], v[80:95]
    s_lshl_b32 s60, s60, 3
    v_cvt_pk_bf16_f32 v70, v44, v45
    v_cvt_pk_bf16_f32 v71, v46, v47
    v_exp_f32 v48, v48
    v_exp_f32 v49, v49
    v_exp_f32 v50, v50
    v_exp_f32_e64 v51, v51
    v_mfma_f32_32x32x16_bf16 v[32:47], a[24:27], v[18:21], 0
    s_add_u32 s60, s60, s34
    v_cvt_pk_bf16_f32 v72, v48, v49
    v_cvt_pk_bf16_f32 v73, v50, v51
    v_exp_f32 v52, v52
    v_exp_f32 v53, v53
    v_exp_f32 v54, v54
    v_exp_f32_e64 v55, v55
    v_mfma_f32_32x32x8_bf16 v[32:47], a[76:77], v[22:23], v[32:47]
    v_cvt_pk_bf16_f32 v74, v52, v53
    v_cvt_pk_bf16_f32 v75, v54, v55
    v_exp_f32 v56, v56
    v_exp_f32 v57, v57
    v_exp_f32 v58, v58
    v_exp_f32 v59, v59
    v_mfma_f32_32x32x16_bf16 v[80:95], a[132:135], v[68:71], v[80:95]
    v_cvt_pk_bf16_f32 v76, v56, v57
    v_cvt_pk_bf16_f32 v77, v58, v59
    v_exp_f32 v60, v60
    v_exp_f32 v61, v61
    v_exp_f32 v62, v62
    v_exp_f32 v63, v63
    v_mfma_f32_32x32x16_bf16 v[80:95], a[136:139], v[72:75], v[80:95]
    buffer_load_dwordx4 v[120:123], v114, s[16:19], s81 offen
    v_cvt_pk_bf16_f32 v78, v60, v61
    v_cvt_pk_bf16_f32 v79, v62, v63
    v_exp_f32 v32, v32
    v_exp_f32 v33, v33
    v_exp_f32 v34, v34
    v_exp_f32 v35, v35
    v_mfma_f32_32x32x16_bf16 v[48:63], a[28:31], v[18:21], 0
    v_cvt_pk_bf16_f32 v64, v32, v33
    v_cvt_pk_bf16_f32 v65, v34, v35
    v_exp_f32 v36, v36
    v_exp_f32 v37, v37
    v_exp_f32 v38, v38
    v_exp_f32 v39, v39
    v_mfma_f32_32x32x8_bf16 v[48:63], a[78:79], v[22:23], v[48:63]
    v_cvt_pk_bf16_f32 v66, v36, v37
    v_cvt_pk_bf16_f32 v67, v38, v39
    v_exp_f32 v40, v40
    v_exp_f32 v41, v41
    v_exp_f32 v42, v42
    v_exp_f32 v43, v43
    v_mfma_f32_32x32x16_bf16 v[80:95], a[140:143], v[76:79], v[80:95]
    v_cvt_pk_bf16_f32 v68, v40, v41
    v_cvt_pk_bf16_f32 v69, v42, v43
    v_exp_f32 v44, v44
    v_exp_f32 v45, v45
    v_exp_f32 v46, v46
    v_exp_f32 v47, v47
    v_mfma_f32_32x32x16_bf16 v[80:95], a[144:147], v[64:67], v[80:95]
    v_cvt_pk_bf16_f32 v70, v44, v45
    v_cvt_pk_bf16_f32 v71, v46, v47
    v_exp_f32 v48, v48
    v_exp_f32 v49, v49
    v_exp_f32 v50, v50
    v_exp_f32 v51, v51
    v_mfma_f32_32x32x16_bf16 v[32:47], a[32:35], v[18:21], 0
    v_cvt_pk_bf16_f32 v72, v48, v49
    v_cvt_pk_bf16_f32 v73, v50, v51
    v_exp_f32 v52, v52
    v_exp_f32 v53, v53
    v_exp_f32 v54, v54
    v_exp_f32 v55, v55
    v_mfma_f32_32x32x8_bf16 v[32:47], a[80:81], v[22:23], v[32:47]
    v_cvt_pk_bf16_f32 v74, v52, v53
    v_cvt_pk_bf16_f32 v75, v54, v55
    v_exp_f32 v56, v56
    v_exp_f32 v57, v57
    v_exp_f32 v58, v58
    v_exp_f32 v59, v59
    v_mfma_f32_32x32x16_bf16 v[80:95], a[148:151], v[68:71], v[80:95]
    v_cvt_pk_bf16_f32 v76, v56, v57
    v_cvt_pk_bf16_f32 v77, v58, v59
    v_exp_f32 v60, v60
    v_exp_f32 v61, v61
    v_exp_f32 v62, v62
    v_exp_f32 v63, v63
    v_mfma_f32_32x32x16_bf16 v[80:95], a[152:155], v[72:75], v[80:95]
    buffer_load_dwordx4 v[124:127], v114, s[16:19], s81 offen offset:64
    v_cvt_pk_bf16_f32 v78, v60, v61
    v_cvt_pk_bf16_f32 v79, v62, v63
    v_exp_f32 v32, v32
    v_exp_f32 v33, v33
    v_exp_f32 v34, v34
    v_exp_f32 v35, v35
    v_mfma_f32_32x32x16_bf16 v[48:63], a[36:39], v[18:21], 0
    v_cvt_pk_bf16_f32 v64, v32, v33
    v_cvt_pk_bf16_f32 v65, v34, v35
    v_exp_f32 v36, v36
    v_exp_f32 v37, v37
    v_exp_f32 v38, v38
    v_exp_f32 v39, v39
    v_mfma_f32_32x32x8_bf16 v[48:63], a[82:83], v[22:23], v[48:63]
    v_cvt_pk_bf16_f32 v66, v36, v37
    v_cvt_pk_bf16_f32 v67, v38, v39
    v_exp_f32 v40, v40
    v_exp_f32 v41, v41
    v_exp_f32 v42, v42
    v_exp_f32 v43, v43
    v_mfma_f32_32x32x16_bf16 v[80:95], a[156:159], v[76:79], v[80:95]
    v_cvt_pk_bf16_f32 v68, v40, v41
    v_cvt_pk_bf16_f32 v69, v42, v43
    v_exp_f32 v44, v44
    v_exp_f32 v45, v45
    v_exp_f32 v46, v46
    v_exp_f32 v47, v47
    v_mfma_f32_32x32x16_bf16 v[96:111], a[160:163], v[64:67], v[80:95]
    v_cvt_pk_bf16_f32 v70, v44, v45
    v_cvt_pk_bf16_f32 v71, v46, v47
    v_exp_f32 v48, v48
    v_exp_f32 v49, v49
    v_exp_f32 v50, v50
    v_exp_f32 v51, v51
    v_mfma_f32_32x32x16_bf16 v[32:47], a[40:43], v[18:21], 0
    v_cvt_pk_bf16_f32 v72, v48, v49
    v_cvt_pk_bf16_f32 v73, v50, v51
    v_exp_f32 v52, v52
    v_exp_f32 v53, v53
    v_exp_f32 v54, v54
    v_exp_f32 v55, v55
    v_mfma_f32_32x32x8_bf16 v[32:47], a[84:85], v[22:23], v[32:47]
    v_cvt_pk_bf16_f32 v74, v52, v53
    v_cvt_pk_bf16_f32 v75, v54, v55
    v_exp_f32 v56, v56
    v_exp_f32 v57, v57
    v_exp_f32 v58, v58
    v_exp_f32 v59, v59
    v_mfma_f32_32x32x16_bf16 v[96:111], a[164:167], v[68:71], v[96:111]
    ds_read_b32 v249, v246 offset:3072
    v_cvt_pk_bf16_f32 v76, v56, v57
    v_cvt_pk_bf16_f32 v77, v58, v59
    v_exp_f32 v60, v60
    v_exp_f32 v61, v61
    v_exp_f32 v62, v62
    v_exp_f32 v63, v63
    v_mfma_f32_32x32x16_bf16 v[96:111], a[168:171], v[72:75], v[96:111]
    ds_read_b128 v[80:83], v246 offset:0
    v_cvt_pk_bf16_f32 v78, v60, v61
    v_cvt_pk_bf16_f32 v79, v62, v63
    v_exp_f32 v32, v32
    v_exp_f32 v33, v33
    v_exp_f32 v34, v34
    v_exp_f32 v35, v35
    v_mfma_f32_32x32x16_bf16 v[48:63], a[44:47], v[18:21], 0
    ds_read_b128 v[84:87], v246 offset:1024
    v_cvt_pk_bf16_f32 v64, v32, v33
    v_cvt_pk_bf16_f32 v65, v34, v35
    v_exp_f32 v36, v36
    v_exp_f32 v37, v37
    v_exp_f32 v38, v38
    v_exp_f32 v39, v39
    v_mfma_f32_32x32x8_bf16 v[48:63], a[86:87], v[22:23], v[48:63]
    v_cvt_pk_bf16_f32 v66, v36, v37
    v_cvt_pk_bf16_f32 v67, v38, v39
    v_exp_f32 v40, v40
    v_exp_f32 v41, v41
    v_exp_f32 v42, v42
    v_exp_f32 v43, v43
    v_mfma_f32_32x32x16_bf16 v[96:111], a[172:175], v[76:79], v[96:111]
    ds_read_b128 v[88:91], v246 offset:2048
    v_cvt_pk_bf16_f32 v68, v40, v41
    v_cvt_pk_bf16_f32 v69, v42, v43
    v_exp_f32 v44, v44
    v_exp_f32 v45, v45
    v_exp_f32 v46, v46
    v_exp_f32 v47, v47
    v_mfma_f32_32x32x16_bf16 v[96:111], a[176:179], v[64:67], v[96:111]
    buffer_load_dwordx2 v[128:129], v114, s[16:19], s60 offen
    v_cvt_pk_bf16_f32 v70, v44, v45
    v_cvt_pk_bf16_f32 v71, v46, v47
    v_exp_f32 v48, v48
    v_exp_f32 v49, v49
    v_exp_f32 v50, v50
    v_exp_f32 v51, v51
    v_mfma_f32_32x32x16_bf16 v[32:47], a[48:51], v[18:21], 0
    v_cvt_pk_bf16_f32 v72, v48, v49
    v_cvt_pk_bf16_f32 v73, v50, v51
    v_exp_f32 v52, v52
    v_exp_f32 v53, v53
    v_exp_f32 v54, v54
    v_exp_f32 v55, v55
    v_mfma_f32_32x32x8_bf16 v[32:47], a[88:89], v[22:23], v[32:47]
    v_cvt_pk_bf16_f32 v74, v52, v53
    v_cvt_pk_bf16_f32 v75, v54, v55
    v_exp_f32 v56, v56
    v_exp_f32 v57, v57
    v_exp_f32 v58, v58
    v_exp_f32 v59, v59
    v_mfma_f32_32x32x16_bf16 v[96:111], a[180:183], v[68:71], v[96:111]
    v_cvt_pk_bf16_f32 v76, v56, v57
    v_cvt_pk_bf16_f32 v77, v58, v59
    v_exp_f32 v60, v60
    v_exp_f32 v61, v61
    v_exp_f32 v62, v62
    v_exp_f32 v63, v63
    v_mfma_f32_32x32x16_bf16 v[96:111], a[184:187], v[72:75], v[96:111]
    buffer_load_dword v242, v112, s[28:31], s78 offen sc1
    v_cvt_pk_bf16_f32 v78, v60, v61
    v_cvt_pk_bf16_f32 v79, v62, v63
    v_exp_f32 v32, v32
    v_exp_f32 v33, v33
    v_exp_f32 v34, v34
    v_exp_f32 v35, v35
    v_mfma_f32_32x32x16_bf16 v[48:63], a[52:55], v[18:21], 0
    s_add_u32 s78, s78, 55296
    v_cvt_pk_bf16_f32 v64, v32, v33
    v_cvt_pk_bf16_f32 v65, v34, v35
    v_exp_f32 v36, v36
    v_exp_f32 v37, v37
    v_exp_f32 v38, v38
    v_exp_f32 v39, v39
    v_mfma_f32_32x32x8_bf16 v[48:63], a[90:91], v[22:23], v[48:63]
    v_cvt_pk_bf16_f32 v66, v36, v37
    v_cvt_pk_bf16_f32 v67, v38, v39
    v_exp_f32 v40, v40
    v_exp_f32 v41, v41
    v_exp_f32 v42, v42
    v_exp_f32 v43, v43
    v_mfma_f32_32x32x16_bf16 v[96:111], a[188:191], v[76:79], v[96:111]
    v_cvt_pk_bf16_f32 v68, v40, v41
    v_cvt_pk_bf16_f32 v69, v42, v43
    v_exp_f32 v44, v44
    v_exp_f32 v45, v45
    v_exp_f32 v46, v46
    v_exp_f32 v47, v47
    v_mfma_f32_32x32x16_bf16 v[96:111], a[192:195], v[64:67], v[96:111]
    s_waitcnt vmcnt(4)
    v_cvt_pk_bf16_f32 v70, v44, v45
    v_cvt_pk_bf16_f32 v71, v46, v47
    v_exp_f32 v48, v48
    v_exp_f32 v49, v49
    v_exp_f32 v50, v50
    v_exp_f32_e64 v51, v51
    v_mfma_f32_32x32x16_bf16 v[32:47], a[56:59], v[18:21], 0
    ds_read_b64_tr_b16 v[136:137], v135 offset:0
    v_cvt_pk_bf16_f32 v72, v48, v49
    v_cvt_pk_bf16_f32 v73, v50, v51
    v_exp_f32 v52, v52
    v_exp_f32 v53, v53
    v_exp_f32 v54, v54
    v_exp_f32 v55, v55
    v_mfma_f32_32x32x8_bf16 v[32:47], a[92:93], v[22:23], v[32:47]
    v_cvt_pk_bf16_f32 v74, v52, v53
    v_cvt_pk_bf16_f32 v75, v54, v55
    v_exp_f32 v56, v56
    v_exp_f32 v57, v57
    v_exp_f32 v58, v58
    v_exp_f32 v59, v59
    v_mfma_f32_32x32x16_bf16 v[96:111], a[196:199], v[68:71], v[96:111]
    ds_read_b64_tr_b16 v[138:139], v135 offset:256
    v_cvt_pk_bf16_f32 v76, v56, v57
    v_cvt_pk_bf16_f32 v77, v58, v59
    v_exp_f32 v60, v60
    v_exp_f32 v61, v61
    v_exp_f32 v62, v62
    v_exp_f32 v63, v63
    v_mfma_f32_32x32x16_bf16 v[96:111], a[200:203], v[72:75], v[96:111]
    ds_read_b64_tr_b16 v[140:141], v135 offset:8
    v_cvt_pk_bf16_f32 v78, v60, v61
    v_cvt_pk_bf16_f32 v79, v62, v63
    v_exp_f32 v32, v32
    v_exp_f32 v33, v33
    v_exp_f32 v34, v34
    v_exp_f32 v35, v35
    v_mfma_f32_32x32x16_bf16 v[48:63], a[60:63], v[18:21], 0
    ds_read2_b64 v[18:21], v11 offset0:0 offset1:8
    v_cvt_pk_bf16_f32 v64, v32, v33
    v_cvt_pk_bf16_f32 v65, v34, v35
    v_exp_f32 v36, v36
    v_exp_f32 v37, v37
    v_exp_f32 v38, v38
    v_exp_f32 v39, v39
    v_mfma_f32_32x32x8_bf16 v[48:63], a[94:95], v[22:23], v[48:63]
    v_cvt_pk_bf16_f32 v66, v36, v37
    v_cvt_pk_bf16_f32 v67, v38, v39
    v_exp_f32 v40, v40
    v_exp_f32 v41, v41
    v_exp_f32 v42, v42
    v_exp_f32 v43, v43
    v_mfma_f32_32x32x16_bf16 v[96:111], a[204:207], v[76:79], v[96:111]
    ds_read_b64 v[22:23], v12 offset:0
    v_cvt_pk_bf16_f32 v68, v40, v41
    v_cvt_pk_bf16_f32 v69, v42, v43
    v_exp_f32 v44, v44
    v_exp_f32 v45, v45
    v_exp_f32 v46, v46
    v_exp_f32 v47, v47
    v_mfma_f32_32x32x16_bf16 v[96:111], a[208:211], v[64:67], v[96:111]
    s_waitcnt lgkmcnt(1)
    v_cvt_pk_bf16_f32 v70, v44, v45
    v_cvt_pk_bf16_f32 v71, v46, v47
    v_exp_f32 v48, v48
    v_exp_f32 v49, v49
    v_exp_f32 v50, v50
    v_exp_f32_e64 v51, v51
    v_mfma_f32_32x32x16_bf16 v[32:47], a[0:3], v[18:21], 0
    s_waitcnt lgkmcnt(0)
    v_cvt_pk_bf16_f32 v72, v48, v49
    v_cvt_pk_bf16_f32 v73, v50, v51
    v_exp_f32 v52, v52
    v_exp_f32 v53, v53
    v_exp_f32 v54, v54
    v_exp_f32_e64 v55, v55
    v_mfma_f32_32x32x8_bf16 v[32:47], a[64:65], v[22:23], v[32:47]
    v_cmp_ne_u32_e64 vcc, v249, v5
    v_cvt_pk_bf16_f32 v74, v52, v53
    v_cvt_pk_bf16_f32 v75, v54, v55
    v_exp_f32 v56, v56
    v_exp_f32 v57, v57
    v_exp_f32 v58, v58
    v_exp_f32 v59, v59
    v_mfma_f32_32x32x16_bf16 v[96:111], a[212:215], v[68:71], v[96:111]
    s_cbranch_vccnz CH_1
CR_1:
    v_cvt_pk_bf16_f32 v76, v56, v57
    v_cvt_pk_bf16_f32 v77, v58, v59
    v_exp_f32 v60, v60
    v_exp_f32 v61, v61
    v_exp_f32 v62, v62
    v_exp_f32_e64 v63, v63
    v_mfma_f32_32x32x16_bf16 v[96:111], a[216:219], v[72:75], v[96:111]
    ds_read_b64_tr_b16 v[142:143], v135 offset:264
    v_cvt_pk_bf16_f32 v78, v60, v61
    v_cvt_pk_bf16_f32 v79, v62, v63
    v_exp_f32 v32, v32
    v_exp_f32 v33, v33
    v_exp_f32 v34, v34
    v_exp_f32 v35, v35
    v_mfma_f32_32x32x16_bf16 v[48:63], a[4:7], v[18:21], 0
    ds_read_b64_tr_b16 v[144:145], v135 offset:2048
    ds_read_b64_tr_b16 v[146:147], v135 offset:2304
    v_cvt_pk_bf16_f32 v64, v32, v33
    v_cvt_pk_bf16_f32 v65, v34, v35
    v_exp_f32 v36, v36
    v_exp_f32 v37, v37
    v_exp_f32 v38, v38
    v_exp_f32 v39, v39
    v_mfma_f32_32x32x8_bf16 v[48:63], a[66:67], v[22:23], v[48:63]
    ds_read_b64_tr_b16 v[148:149], v135 offset:2056
    v_cvt_pk_bf16_f32 v66, v36, v37
    v_cvt_pk_bf16_f32 v67, v38, v39
    v_exp_f32 v40, v40
    v_exp_f32 v41, v41
    v_exp_f32 v42, v42
    v_exp_f32 v43, v43
    v_mfma_f32_32x32x16_bf16 v[96:111], a[220:223], v[76:79], v[96:111]
    ds_read_b64_tr_b16 v[150:151], v135 offset:2312
    ds_read_b64_tr_b16 v[152:153], v135 offset:16384
    v_cvt_pk_bf16_f32 v68, v40, v41
    v_cvt_pk_bf16_f32 v69, v42, v43
    v_exp_f32 v44, v44
    v_exp_f32 v45, v45
    v_exp_f32 v46, v46
    v_exp_f32 v47, v47
    v_mfma_f32_32x32x16_bf16 v[80:95], a[96:99], v[64:67], v[80:95]
    ds_read_b64_tr_b16 v[154:155], v135 offset:16640
    ds_read_b64_tr_b16 v[156:157], v135 offset:16392
    v_cvt_pk_bf16_f32 v70, v44, v45
    v_cvt_pk_bf16_f32 v71, v46, v47
    v_exp_f32 v48, v48
    v_exp_f32 v49, v49
    v_exp_f32 v50, v50
    v_exp_f32 v51, v51
    v_mfma_f32_32x32x16_bf16 v[32:47], a[8:11], v[18:21], 0
    ds_read_b64_tr_b16 v[158:159], v135 offset:16648
    s_waitcnt lgkmcnt(0)
    v_cvt_pk_bf16_f32 v72, v48, v49
    v_cvt_pk_bf16_f32 v73, v50, v51
    v_exp_f32 v52, v52
    v_exp_f32 v53, v53
    v_exp_f32 v54, v54
    v_exp_f32_e64 v55, v55
    v_mfma_f32_32x32x8_bf16 v[32:47], a[68:69], v[22:23], v[32:47]
    v_cvt_pk_bf16_f32 v74, v52, v53
    v_cvt_pk_bf16_f32 v75, v54, v55
    v_exp_f32 v56, v56
    v_exp_f32 v57, v57
    v_exp_f32 v58, v58
    v_exp_f32 v59, v59
    v_mfma_f32_32x32x16_bf16 v[80:95], a[100:103], v[68:71], v[80:95]
    v_cvt_pk_bf16_f32 v76, v56, v57
    v_cvt_pk_bf16_f32 v77, v58, v59
    v_exp_f32 v60, v60
    v_exp_f32 v61, v61
    v_exp_f32 v62, v62
    v_exp_f32 v63, v63
    v_mfma_f32_32x32x16_bf16 v[80:95], a[104:107], v[72:75], v[80:95]
    ds_write_b128 v15, v[96:99] offset:4096
    v_cvt_pk_bf16_f32 v78, v60, v61
    v_cvt_pk_bf16_f32 v79, v62, v63
    v_exp_f32 v32, v32
    v_exp_f32 v33, v33
    v_exp_f32 v34, v34
    v_exp_f32 v35, v35
    v_mfma_f32_32x32x16_bf16 v[48:63], a[12:15], v[18:21], 0
    ds_write_b128 v15, v[100:103] offset:5120
    v_cvt_pk_bf16_f32 v64, v32, v33
    v_cvt_pk_bf16_f32 v65, v34, v35
    v_exp_f32 v36, v36
    v_exp_f32 v37, v37
    v_exp_f32 v38, v38
    v_exp_f32 v39, v39
    v_mfma_f32_32x32x8_bf16 v[48:63], a[70:71], v[22:23], v[48:63]
    v_cvt_pk_bf16_f32 v66, v36, v37
    v_cvt_pk_bf16_f32 v67, v38, v39
    v_exp_f32 v40, v40
    v_exp_f32 v41, v41
    v_exp_f32 v42, v42
    v_exp_f32 v43, v43
    v_mfma_f32_32x32x16_bf16 v[80:95], a[108:111], v[76:79], v[80:95]
    ds_write_b128 v15, v[104:107] offset:6144
    v_cvt_pk_bf16_f32 v68, v40, v41
    v_cvt_pk_bf16_f32 v69, v42, v43
    v_exp_f32 v44, v44
    v_exp_f32 v45, v45
    v_exp_f32 v46, v46
    v_exp_f32 v47, v47
    v_mfma_f32_32x32x16_bf16 v[80:95], a[112:115], v[64:67], v[80:95]
    ds_write_b32 v15, v5 offset:7168
    v_cvt_pk_bf16_f32 v70, v44, v45
    v_cvt_pk_bf16_f32 v71, v46, v47
    v_exp_f32 v48, v48
    v_exp_f32 v49, v49
    v_exp_f32 v50, v50
    v_exp_f32 v51, v51
    v_mfma_f32_32x32x16_bf16 v[32:47], a[16:19], v[18:21], 0
    buffer_store_dwordx4 v[136:139], v5, s[28:31], s68 offen sc1
    v_cvt_pk_bf16_f32 v72, v48, v49
    v_cvt_pk_bf16_f32 v73, v50, v51
    v_exp_f32 v52, v52
    v_exp_f32 v53, v53
    v_exp_f32 v54, v54
    v_exp_f32 v55, v55
    v_mfma_f32_32x32x8_bf16 v[32:47], a[72:73], v[22:23], v[32:47]
    v_cvt_pk_bf16_f32 v74, v52, v53
    v_cvt_pk_bf16_f32 v75, v54, v55
    v_exp_f32 v56, v56
    v_exp_f32 v57, v57
    v_exp_f32 v58, v58
    v_exp_f32 v59, v59
    v_mfma_f32_32x32x16_bf16 v[80:95], a[116:119], v[68:71], v[80:95]
    v_mfma_f32_16x16x32_bf16 v[160:163], v[168:171], v[136:139], 0
    v_cvt_pk_bf16_f32 v76, v56, v57
    v_cvt_pk_bf16_f32 v77, v58, v59
    v_exp_f32 v60, v60
    v_exp_f32 v61, v61
    v_exp_f32 v62, v62
    v_exp_f32 v63, v63
    v_mfma_f32_32x32x16_bf16 v[80:95], a[120:123], v[72:75], v[80:95]
    buffer_store_dwordx4 v[140:143], v5, s[28:31], s69 offen sc1
    v_cvt_pk_bf16_f32 v78, v60, v61
    v_cvt_pk_bf16_f32 v79, v62, v63
    v_exp_f32 v32, v32
    v_exp_f32 v33, v33
    v_exp_f32 v34, v34
    v_exp_f32 v35, v35
    v_mfma_f32_32x32x16_bf16 v[48:63], a[20:23], v[18:21], 0
    v_mfma_f32_16x16x32_bf16 v[164:167], v[168:171], v[140:143], 0
    v_cvt_pk_bf16_f32 v64, v32, v33
    v_cvt_pk_bf16_f32 v65, v34, v35
    v_exp_f32 v36, v36
    v_exp_f32 v37, v37
    v_exp_f32 v38, v38
    v_exp_f32 v39, v39
    v_mfma_f32_32x32x8_bf16 v[48:63], a[74:75], v[22:23], v[48:63]
    v_cvt_pk_bf16_f32 v66, v36, v37
    v_cvt_pk_bf16_f32 v67, v38, v39
    v_exp_f32 v40, v40
    v_exp_f32 v41, v41
    v_exp_f32 v42, v42
    v_exp_f32 v43, v43
    v_mfma_f32_32x32x16_bf16 v[80:95], a[124:127], v[76:79], v[80:95]
    v_cvt_pk_bf16_f32 v68, v40, v41
    v_cvt_pk_bf16_f32 v69, v42, v43
    v_exp_f32 v44, v44
    v_exp_f32 v45, v45
    v_exp_f32 v46, v46
    v_exp_f32 v47, v47
    v_mfma_f32_32x32x16_bf16 v[80:95], a[128:131], v[64:67], v[80:95]
    buffer_store_dwordx4 v[144:147], v5, s[28:31], s70 offen sc1
    v_cvt_pk_bf16_f32 v70, v44, v45
    v_cvt_pk_bf16_f32 v71, v46, v47
    v_exp_f32 v48, v48
    v_exp_f32 v49, v49
    v_exp_f32 v50, v50
    v_exp_f32 v51, v51
    v_mfma_f32_32x32x16_bf16 v[32:47], a[24:27], v[18:21], 0
    v_mfma_f32_16x16x32_bf16 v[160:163], v[168:171], v[144:147], v[160:163]
    v_cvt_pk_bf16_f32 v72, v48, v49
    v_cvt_pk_bf16_f32 v73, v50, v51
    v_exp_f32 v52, v52
    v_exp_f32 v53, v53
    v_exp_f32 v54, v54
    v_exp_f32 v55, v55
    v_mfma_f32_32x32x8_bf16 v[32:47], a[76:77], v[22:23], v[32:47]
    v_cvt_pk_bf16_f32 v74, v52, v53
    v_cvt_pk_bf16_f32 v75, v54, v55
    v_exp_f32 v56, v56
    v_exp_f32 v57, v57
    v_exp_f32 v58, v58
    v_exp_f32 v59, v59
    v_mfma_f32_32x32x16_bf16 v[80:95], a[132:135], v[68:71], v[80:95]
    v_cvt_pk_bf16_f32 v76, v56, v57
    v_cvt_pk_bf16_f32 v77, v58, v59
    v_exp_f32 v60, v60
    v_exp_f32 v61, v61
    v_exp_f32 v62, v62
    v_exp_f32 v63, v63
    v_mfma_f32_32x32x16_bf16 v[80:95], a[136:139], v[72:75], v[80:95]
    buffer_store_dwordx4 v[148:151], v5, s[28:31], s71 offen sc1
    v_cvt_pk_bf16_f32 v78, v60, v61
    v_cvt_pk_bf16_f32 v79, v62, v63
    v_exp_f32 v32, v32
    v_exp_f32 v33, v33
    v_exp_f32 v34, v34
    v_exp_f32 v35, v35
    v_mfma_f32_32x32x16_bf16 v[48:63], a[28:31], v[18:21], 0
    v_mfma_f32_16x16x32_bf16 v[164:167], v[168:171], v[148:151], v[164:167]
    v_cvt_pk_bf16_f32 v64, v32, v33
    v_cvt_pk_bf16_f32 v65, v34, v35
    v_exp_f32 v36, v36
    v_exp_f32 v37, v37
    v_exp_f32 v38, v38
    v_exp_f32 v39, v39
    v_mfma_f32_32x32x8_bf16 v[48:63], a[78:79], v[22:23], v[48:63]
    v_cvt_pk_bf16_f32 v66, v36, v37
    v_cvt_pk_bf16_f32 v67, v38, v39
    v_exp_f32 v40, v40
    v_exp_f32 v41, v41
    v_exp_f32 v42, v42
    v_exp_f32 v43, v43
    v_mfma_f32_32x32x16_bf16 v[80:95], a[140:143], v[76:79], v[80:95]
    v_cvt_pk_bf16_f32 v68, v40, v41
    v_cvt_pk_bf16_f32 v69, v42, v43
    v_exp_f32 v44, v44
    v_exp_f32 v45, v45
    v_exp_f32 v46, v46
    v_exp_f32 v47, v47
    v_mfma_f32_32x32x16_bf16 v[80:95], a[144:147], v[64:67], v[80:95]
    buffer_store_dwordx4 v[152:155], v5, s[28:31], s72 offen sc1
    v_cvt_pk_bf16_f32 v70, v44, v45
    v_cvt_pk_bf16_f32 v71, v46, v47
    v_exp_f32 v48, v48
    v_exp_f32 v49, v49
    v_exp_f32 v50, v50
    v_exp_f32 v51, v51
    v_mfma_f32_32x32x16_bf16 v[32:47], a[32:35], v[18:21], 0
    v_mfma_f32_16x16x32_bf16 v[160:163], v[168:171], v[152:155], v[160:163]
    v_cvt_pk_bf16_f32 v72, v48, v49
    v_cvt_pk_bf16_f32 v73, v50, v51
    v_exp_f32 v52, v52
    v_exp_f32 v53, v53
    v_exp_f32 v54, v54
    v_exp_f32 v55, v55
    v_mfma_f32_32x32x8_bf16 v[32:47], a[80:81], v[22:23], v[32:47]
    v_cvt_pk_bf16_f32 v74, v52, v53
    v_cvt_pk_bf16_f32 v75, v54, v55
    v_exp_f32 v56, v56
    v_exp_f32 v57, v57
    v_exp_f32 v58, v58
    v_exp_f32 v59, v59
    v_mfma_f32_32x32x16_bf16 v[80:95], a[148:151], v[68:71], v[80:95]
    v_cvt_pk_bf16_f32 v76, v56, v57
    v_cvt_pk_bf16_f32 v77, v58, v59
    v_exp_f32 v60, v60
    v_exp_f32 v61, v61
    v_exp_f32 v62, v62
    v_exp_f32 v63, v63
    v_mfma_f32_32x32x16_bf16 v[80:95], a[152:155], v[72:75], v[80:95]
    buffer_store_dwordx4 v[156:159], v5, s[28:31], s73 offen sc1
    v_cvt_pk_bf16_f32 v78, v60, v61
    v_cvt_pk_bf16_f32 v79, v62, v63
    v_exp_f32 v32, v32
    v_exp_f32 v33, v33
    v_exp_f32 v34, v34
    v_exp_f32 v35, v35
    v_mfma_f32_32x32x16_bf16 v[48:63], a[36:39], v[18:21], 0
    v_mfma_f32_16x16x32_bf16 v[164:167], v[168:171], v[156:159], v[164:167]
    v_cvt_pk_bf16_f32 v64, v32, v33
    v_cvt_pk_bf16_f32 v65, v34, v35
    v_exp_f32 v36, v36
    v_exp_f32 v37, v37
    v_exp_f32 v38, v38
    v_exp_f32 v39, v39
    v_mfma_f32_32x32x8_bf16 v[48:63], a[82:83], v[22:23], v[48:63]
    v_cvt_pk_bf16_f32 v66, v36, v37
    v_cvt_pk_bf16_f32 v67, v38, v39
    v_exp_f32 v40, v40
    v_exp_f32 v41, v41
    v_exp_f32 v42, v42
    v_exp_f32 v43, v43
    v_mfma_f32_32x32x16_bf16 v[80:95], a[156:159], v[76:79], v[80:95]
    v_cvt_pk_bf16_f32 v68, v40, v41
    v_cvt_pk_bf16_f32 v69, v42, v43
    v_exp_f32 v44, v44
    v_exp_f32 v45, v45
    v_exp_f32 v46, v46
    v_exp_f32 v47, v47
    v_mfma_f32_32x32x16_bf16 v[96:111], a[160:163], v[64:67], v[80:95]
    v_cvt_pk_bf16_f32 v70, v44, v45
    v_cvt_pk_bf16_f32 v71, v46, v47
    v_exp_f32 v48, v48
    v_exp_f32 v49, v49
    v_exp_f32 v50, v50
    v_exp_f32 v51, v51
    v_mfma_f32_32x32x16_bf16 v[32:47], a[40:43], v[18:21], 0
    v_cvt_pk_bf16_f32 v72, v48, v49
    v_cvt_pk_bf16_f32 v73, v50, v51
    v_exp_f32 v52, v52
    v_exp_f32 v53, v53
    v_exp_f32 v54, v54
    v_exp_f32 v55, v55
    v_mfma_f32_32x32x8_bf16 v[32:47], a[84:85], v[22:23], v[32:47]
    v_cvt_pk_bf16_f32 v74, v52, v53
    v_cvt_pk_bf16_f32 v75, v54, v55
    v_exp_f32 v56, v56
    v_exp_f32 v57, v57
    v_exp_f32 v58, v58
    v_exp_f32 v59, v59
    v_mfma_f32_32x32x16_bf16 v[96:111], a[164:167], v[68:71], v[96:111]
    ds_read_b32 v249, v246 offset:7168
    v_cvt_pk_bf16_f32 v76, v56, v57
    v_cvt_pk_bf16_f32 v77, v58, v59
    v_exp_f32 v60, v60
    v_exp_f32 v61, v61
    v_exp_f32 v62, v62
    v_exp_f32 v63, v63
    v_mfma_f32_32x32x16_bf16 v[96:111], a[168:171], v[72:75], v[96:111]
    ds_read_b128 v[80:83], v246 offset:4096
    v_cvt_pk_bf16_f32 v78, v60, v61
    v_cvt_pk_bf16_f32 v79, v62, v63
    v_exp_f32 v32, v32
    v_exp_f32 v33, v33
    v_exp_f32 v34, v34
    v_exp_f32 v35, v35
    v_mfma_f32_32x32x16_bf16 v[48:63], a[44:47], v[18:21], 0
    ds_read_b128 v[84:87], v246 offset:5120
    v_cvt_pk_bf16_f32 v64, v32, v33
    v_cvt_pk_bf16_f32 v65, v34, v35
    v_exp_f32 v36, v36
    v_exp_f32 v37, v37
    v_exp_f32 v38, v38
    v_exp_f32 v39, v39
    v_mfma_f32_32x32x8_bf16 v[48:63], a[86:87], v[22:23], v[48:63]
    v_cvt_pk_bf16_f32 v66, v36, v37
    v_cvt_pk_bf16_f32 v67, v38, v39
    v_exp_f32 v40, v40
    v_exp_f32 v41, v41
    v_exp_f32 v42, v42
    v_exp_f32 v43, v43
    v_mfma_f32_32x32x16_bf16 v[96:111], a[172:175], v[76:79], v[96:111]
    ds_read_b128 v[88:91], v246 offset:6144
    v_cvt_pk_bf16_f32 v68, v40, v41
    v_cvt_pk_bf16_f32 v69, v42, v43
    v_exp_f32 v44, v44
    v_exp_f32 v45, v45
    v_exp_f32 v46, v46
    v_exp_f32 v47, v47
    v_mfma_f32_32x32x16_bf16 v[96:111], a[176:179], v[64:67], v[96:111]
    buffer_store_dword v160, v172, s[28:31], s74 offen sc1
    v_cvt_pk_bf16_f32 v70, v44, v45
    v_cvt_pk_bf16_f32 v71, v46, v47
    v_exp_f32 v48, v48
    v_exp_f32 v49, v49
    v_exp_f32 v50, v50
    v_exp_f32 v51, v51
    v_mfma_f32_32x32x16_bf16 v[32:47], a[48:51], v[18:21], 0
    buffer_store_dword v164, v172, s[28:31], s75 offen sc1
    v_cvt_pk_bf16_f32 v72, v48, v49
    v_cvt_pk_bf16_f32 v73, v50, v51
    v_exp_f32 v52, v52
    v_exp_f32 v53, v53
    v_exp_f32 v54, v54
    v_exp_f32 v55, v55
    v_mfma_f32_32x32x8_bf16 v[32:47], a[88:89], v[22:23], v[32:47]
    v_cvt_pk_bf16_f32 v74, v52, v53
    v_cvt_pk_bf16_f32 v75, v54, v55
    v_exp_f32 v56, v56
    v_exp_f32 v57, v57
    v_exp_f32 v58, v58
    v_exp_f32 v59, v59
    v_mfma_f32_32x32x16_bf16 v[96:111], a[180:183], v[68:71], v[96:111]
    s_lshl_b32 s61, s43, 2
    v_cvt_pk_bf16_f32 v76, v56, v57
    v_cvt_pk_bf16_f32 v77, v58, v59
    v_exp_f32 v60, v60
    v_exp_f32 v61, v61
    v_exp_f32 v62, v62
    v_exp_f32_e64 v63, v63
    v_mfma_f32_32x32x16_bf16 v[96:111], a[184:187], v[72:75], v[96:111]
    s_add_u32 s61, s61, s32
    v_cvt_pk_bf16_f32 v78, v60, v61
    v_cvt_pk_bf16_f32 v79, v62, v63
    v_exp_f32 v32, v32
    v_exp_f32 v33, v33
    v_exp_f32 v34, v34
    v_exp_f32_e64 v35, v35
    v_mfma_f32_32x32x16_bf16 v[48:63], a[52:55], v[18:21], 0
    s_mul_i32 s61, s61, 25600
    v_cvt_pk_bf16_f32 v64, v32, v33
    v_cvt_pk_bf16_f32 v65, v34, v35
    v_exp_f32 v36, v36
    v_exp_f32 v37, v37
    v_exp_f32 v38, v38
    v_exp_f32 v39, v39
    v_mfma_f32_32x32x8_bf16 v[48:63], a[90:91], v[22:23], v[48:63]
    v_cvt_pk_bf16_f32 v66, v36, v37
    v_cvt_pk_bf16_f32 v67, v38, v39
    v_exp_f32 v40, v40
    v_exp_f32 v41, v41
    v_exp_f32 v42, v42
    v_exp_f32 v43, v43
    v_mfma_f32_32x32x16_bf16 v[96:111], a[188:191], v[76:79], v[96:111]
    s_add_u32 s61, s61, 10223616
    v_cvt_pk_bf16_f32 v68, v40, v41
    v_cvt_pk_bf16_f32 v69, v42, v43
    v_exp_f32 v44, v44
    v_exp_f32 v45, v45
    v_exp_f32 v46, v46
    v_exp_f32 v47, v47
    v_mfma_f32_32x32x16_bf16 v[96:111], a[192:195], v[64:67], v[96:111]
    s_mul_i32 s62, s32, 25600
    v_cvt_pk_bf16_f32 v70, v44, v45
    v_cvt_pk_bf16_f32 v71, v46, v47
    v_exp_f32 v48, v48
    v_exp_f32 v49, v49
    v_exp_f32 v50, v50
    v_exp_f32 v51, v51
    v_mfma_f32_32x32x16_bf16 v[32:47], a[56:59], v[18:21], 0
    s_mov_b32 m0, s62
    v_cvt_pk_bf16_f32 v72, v48, v49
    v_cvt_pk_bf16_f32 v73, v50, v51
    v_exp_f32 v52, v52
    v_exp_f32 v53, v53
    v_exp_f32 v54, v54
    v_exp_f32_e64 v55, v55
    v_mfma_f32_32x32x8_bf16 v[32:47], a[92:93], v[22:23], v[32:47]
    v_cvt_pk_bf16_f32 v74, v52, v53
    v_cvt_pk_bf16_f32 v75, v54, v55
    v_exp_f32 v56, v56
    v_exp_f32 v57, v57
    v_exp_f32 v58, v58
    v_exp_f32 v59, v59
    v_mfma_f32_32x32x16_bf16 v[96:111], a[196:199], v[68:71], v[96:111]
    s_add_u32 s62, s62, s53
    v_cvt_pk_bf16_f32 v76, v56, v57
    v_cvt_pk_bf16_f32 v77, v58, v59
    v_exp_f32 v60, v60
    v_exp_f32 v61, v61
    v_exp_f32 v62, v62
    v_exp_f32_e64 v63, v63
    v_mfma_f32_32x32x16_bf16 v[96:111], a[200:203], v[72:75], v[96:111]
    s_mul_i32 s37, s32, 10240
    v_cvt_pk_bf16_f32 v78, v60, v61
    v_cvt_pk_bf16_f32 v79, v62, v63
    v_exp_f32 v32, v32
    v_exp_f32 v33, v33
    v_exp_f32 v34, v34
    v_exp_f32 v35, v35
    v_mfma_f32_32x32x16_bf16 v[48:63], a[60:63], v[18:21], 0
    ds_read2_b64 v[18:21], v11 offset0:1 offset1:9
    s_add_u32 s37, s37, s53
    v_cvt_pk_bf16_f32 v64, v32, v33
    v_cvt_pk_bf16_f32 v65, v34, v35
    v_exp_f32 v36, v36
    v_exp_f32 v37, v37
    v_exp_f32 v38, v38
    v_exp_f32_e64 v39, v39
    v_mfma_f32_32x32x8_bf16 v[48:63], a[94:95], v[22:23], v[48:63]
    s_add_u32 s37, s37, 102400
    v_cvt_pk_bf16_f32 v66, v36, v37
    v_cvt_pk_bf16_f32 v67, v38, v39
    v_exp_f32 v40, v40
    v_exp_f32 v41, v41
    v_exp_f32 v42, v42
    v_exp_f32 v43, v43
    v_mfma_f32_32x32x16_bf16 v[96:111], a[204:207], v[76:79], v[96:111]
    ds_read_b64 v[22:23], v12 offset:8
    s_mul_i32 s38, s48, 3584
    v_cvt_pk_bf16_f32 v68, v40, v41
    v_cvt_pk_bf16_f32 v69, v42, v43
    v_exp_f32 v44, v44
    v_exp_f32 v45, v45
    v_exp_f32 v46, v46
    v_exp_f32 v47, v47
    v_mfma_f32_32x32x16_bf16 v[96:111], a[208:211], v[64:67], v[96:111]
    s_waitcnt lgkmcnt(1)
    s_add_u32 s38, s38, 7471104
    v_cvt_pk_bf16_f32 v70, v44, v45
    v_cvt_pk_bf16_f32 v71, v46, v47
    v_exp_f32 v48, v48
    v_exp_f32 v49, v49
    v_exp_f32 v50, v50
    v_exp_f32_e64 v51, v51
    v_mfma_f32_32x32x16_bf16 v[32:47], a[0:3], v[18:21], 0
    s_waitcnt lgkmcnt(0)
    s_lshr_b32 s58, s33, 3
    v_cvt_pk_bf16_f32 v72, v48, v49
    v_cvt_pk_bf16_f32 v73, v50, v51
    v_exp_f32 v52, v52
    v_exp_f32 v53, v53
    v_exp_f32 v54, v54
    v_exp_f32 v55, v55
    v_mfma_f32_32x32x8_bf16 v[32:47], a[64:65], v[22:23], v[32:47]
    v_cmp_ne_u32 vcc, v249, v5
    s_lshl_b32 s58, s58, 11
    v_cvt_pk_bf16_f32 v74, v52, v53
    v_cvt_pk_bf16_f32 v75, v54, v55
    v_exp_f32 v56, v56
    v_exp_f32 v57, v57
    v_exp_f32 v58, v58
    v_exp_f32 v59, v59
    v_mfma_f32_32x32x16_bf16 v[96:111], a[212:215], v[68:71], v[96:111]
    s_cbranch_vccnz CH_2
CR_2:
    s_add_u32 s58, s58, s55
    v_cvt_pk_bf16_f32 v76, v56, v57
    v_cvt_pk_bf16_f32 v77, v58, v59
    v_exp_f32 v60, v60
    v_exp_f32 v61, v61
    v_exp_f32 v62, v62
    v_exp_f32 v63, v63
    v_mfma_f32_32x32x16_bf16 v[96:111], a[216:219], v[72:75], v[96:111]
    buffer_load_dword v242, v112, s[28:31], s78 offen sc1
    v_cvt_pk_bf16_f32 v78, v60, v61
    v_cvt_pk_bf16_f32 v79, v62, v63
    v_exp_f32 v32, v32
    v_exp_f32 v33, v33
    v_exp_f32 v34, v34
    v_exp_f32 v35, v35
    v_mfma_f32_32x32x16_bf16 v[48:63], a[4:7], v[18:21], 0
    v_cvt_pk_bf16_f32 v64, v32, v33
    v_cvt_pk_bf16_f32 v65, v34, v35
    v_exp_f32 v36, v36
    v_exp_f32 v37, v37
    v_exp_f32 v38, v38
    v_exp_f32 v39, v39
    v_mfma_f32_32x32x8_bf16 v[48:63], a[66:67], v[22:23], v[48:63]
    v_cvt_pk_bf16_f32 v66, v36, v37
    v_cvt_pk_bf16_f32 v67, v38, v39
    v_exp_f32 v40, v40
    v_exp_f32 v41, v41
    v_exp_f32 v42, v42
    v_exp_f32 v43, v43
    v_mfma_f32_32x32x16_bf16 v[96:111], a[220:223], v[76:79], v[96:111]
    v_cvt_pk_bf16_f32 v68, v40, v41
    v_cvt_pk_bf16_f32 v69, v42, v43
    v_exp_f32 v44, v44
    v_exp_f32 v45, v45
    v_exp_f32 v46, v46
    v_exp_f32 v47, v47
    v_mfma_f32_32x32x16_bf16 v[80:95], a[96:99], v[64:67], v[80:95]
    v_cvt_pk_bf16_f32 v70, v44, v45
    v_cvt_pk_bf16_f32 v71, v46, v47
    v_exp_f32 v48, v48
    v_exp_f32 v49, v49
    v_exp_f32 v50, v50
    v_exp_f32 v51, v51
    v_mfma_f32_32x32x16_bf16 v[32:47], a[8:11], v[18:21], 0
    v_cvt_pk_bf16_f32 v72, v48, v49
    v_cvt_pk_bf16_f32 v73, v50, v51
    v_exp_f32 v52, v52
    v_exp_f32 v53, v53
    v_exp_f32 v54, v54
    v_exp_f32 v55, v55
    v_mfma_f32_32x32x8_bf16 v[32:47], a[68:69], v[22:23], v[32:47]
    v_cvt_pk_bf16_f32 v74, v52, v53
    v_cvt_pk_bf16_f32 v75, v54, v55
    v_exp_f32 v56, v56
    v_exp_f32 v57, v57
    v_exp_f32 v58, v58
    v_exp_f32 v59, v59
    v_mfma_f32_32x32x16_bf16 v[80:95], a[100:103], v[68:71], v[80:95]
    v_cvt_pk_bf16_f32 v76, v56, v57
    v_cvt_pk_bf16_f32 v77, v58, v59
    v_exp_f32 v60, v60
    v_exp_f32 v61, v61
    v_exp_f32 v62, v62
    v_exp_f32 v63, v63
    v_mfma_f32_32x32x16_bf16 v[80:95], a[104:107], v[72:75], v[80:95]
    ds_write_b128 v246, v[96:99] offset:0
    v_cvt_pk_bf16_f32 v78, v60, v61
    v_cvt_pk_bf16_f32 v79, v62, v63
    v_exp_f32 v32, v32
    v_exp_f32 v33, v33
    v_exp_f32 v34, v34
    v_exp_f32 v35, v35
    v_mfma_f32_32x32x16_bf16 v[48:63], a[12:15], v[18:21], 0
    ds_write_b128 v246, v[100:103] offset:1024
    v_cvt_pk_bf16_f32 v64, v32, v33
    v_cvt_pk_bf16_f32 v65, v34, v35
    v_exp_f32 v36, v36
    v_exp_f32 v37, v37
    v_exp_f32 v38, v38
    v_exp_f32 v39, v39
    v_mfma_f32_32x32x8_bf16 v[48:63], a[70:71], v[22:23], v[48:63]
    v_cvt_pk_bf16_f32 v66, v36, v37
    v_cvt_pk_bf16_f32 v67, v38, v39
    v_exp_f32 v40, v40
    v_exp_f32 v41, v41
    v_exp_f32 v42, v42
    v_exp_f32 v43, v43
    v_mfma_f32_32x32x16_bf16 v[80:95], a[108:111], v[76:79], v[80:95]
    ds_write_b128 v246, v[104:107] offset:2048
    v_cvt_pk_bf16_f32 v68, v40, v41
    v_cvt_pk_bf16_f32 v69, v42, v43
    v_exp_f32 v44, v44
    v_exp_f32 v45, v45
    v_exp_f32 v46, v46
    v_exp_f32 v47, v47
    v_mfma_f32_32x32x16_bf16 v[80:95], a[112:115], v[64:67], v[80:95]
    ds_write_b32 v246, v7 offset:3072
    v_cvt_pk_bf16_f32 v70, v44, v45
    v_cvt_pk_bf16_f32 v71, v46, v47
    v_exp_f32 v48, v48
    v_exp_f32 v49, v49
    v_exp_f32 v50, v50
    v_exp_f32 v51, v51
    v_mfma_f32_32x32x16_bf16 v[32:47], a[16:19], v[18:21], 0
    buffer_load_dword v242, v113, s[24:27], s79 offen sc1
    v_cvt_pk_bf16_f32 v72, v48, v49
    v_cvt_pk_bf16_f32 v73, v50, v51
    v_exp_f32 v52, v52
    v_exp_f32 v53, v53
    v_exp_f32 v54, v54
    v_exp_f32 v55, v55
    v_mfma_f32_32x32x8_bf16 v[32:47], a[72:73], v[22:23], v[32:47]
    v_cvt_pk_bf16_f32 v74, v52, v53
    v_cvt_pk_bf16_f32 v75, v54, v55
    v_exp_f32 v56, v56
    v_exp_f32 v57, v57
    v_exp_f32 v58, v58
    v_exp_f32 v59, v59
    v_mfma_f32_32x32x16_bf16 v[80:95], a[116:119], v[68:71], v[80:95]
    buffer_load_dword v242, v117, s[28:31], s80 offen sc1
    v_cvt_pk_bf16_f32 v76, v56, v57
    v_cvt_pk_bf16_f32 v77, v58, v59
    v_exp_f32 v60, v60
    v_exp_f32 v61, v61
    v_exp_f32 v62, v62
    v_exp_f32 v63, v63
    v_mfma_f32_32x32x16_bf16 v[80:95], a[120:123], v[72:75], v[80:95]
    buffer_load_ushort v253, v115, s[20:23], 0 offen
    v_cvt_pk_bf16_f32 v78, v60, v61
    v_cvt_pk_bf16_f32 v79, v62, v63
    v_exp_f32 v32, v32
    v_exp_f32 v33, v33
    v_exp_f32 v34, v34
    v_exp_f32 v35, v35
    v_mfma_f32_32x32x16_bf16 v[48:63], a[20:23], v[18:21], 0
    v_cvt_pk_bf16_f32 v64, v32, v33
    v_cvt_pk_bf16_f32 v65, v34, v35
    v_exp_f32 v36, v36
    v_exp_f32 v37, v37
    v_exp_f32 v38, v38
    v_exp_f32 v39, v39
    v_mfma_f32_32x32x8_bf16 v[48:63], a[74:75], v[22:23], v[48:63]
    v_cvt_pk_bf16_f32 v66, v36, v37
    v_cvt_pk_bf16_f32 v67, v38, v39
    v_exp_f32 v40, v40
    v_exp_f32 v41, v41
    v_exp_f32 v42, v42
    v_exp_f32 v43, v43
    v_mfma_f32_32x32x16_bf16 v[80:95], a[124:127], v[76:79], v[80:95]
    v_cvt_pk_bf16_f32 v68, v40, v41
    v_cvt_pk_bf16_f32 v69, v42, v43
    v_exp_f32 v44, v44
    v_exp_f32 v45, v45
    v_exp_f32 v46, v46
    v_exp_f32 v47, v47
    v_mfma_f32_32x32x16_bf16 v[80:95], a[128:131], v[64:67], v[80:95]
    s_waitcnt vmcnt(4)
    v_cvt_pk_bf16_f32 v70, v44, v45
    v_cvt_pk_bf16_f32 v71, v46, v47
    v_exp_f32 v48, v48
    v_exp_f32 v49, v49
    v_exp_f32 v50, v50
    v_exp_f32_e64 v51, v51
    v_mfma_f32_32x32x16_bf16 v[32:47], a[24:27], v[18:21], 0
    buffer_atomic_add v241, v117, s[28:31], s39 offen sc1
    v_cvt_pk_bf16_f32 v72, v48, v49
    v_cvt_pk_bf16_f32 v73, v50, v51
    v_exp_f32 v52, v52
    v_exp_f32 v53, v53
    v_exp_f32 v54, v54
    v_exp_f32 v55, v55
    v_mfma_f32_32x32x8_bf16 v[32:47], a[76:77], v[22:23], v[32:47]
    v_cvt_pk_bf16_f32 v74, v52, v53
    v_cvt_pk_bf16_f32 v75, v54, v55
    v_exp_f32 v56, v56
    v_exp_f32 v57, v57
    v_exp_f32 v58, v58
    v_exp_f32 v59, v59
    v_mfma_f32_32x32x16_bf16 v[80:95], a[132:135], v[68:71], v[80:95]
    v_cvt_pk_bf16_f32 v76, v56, v57
    v_cvt_pk_bf16_f32 v77, v58, v59
    v_exp_f32 v60, v60
    v_exp_f32 v61, v61
    v_exp_f32 v62, v62
    v_exp_f32 v63, v63
    v_mfma_f32_32x32x16_bf16 v[80:95], a[136:139], v[72:75], v[80:95]
    v_cvt_pk_bf16_f32 v78, v60, v61
    v_cvt_pk_bf16_f32 v79, v62, v63
    v_exp_f32 v32, v32
    v_exp_f32 v33, v33
    v_exp_f32 v34, v34
    v_exp_f32 v35, v35
    v_mfma_f32_32x32x16_bf16 v[48:63], a[28:31], v[18:21], 0
    v_cvt_pk_bf16_f32 v64, v32, v33
    v_cvt_pk_bf16_f32 v65, v34, v35
    v_exp_f32 v36, v36
    v_exp_f32 v37, v37
    v_exp_f32 v38, v38
    v_exp_f32 v39, v39
    v_mfma_f32_32x32x8_bf16 v[48:63], a[78:79], v[22:23], v[48:63]
    v_cvt_pk_bf16_f32 v66, v36, v37
    v_cvt_pk_bf16_f32 v67, v38, v39
    v_exp_f32 v40, v40
    v_exp_f32 v41, v41
    v_exp_f32 v42, v42
    v_exp_f32 v43, v43
    v_mfma_f32_32x32x16_bf16 v[80:95], a[140:143], v[76:79], v[80:95]
    v_cvt_pk_bf16_f32 v68, v40, v41
    v_cvt_pk_bf16_f32 v69, v42, v43
    v_exp_f32 v44, v44
    v_exp_f32 v45, v45
    v_exp_f32 v46, v46
    v_exp_f32 v47, v47
    v_mfma_f32_32x32x16_bf16 v[80:95], a[144:147], v[64:67], v[80:95]
    v_cvt_pk_bf16_f32 v70, v44, v45
    v_cvt_pk_bf16_f32 v71, v46, v47
    v_exp_f32 v48, v48
    v_exp_f32 v49, v49
    v_exp_f32 v50, v50
    v_exp_f32 v51, v51
    v_mfma_f32_32x32x16_bf16 v[32:47], a[32:35], v[18:21], 0
    v_cvt_pk_bf16_f32 v72, v48, v49
    v_cvt_pk_bf16_f32 v73, v50, v51
    v_exp_f32 v52, v52
    v_exp_f32 v53, v53
    v_exp_f32 v54, v54
    v_exp_f32 v55, v55
    v_mfma_f32_32x32x8_bf16 v[32:47], a[80:81], v[22:23], v[32:47]
    v_cvt_pk_bf16_f32 v74, v52, v53
    v_cvt_pk_bf16_f32 v75, v54, v55
    v_exp_f32 v56, v56
    v_exp_f32 v57, v57
    v_exp_f32 v58, v58
    v_exp_f32 v59, v59
    v_mfma_f32_32x32x16_bf16 v[80:95], a[148:151], v[68:71], v[80:95]
    v_cvt_pk_bf16_f32 v76, v56, v57
    v_cvt_pk_bf16_f32 v77, v58, v59
    v_exp_f32 v60, v60
    v_exp_f32 v61, v61
    v_exp_f32 v62, v62
    v_exp_f32 v63, v63
    v_mfma_f32_32x32x16_bf16 v[80:95], a[152:155], v[72:75], v[80:95]
    v_cvt_pk_bf16_f32 v78, v60, v61
    v_cvt_pk_bf16_f32 v79, v62, v63
    v_exp_f32 v32, v32
    v_exp_f32 v33, v33
    v_exp_f32 v34, v34
    v_exp_f32 v35, v35
    v_mfma_f32_32x32x16_bf16 v[48:63], a[36:39], v[18:21], 0
    v_cvt_pk_bf16_f32 v64, v32, v33
    v_cvt_pk_bf16_f32 v65, v34, v35
    v_exp_f32 v36, v36
    v_exp_f32 v37, v37
    v_exp_f32 v38, v38
    v_exp_f32 v39, v39
    v_mfma_f32_32x32x8_bf16 v[48:63], a[82:83], v[22:23], v[48:63]
    v_cvt_pk_bf16_f32 v66, v36, v37
    v_cvt_pk_bf16_f32 v67, v38, v39
    v_exp_f32 v40, v40
    v_exp_f32 v41, v41
    v_exp_f32 v42, v42
    v_exp_f32 v43, v43
    v_mfma_f32_32x32x16_bf16 v[80:95], a[156:159], v[76:79], v[80:95]
    v_cvt_pk_bf16_f32 v68, v40, v41
    v_cvt_pk_bf16_f32 v69, v42, v43
    v_exp_f32 v44, v44
    v_exp_f32 v45, v45
    v_exp_f32 v46, v46
    v_exp_f32 v47, v47
    v_mfma_f32_32x32x16_bf16 v[96:111], a[160:163], v[64:67], v[80:95]
    v_cvt_pk_bf16_f32 v70, v44, v45
    v_cvt_pk_bf16_f32 v71, v46, v47
    v_exp_f32 v48, v48
    v_exp_f32 v49, v49
    v_exp_f32 v50, v50
    v_exp_f32 v51, v51
    v_mfma_f32_32x32x16_bf16 v[32:47], a[40:43], v[18:21], 0
    v_cvt_pk_bf16_f32 v72, v48, v49
    v_cvt_pk_bf16_f32 v73, v50, v51
    v_exp_f32 v52, v52
    v_exp_f32 v53, v53
    v_exp_f32 v54, v54
    v_exp_f32 v55, v55
    v_mfma_f32_32x32x8_bf16 v[32:47], a[84:85], v[22:23], v[32:47]
    v_cvt_pk_bf16_f32 v74, v52, v53
    v_cvt_pk_bf16_f32 v75, v54, v55
    v_exp_f32 v56, v56
    v_exp_f32 v57, v57
    v_exp_f32 v58, v58
    v_exp_f32 v59, v59
    v_mfma_f32_32x32x16_bf16 v[96:111], a[164:167], v[68:71], v[96:111]
    ds_read_b32 v249, v247 offset:3072
    v_cvt_pk_bf16_f32 v76, v56, v57
    v_cvt_pk_bf16_f32 v77, v58, v59
    v_exp_f32 v60, v60
    v_exp_f32 v61, v61
    v_exp_f32 v62, v62
    v_exp_f32 v63, v63
    v_mfma_f32_32x32x16_bf16 v[96:111], a[168:171], v[72:75], v[96:111]
    ds_read_b128 v[80:83], v247 offset:0
    v_cvt_pk_bf16_f32 v78, v60, v61
    v_cvt_pk_bf16_f32 v79, v62, v63
    v_exp_f32 v32, v32
    v_exp_f32 v33, v33
    v_exp_f32 v34, v34
    v_exp_f32 v35, v35
    v_mfma_f32_32x32x16_bf16 v[48:63], a[44:47], v[18:21], 0
    ds_read_b128 v[84:87], v247 offset:1024
    v_cvt_pk_bf16_f32 v64, v32, v33
    v_cvt_pk_bf16_f32 v65, v34, v35
    v_exp_f32 v36, v36
    v_exp_f32 v37, v37
    v_exp_f32 v38, v38
    v_exp_f32 v39, v39
    v_mfma_f32_32x32x8_bf16 v[48:63], a[86:87], v[22:23], v[48:63]
    v_cvt_pk_bf16_f32 v66, v36, v37
    v_cvt_pk_bf16_f32 v67, v38, v39
    v_exp_f32 v40, v40
    v_exp_f32 v41, v41
    v_exp_f32 v42, v42
    v_exp_f32 v43, v43
    v_mfma_f32_32x32x16_bf16 v[96:111], a[172:175], v[76:79], v[96:111]
    ds_read_b128 v[88:91], v247 offset:2048
    v_cvt_pk_bf16_f32 v68, v40, v41
    v_cvt_pk_bf16_f32 v69, v42, v43
    v_exp_f32 v44, v44
    v_exp_f32 v45, v45
    v_exp_f32 v46, v46
    v_exp_f32 v47, v47
    v_mfma_f32_32x32x16_bf16 v[96:111], a[176:179], v[64:67], v[96:111]
    v_cvt_pk_bf16_f32 v70, v44, v45
    v_cvt_pk_bf16_f32 v71, v46, v47
    v_exp_f32 v48, v48
    v_exp_f32 v49, v49
    v_exp_f32 v50, v50
    v_exp_f32 v51, v51
    v_mfma_f32_32x32x16_bf16 v[32:47], a[48:51], v[18:21], 0
    v_cvt_pk_bf16_f32 v72, v48, v49
    v_cvt_pk_bf16_f32 v73, v50, v51
    v_exp_f32 v52, v52
    v_exp_f32 v53, v53
    v_exp_f32 v54, v54
    v_exp_f32 v55, v55
    v_mfma_f32_32x32x8_bf16 v[32:47], a[88:89], v[22:23], v[32:47]
    v_cvt_pk_bf16_f32 v74, v52, v53
    v_cvt_pk_bf16_f32 v75, v54, v55
    v_exp_f32 v56, v56
    v_exp_f32 v57, v57
    v_exp_f32 v58, v58
    v_exp_f32 v59, v59
    v_mfma_f32_32x32x16_bf16 v[96:111], a[180:183], v[68:71], v[96:111]
    v_cvt_pk_bf16_f32 v76, v56, v57
    v_cvt_pk_bf16_f32 v77, v58, v59
    v_exp_f32 v60, v60
    v_exp_f32 v61, v61
    v_exp_f32 v62, v62
    v_exp_f32 v63, v63
    v_mfma_f32_32x32x16_bf16 v[96:111], a[184:187], v[72:75], v[96:111]
    v_cvt_pk_bf16_f32 v78, v60, v61
    v_cvt_pk_bf16_f32 v79, v62, v63
    v_exp_f32 v32, v32
    v_exp_f32 v33, v33
    v_exp_f32 v34, v34
    v_exp_f32 v35, v35
    v_mfma_f32_32x32x16_bf16 v[48:63], a[52:55], v[18:21], 0
    v_cvt_pk_bf16_f32 v64, v32, v33
    v_cvt_pk_bf16_f32 v65, v34, v35
    v_exp_f32 v36, v36
    v_exp_f32 v37, v37
    v_exp_f32 v38, v38
    v_exp_f32 v39, v39
    v_mfma_f32_32x32x8_bf16 v[48:63], a[90:91], v[22:23], v[48:63]
    v_cvt_pk_bf16_f32 v66, v36, v37
    v_cvt_pk_bf16_f32 v67, v38, v39
    v_exp_f32 v40, v40
    v_exp_f32 v41, v41
    v_exp_f32 v42, v42
    v_exp_f32 v43, v43
    v_mfma_f32_32x32x16_bf16 v[96:111], a[188:191], v[76:79], v[96:111]
    v_cvt_pk_bf16_f32 v68, v40, v41
    v_cvt_pk_bf16_f32 v69, v42, v43
    v_exp_f32 v44, v44
    v_exp_f32 v45, v45
    v_exp_f32 v46, v46
    v_exp_f32 v47, v47
    v_mfma_f32_32x32x16_bf16 v[96:111], a[192:195], v[64:67], v[96:111]
    v_cvt_pk_bf16_f32 v70, v44, v45
    v_cvt_pk_bf16_f32 v71, v46, v47
    v_exp_f32 v48, v48
    v_exp_f32 v49, v49
    v_exp_f32 v50, v50
    v_exp_f32 v51, v51
    v_mfma_f32_32x32x16_bf16 v[32:47], a[56:59], v[18:21], 0
    v_cvt_pk_bf16_f32 v72, v48, v49
    v_cvt_pk_bf16_f32 v73, v50, v51
    v_exp_f32 v52, v52
    v_exp_f32 v53, v53
    v_exp_f32 v54, v54
    v_exp_f32 v55, v55
    v_mfma_f32_32x32x8_bf16 v[32:47], a[92:93], v[22:23], v[32:47]
    v_cvt_pk_bf16_f32 v74, v52, v53
    v_cvt_pk_bf16_f32 v75, v54, v55
    v_exp_f32 v56, v56
    v_exp_f32 v57, v57
    v_exp_f32 v58, v58
    v_exp_f32 v59, v59
    v_mfma_f32_32x32x16_bf16 v[96:111], a[196:199], v[68:71], v[96:111]
    v_cvt_pk_bf16_f32 v76, v56, v57
    v_cvt_pk_bf16_f32 v77, v58, v59
    v_exp_f32 v60, v60
    v_exp_f32 v61, v61
    v_exp_f32 v62, v62
    v_exp_f32 v63, v63
    v_mfma_f32_32x32x16_bf16 v[96:111], a[200:203], v[72:75], v[96:111]
    v_cvt_pk_bf16_f32 v78, v60, v61
    v_cvt_pk_bf16_f32 v79, v62, v63
    v_exp_f32 v32, v32
    v_exp_f32 v33, v33
    v_exp_f32 v34, v34
    v_exp_f32 v35, v35
    v_mfma_f32_32x32x16_bf16 v[48:63], a[60:63], v[18:21], 0
    ds_read2_b64 v[18:21], v130 offset0:0 offset1:8
    v_cvt_pk_bf16_f32 v64, v32, v33
    v_cvt_pk_bf16_f32 v65, v34, v35
    v_exp_f32 v36, v36
    v_exp_f32 v37, v37
    v_exp_f32 v38, v38
    v_exp_f32 v39, v39
    v_mfma_f32_32x32x8_bf16 v[48:63], a[94:95], v[22:23], v[48:63]
    v_cvt_pk_bf16_f32 v66, v36, v37
    v_cvt_pk_bf16_f32 v67, v38, v39
    v_exp_f32 v40, v40
    v_exp_f32 v41, v41
    v_exp_f32 v42, v42
    v_exp_f32 v43, v43
    v_mfma_f32_32x32x16_bf16 v[96:111], a[204:207], v[76:79], v[96:111]
    ds_read_b64 v[22:23], v254 offset:0
    v_cvt_pk_bf16_f32 v68, v40, v41
    v_cvt_pk_bf16_f32 v69, v42, v43
    v_exp_f32 v44, v44
    v_exp_f32 v45, v45
    v_exp_f32 v46, v46
    v_exp_f32 v47, v47
    v_mfma_f32_32x32x16_bf16 v[96:111], a[208:211], v[64:67], v[96:111]
    s_waitcnt lgkmcnt(1)
    v_cvt_pk_bf16_f32 v70, v44, v45
    v_cvt_pk_bf16_f32 v71, v46, v47
    v_exp_f32 v48, v48
    v_exp_f32 v49, v49
    v_exp_f32 v50, v50
    v_exp_f32_e64 v51, v51
    v_mfma_f32_32x32x16_bf16 v[32:47], a[0:3], v[18:21], 0
    s_waitcnt lgkmcnt(0)
    v_cvt_pk_bf16_f32 v72, v48, v49
    v_cvt_pk_bf16_f32 v73, v50, v51
    v_exp_f32 v52, v52
    v_exp_f32 v53, v53
    v_exp_f32 v54, v54
    v_exp_f32_e64 v55, v55
    v_mfma_f32_32x32x8_bf16 v[32:47], a[64:65], v[22:23], v[32:47]
    v_cmp_ne_u32_e64 vcc, v249, v7
    v_cvt_pk_bf16_f32 v74, v52, v53
    v_cvt_pk_bf16_f32 v75, v54, v55
    v_exp_f32 v56, v56
    v_exp_f32 v57, v57
    v_exp_f32 v58, v58
    v_exp_f32 v59, v59
    v_mfma_f32_32x32x16_bf16 v[96:111], a[212:215], v[68:71], v[96:111]
    s_cbranch_vccnz CH_3
CR_3:
    v_cvt_pk_bf16_f32 v76, v56, v57
    v_cvt_pk_bf16_f32 v77, v58, v59
    v_exp_f32 v60, v60
    v_exp_f32 v61, v61
    v_exp_f32 v62, v62
    v_exp_f32_e64 v63, v63
    v_mfma_f32_32x32x16_bf16 v[96:111], a[216:219], v[72:75], v[96:111]
    v_cvt_pk_bf16_f32 v78, v60, v61
    v_cvt_pk_bf16_f32 v79, v62, v63
    v_exp_f32 v32, v32
    v_exp_f32 v33, v33
    v_exp_f32 v34, v34
    v_exp_f32 v35, v35
    v_mfma_f32_32x32x16_bf16 v[48:63], a[4:7], v[18:21], 0
    v_cvt_pk_bf16_f32 v64, v32, v33
    v_cvt_pk_bf16_f32 v65, v34, v35
    v_exp_f32 v36, v36
    v_exp_f32 v37, v37
    v_exp_f32 v38, v38
    v_exp_f32 v39, v39
    v_mfma_f32_32x32x8_bf16 v[48:63], a[66:67], v[22:23], v[48:63]
    v_cvt_pk_bf16_f32 v66, v36, v37
    v_cvt_pk_bf16_f32 v67, v38, v39
    v_exp_f32 v40, v40
    v_exp_f32 v41, v41
    v_exp_f32 v42, v42
    v_exp_f32 v43, v43
    v_mfma_f32_32x32x16_bf16 v[96:111], a[220:223], v[76:79], v[96:111]
    v_cvt_pk_bf16_f32 v68, v40, v41
    v_cvt_pk_bf16_f32 v69, v42, v43
    v_exp_f32 v44, v44
    v_exp_f32 v45, v45
    v_exp_f32 v46, v46
    v_exp_f32 v47, v47
    v_mfma_f32_32x32x16_bf16 v[80:95], a[96:99], v[64:67], v[80:95]
    v_cvt_pk_bf16_f32 v70, v44, v45
    v_cvt_pk_bf16_f32 v71, v46, v47
    v_exp_f32 v48, v48
    v_exp_f32 v49, v49
    v_exp_f32 v50, v50
    v_exp_f32 v51, v51
    v_mfma_f32_32x32x16_bf16 v[32:47], a[8:11], v[18:21], 0
    v_cvt_pk_bf16_f32 v72, v48, v49
    v_cvt_pk_bf16_f32 v73, v50, v51
    v_exp_f32 v52, v52
    v_exp_f32 v53, v53
    v_exp_f32 v54, v54
    v_exp_f32 v55, v55
    v_mfma_f32_32x32x8_bf16 v[32:47], a[68:69], v[22:23], v[32:47]
    v_cvt_pk_bf16_f32 v74, v52, v53
    v_cvt_pk_bf16_f32 v75, v54, v55
    v_exp_f32 v56, v56
    v_exp_f32 v57, v57
    v_exp_f32 v58, v58
    v_exp_f32 v59, v59
    v_mfma_f32_32x32x16_bf16 v[80:95], a[100:103], v[68:71], v[80:95]
    v_cvt_pk_bf16_f32 v76, v56, v57
    v_cvt_pk_bf16_f32 v77, v58, v59
    v_exp_f32 v60, v60
    v_exp_f32 v61, v61
    v_exp_f32 v62, v62
    v_exp_f32 v63, v63
    v_mfma_f32_32x32x16_bf16 v[80:95], a[104:107], v[72:75], v[80:95]
    ds_write_b128 v246, v[96:99] offset:4096
    v_cvt_pk_bf16_f32 v78, v60, v61
    v_cvt_pk_bf16_f32 v79, v62, v63
    v_exp_f32 v32, v32
    v_exp_f32 v33, v33
    v_exp_f32 v34, v34
    v_exp_f32 v35, v35
    v_mfma_f32_32x32x16_bf16 v[48:63], a[12:15], v[18:21], 0
    ds_write_b128 v246, v[100:103] offset:5120
    v_cvt_pk_bf16_f32 v64, v32, v33
    v_cvt_pk_bf16_f32 v65, v34, v35
    v_exp_f32 v36, v36
    v_exp_f32 v37, v37
    v_exp_f32 v38, v38
    v_exp_f32 v39, v39
    v_mfma_f32_32x32x8_bf16 v[48:63], a[70:71], v[22:23], v[48:63]
    v_cvt_pk_bf16_f32 v66, v36, v37
    v_cvt_pk_bf16_f32 v67, v38, v39
    v_exp_f32 v40, v40
    v_exp_f32 v41, v41
    v_exp_f32 v42, v42
    v_exp_f32 v43, v43
    v_mfma_f32_32x32x16_bf16 v[80:95], a[108:111], v[76:79], v[80:95]
    ds_write_b128 v246, v[104:107] offset:6144
    v_cvt_pk_bf16_f32 v68, v40, v41
    v_cvt_pk_bf16_f32 v69, v42, v43
    v_exp_f32 v44, v44
    v_exp_f32 v45, v45
    v_exp_f32 v46, v46
    v_exp_f32 v47, v47
    v_mfma_f32_32x32x16_bf16 v[80:95], a[112:115], v[64:67], v[80:95]
    ds_write_b32 v246, v7 offset:7168
    v_cvt_pk_bf16_f32 v70, v44, v45
    v_cvt_pk_bf16_f32 v71, v46, v47
    v_exp_f32 v48, v48
    v_exp_f32 v49, v49
    v_exp_f32 v50, v50
    v_exp_f32 v51, v51
    v_mfma_f32_32x32x16_bf16 v[32:47], a[16:19], v[18:21], 0
    v_cvt_pk_bf16_f32 v72, v48, v49
    v_cvt_pk_bf16_f32 v73, v50, v51
    v_exp_f32 v52, v52
    v_exp_f32 v53, v53
    v_exp_f32 v54, v54
    v_exp_f32 v55, v55
    v_mfma_f32_32x32x8_bf16 v[32:47], a[72:73], v[22:23], v[32:47]
    v_cvt_pk_bf16_f32 v74, v52, v53
    v_cvt_pk_bf16_f32 v75, v54, v55
    v_exp_f32 v56, v56
    v_exp_f32 v57, v57
    v_exp_f32 v58, v58
    v_exp_f32 v59, v59
    v_mfma_f32_32x32x16_bf16 v[80:95], a[116:119], v[68:71], v[80:95]
    v_cvt_pk_bf16_f32 v76, v56, v57
    v_cvt_pk_bf16_f32 v77, v58, v59
    v_exp_f32 v60, v60
    v_exp_f32 v61, v61
    v_exp_f32 v62, v62
    v_exp_f32 v63, v63
    v_mfma_f32_32x32x16_bf16 v[80:95], a[120:123], v[72:75], v[80:95]
    v_cvt_pk_bf16_f32 v78, v60, v61
    v_cvt_pk_bf16_f32 v79, v62, v63
    v_exp_f32 v32, v32
    v_exp_f32 v33, v33
    v_exp_f32 v34, v34
    v_exp_f32 v35, v35
    v_mfma_f32_32x32x16_bf16 v[48:63], a[20:23], v[18:21], 0
    v_cvt_pk_bf16_f32 v64, v32, v33
    v_cvt_pk_bf16_f32 v65, v34, v35
    v_exp_f32 v36, v36
    v_exp_f32 v37, v37
    v_exp_f32 v38, v38
    v_exp_f32 v39, v39
    v_mfma_f32_32x32x8_bf16 v[48:63], a[74:75], v[22:23], v[48:63]
    v_cvt_pk_bf16_f32 v66, v36, v37
    v_cvt_pk_bf16_f32 v67, v38, v39
    v_exp_f32 v40, v40
    v_exp_f32 v41, v41
    v_exp_f32 v42, v42
    v_exp_f32 v43, v43
    v_mfma_f32_32x32x16_bf16 v[80:95], a[124:127], v[76:79], v[80:95]
    v_cvt_pk_bf16_f32 v68, v40, v41
    v_cvt_pk_bf16_f32 v69, v42, v43
    v_exp_f32 v44, v44
    v_exp_f32 v45, v45
    v_exp_f32 v46, v46
    v_exp_f32 v47, v47
    v_mfma_f32_32x32x16_bf16 v[80:95], a[128:131], v[64:67], v[80:95]
    v_cvt_pk_bf16_f32 v70, v44, v45
    v_cvt_pk_bf16_f32 v71, v46, v47
    v_exp_f32 v48, v48
    v_exp_f32 v49, v49
    v_exp_f32 v50, v50
    v_exp_f32 v51, v51
    v_mfma_f32_32x32x16_bf16 v[32:47], a[24:27], v[18:21], 0
    v_cvt_pk_bf16_f32 v72, v48, v49
    v_cvt_pk_bf16_f32 v73, v50, v51
    v_exp_f32 v52, v52
    v_exp_f32 v53, v53
    v_exp_f32 v54, v54
    v_exp_f32 v55, v55
    v_mfma_f32_32x32x8_bf16 v[32:47], a[76:77], v[22:23], v[32:47]
    v_cvt_pk_bf16_f32 v74, v52, v53
    v_cvt_pk_bf16_f32 v75, v54, v55
    v_exp_f32 v56, v56
    v_exp_f32 v57, v57
    v_exp_f32 v58, v58
    v_exp_f32 v59, v59
    v_mfma_f32_32x32x16_bf16 v[80:95], a[132:135], v[68:71], v[80:95]
    v_cvt_pk_bf16_f32 v76, v56, v57
    v_cvt_pk_bf16_f32 v77, v58, v59
    v_exp_f32 v60, v60
    v_exp_f32 v61, v61
    v_exp_f32 v62, v62
    v_exp_f32 v63, v63
    v_mfma_f32_32x32x16_bf16 v[80:95], a[136:139], v[72:75], v[80:95]
    v_cvt_pk_bf16_f32 v78, v60, v61
    v_cvt_pk_bf16_f32 v79, v62, v63
    v_exp_f32 v32, v32
    v_exp_f32 v33, v33
    v_exp_f32 v34, v34
    v_exp_f32 v35, v35
    v_mfma_f32_32x32x16_bf16 v[48:63], a[28:31], v[18:21], 0
    v_cvt_pk_bf16_f32 v64, v32, v33
    v_cvt_pk_bf16_f32 v65, v34, v35
    v_exp_f32 v36, v36
    v_exp_f32 v37, v37
    v_exp_f32 v38, v38
    v_exp_f32 v39, v39
    v_mfma_f32_32x32x8_bf16 v[48:63], a[78:79], v[22:23], v[48:63]
    v_cvt_pk_bf16_f32 v66, v36, v37
    v_cvt_pk_bf16_f32 v67, v38, v39
    v_exp_f32 v40, v40
    v_exp_f32 v41, v41
    v_exp_f32 v42, v42
    v_exp_f32 v43, v43
    v_mfma_f32_32x32x16_bf16 v[80:95], a[140:143], v[76:79], v[80:95]
    v_cvt_pk_bf16_f32 v68, v40, v41
    v_cvt_pk_bf16_f32 v69, v42, v43
    v_exp_f32 v44, v44
    v_exp_f32 v45, v45
    v_exp_f32 v46, v46
    v_exp_f32 v47, v47
    v_mfma_f32_32x32x16_bf16 v[80:95], a[144:147], v[64:67], v[80:95]
    buffer_load_dword v240, v118, s[28:31], 0 offen sc1
    v_cvt_pk_bf16_f32 v70, v44, v45
    v_cvt_pk_bf16_f32 v71, v46, v47
    v_exp_f32 v48, v48
    v_exp_f32 v49, v49
    v_exp_f32 v50, v50
    v_exp_f32 v51, v51
    v_mfma_f32_32x32x16_bf16 v[32:47], a[32:35], v[18:21], 0
    v_cvt_pk_bf16_f32 v72, v48, v49
    v_cvt_pk_bf16_f32 v73, v50, v51
    v_exp_f32 v52, v52
    v_exp_f32 v53, v53
    v_exp_f32 v54, v54
    v_exp_f32 v55, v55
    v_mfma_f32_32x32x8_bf16 v[32:47], a[80:81], v[22:23], v[32:47]
    v_cvt_pk_bf16_f32 v74, v52, v53
    v_cvt_pk_bf16_f32 v75, v54, v55
    v_exp_f32 v56, v56
    v_exp_f32 v57, v57
    v_exp_f32 v58, v58
    v_exp_f32 v59, v59
    v_mfma_f32_32x32x16_bf16 v[80:95], a[148:151], v[68:71], v[80:95]
    v_cvt_pk_bf16_f32 v76, v56, v57
    v_cvt_pk_bf16_f32 v77, v58, v59
    v_exp_f32 v60, v60
    v_exp_f32 v61, v61
    v_exp_f32 v62, v62
    v_exp_f32 v63, v63
    v_mfma_f32_32x32x16_bf16 v[80:95], a[152:155], v[72:75], v[80:95]
    v_cvt_pk_bf16_f32 v78, v60, v61
    v_cvt_pk_bf16_f32 v79, v62, v63
    v_exp_f32 v32, v32
    v_exp_f32 v33, v33
    v_exp_f32 v34, v34
    v_exp_f32 v35, v35
    v_mfma_f32_32x32x16_bf16 v[48:63], a[36:39], v[18:21], 0
    v_cvt_pk_bf16_f32 v64, v32, v33
    v_cvt_pk_bf16_f32 v65, v34, v35
    v_exp_f32 v36, v36
    v_exp_f32 v37, v37
    v_exp_f32 v38, v38
    v_exp_f32 v39, v39
    v_mfma_f32_32x32x8_bf16 v[48:63], a[82:83], v[22:23], v[48:63]
    v_cvt_pk_bf16_f32 v66, v36, v37
    v_cvt_pk_bf16_f32 v67, v38, v39
    v_exp_f32 v40, v40
    v_exp_f32 v41, v41
    v_exp_f32 v42, v42
    v_exp_f32 v43, v43
    v_mfma_f32_32x32x16_bf16 v[80:95], a[156:159], v[76:79], v[80:95]
    v_cvt_pk_bf16_f32 v68, v40, v41
    v_cvt_pk_bf16_f32 v69, v42, v43
    v_exp_f32 v44, v44
    v_exp_f32 v45, v45
    v_exp_f32 v46, v46
    v_exp_f32 v47, v47
    v_mfma_f32_32x32x16_bf16 v[96:111], a[160:163], v[64:67], v[80:95]
    v_cvt_pk_bf16_f32 v70, v44, v45
    v_cvt_pk_bf16_f32 v71, v46, v47
    v_exp_f32 v48, v48
    v_exp_f32 v49, v49
    v_exp_f32 v50, v50
    v_exp_f32 v51, v51
    v_mfma_f32_32x32x16_bf16 v[32:47], a[40:43], v[18:21], 0
    v_cvt_pk_bf16_f32 v72, v48, v49
    v_cvt_pk_bf16_f32 v73, v50, v51
    v_exp_f32 v52, v52
    v_exp_f32 v53, v53
    v_exp_f32 v54, v54
    v_exp_f32 v55, v55
    v_mfma_f32_32x32x8_bf16 v[32:47], a[84:85], v[22:23], v[32:47]
    v_cvt_pk_bf16_f32 v74, v52, v53
    v_cvt_pk_bf16_f32 v75, v54, v55
    v_exp_f32 v56, v56
    v_exp_f32 v57, v57
    v_exp_f32 v58, v58
    v_exp_f32 v59, v59
    v_mfma_f32_32x32x16_bf16 v[96:111], a[164:167], v[68:71], v[96:111]
    ds_read_b32 v249, v247 offset:7168
    v_cvt_pk_bf16_f32 v76, v56, v57
    v_cvt_pk_bf16_f32 v77, v58, v59
    v_exp_f32 v60, v60
    v_exp_f32 v61, v61
    v_exp_f32 v62, v62
    v_exp_f32 v63, v63
    v_mfma_f32_32x32x16_bf16 v[96:111], a[168:171], v[72:75], v[96:111]
    ds_read_b128 v[80:83], v247 offset:4096
    v_cvt_pk_bf16_f32 v78, v60, v61
    v_cvt_pk_bf16_f32 v79, v62, v63
    v_exp_f32 v32, v32
    v_exp_f32 v33, v33
    v_exp_f32 v34, v34
    v_exp_f32 v35, v35
    v_mfma_f32_32x32x16_bf16 v[48:63], a[44:47], v[18:21], 0
    ds_read_b128 v[84:87], v247 offset:5120
    v_cvt_pk_bf16_f32 v64, v32, v33
    v_cvt_pk_bf16_f32 v65, v34, v35
    v_exp_f32 v36, v36
    v_exp_f32 v37, v37
    v_exp_f32 v38, v38
    v_exp_f32 v39, v39
    v_mfma_f32_32x32x8_bf16 v[48:63], a[86:87], v[22:23], v[48:63]
    v_cvt_pk_bf16_f32 v66, v36, v37
    v_cvt_pk_bf16_f32 v67, v38, v39
    v_exp_f32 v40, v40
    v_exp_f32 v41, v41
    v_exp_f32 v42, v42
    v_exp_f32 v43, v43
    v_mfma_f32_32x32x16_bf16 v[96:111], a[172:175], v[76:79], v[96:111]
    ds_read_b128 v[88:91], v247 offset:6144
    v_cvt_pk_bf16_f32 v68, v40, v41
    v_cvt_pk_bf16_f32 v69, v42, v43
    v_exp_f32 v44, v44
    v_exp_f32 v45, v45
    v_exp_f32 v46, v46
    v_exp_f32 v47, v47
    v_mfma_f32_32x32x16_bf16 v[96:111], a[176:179], v[64:67], v[96:111]
    s_waitcnt vmcnt(0)
    v_cmp_ne_u32 vcc, 64, v240
    s_cbranch_vccnz K2_PWa
K2_PRa:
    v_cvt_pk_bf16_f32 v70, v44, v45
    v_cvt_pk_bf16_f32 v71, v46, v47
    v_exp_f32 v48, v48
    v_exp_f32 v49, v49
    v_exp_f32 v50, v50
    v_exp_f32_e64 v51, v51
    v_mfma_f32_32x32x16_bf16 v[32:47], a[48:51], v[18:21], 0
    buffer_load_dwordx4 v[132:135], v5, s[28:31], s61 offen offset:0 sc1
    v_cvt_pk_bf16_f32 v72, v48, v49
    v_cvt_pk_bf16_f32 v73, v50, v51
    v_exp_f32 v52, v52
    v_exp_f32 v53, v53
    v_exp_f32 v54, v54
    v_exp_f32 v55, v55
    v_mfma_f32_32x32x8_bf16 v[32:47], a[88:89], v[22:23], v[32:47]
    v_cvt_pk_bf16_f32 v74, v52, v53
    v_cvt_pk_bf16_f32 v75, v54, v55
    v_exp_f32 v56, v56
    v_exp_f32 v57, v57
    v_exp_f32 v58, v58
    v_exp_f32 v59, v59
    v_mfma_f32_32x32x16_bf16 v[96:111], a[180:183], v[68:71], v[96:111]
    buffer_load_dwordx4 v[136:139], v5, s[28:31], s61 offen offset:1024 sc1
    v_cvt_pk_bf16_f32 v76, v56, v57
    v_cvt_pk_bf16_f32 v77, v58, v59
    v_exp_f32 v60, v60
    v_exp_f32 v61, v61
    v_exp_f32 v62, v62
    v_exp_f32 v63, v63
    v_mfma_f32_32x32x16_bf16 v[96:111], a[184:187], v[72:75], v[96:111]
    buffer_load_dwordx4 v[140:143], v5, s[28:31], s61 offen offset:2048 sc1
    v_cvt_pk_bf16_f32 v78, v60, v61
    v_cvt_pk_bf16_f32 v79, v62, v63
    v_exp_f32 v32, v32
    v_exp_f32 v33, v33
    v_exp_f32 v34, v34
    v_exp_f32 v35, v35
    v_mfma_f32_32x32x16_bf16 v[48:63], a[52:55], v[18:21], 0
    buffer_load_dwordx4 v[144:147], v5, s[28:31], s61 offen offset:3072 sc1
    v_cvt_pk_bf16_f32 v64, v32, v33
    v_cvt_pk_bf16_f32 v65, v34, v35
    v_exp_f32 v36, v36
    v_exp_f32 v37, v37
    v_exp_f32 v38, v38
    v_exp_f32 v39, v39
    v_mfma_f32_32x32x8_bf16 v[48:63], a[90:91], v[22:23], v[48:63]
    v_cvt_pk_bf16_f32 v66, v36, v37
    v_cvt_pk_bf16_f32 v67, v38, v39
    v_exp_f32 v40, v40
    v_exp_f32 v41, v41
    v_exp_f32 v42, v42
    v_exp_f32 v43, v43
    v_mfma_f32_32x32x16_bf16 v[96:111], a[188:191], v[76:79], v[96:111]
    s_add_u32 s61, s61, 4096
    v_cvt_pk_bf16_f32 v68, v40, v41
    v_cvt_pk_bf16_f32 v69, v42, v43
    v_exp_f32 v44, v44
    v_exp_f32 v45, v45
    v_exp_f32 v46, v46
    v_exp_f32 v47, v47
    v_mfma_f32_32x32x16_bf16 v[96:111], a[192:195], v[64:67], v[96:111]
    buffer_load_dwordx4 v[148:151], v5, s[28:31], s61 offen offset:0 sc1
    v_cvt_pk_bf16_f32 v70, v44, v45
    v_cvt_pk_bf16_f32 v71, v46, v47
    v_exp_f32 v48, v48
    v_exp_f32 v49, v49
    v_exp_f32 v50, v50
    v_exp_f32 v51, v51
    v_mfma_f32_32x32x16_bf16 v[32:47], a[56:59], v[18:21], 0
    v_cvt_pk_bf16_f32 v72, v48, v49
    v_cvt_pk_bf16_f32 v73, v50, v51
    v_exp_f32 v52, v52
    v_exp_f32 v53, v53
    v_exp_f32 v54, v54
    v_exp_f32 v55, v55
    v_mfma_f32_32x32x8_bf16 v[32:47], a[92:93], v[22:23], v[32:47]
    v_cvt_pk_bf16_f32 v74, v52, v53
    v_cvt_pk_bf16_f32 v75, v54, v55
    v_exp_f32 v56, v56
    v_exp_f32 v57, v57
    v_exp_f32 v58, v58
    v_exp_f32 v59, v59
    v_mfma_f32_32x32x16_bf16 v[96:111], a[196:199], v[68:71], v[96:111]
    v_cvt_pk_bf16_f32 v76, v56, v57
    v_cvt_pk_bf16_f32 v77, v58, v59
    v_exp_f32 v60, v60
    v_exp_f32 v61, v61
    v_exp_f32 v62, v62
    v_exp_f32 v63, v63
    v_mfma_f32_32x32x16_bf16 v[96:111], a[200:203], v[72:75], v[96:111]
    buffer_load_dwordx4 v[152:155], v5, s[28:31], s61 offen offset:1024 sc1
    v_cvt_pk_bf16_f32 v78, v60, v61
    v_cvt_pk_bf16_f32 v79, v62, v63
    v_exp_f32 v32, v32
    v_exp_f32 v33, v33
    v_exp_f32 v34, v34
    v_exp_f32 v35, v35
    v_mfma_f32_32x32x16_bf16 v[48:63], a[60:63], v[18:21], 0
    ds_read2_b64 v[18:21], v130 offset0:1 offset1:9
    v_cvt_pk_bf16_f32 v64, v32, v33
    v_cvt_pk_bf16_f32 v65, v34, v35
    v_exp_f32 v36, v36
    v_exp_f32 v37, v37
    v_exp_f32 v38, v38
    v_exp_f32 v39, v39
    v_mfma_f32_32x32x8_bf16 v[48:63], a[94:95], v[22:23], v[48:63]
    v_cvt_pk_bf16_f32 v66, v36, v37
    v_cvt_pk_bf16_f32 v67, v38, v39
    v_exp_f32 v40, v40
    v_exp_f32 v41, v41
    v_exp_f32 v42, v42
    v_exp_f32 v43, v43
    v_mfma_f32_32x32x16_bf16 v[96:111], a[204:207], v[76:79], v[96:111]
    ds_read_b64 v[22:23], v254 offset:8
    v_cvt_pk_bf16_f32 v68, v40, v41
    v_cvt_pk_bf16_f32 v69, v42, v43
    v_exp_f32 v44, v44
    v_exp_f32 v45, v45
    v_exp_f32 v46, v46
    v_exp_f32 v47, v47
    v_mfma_f32_32x32x16_bf16 v[96:111], a[208:211], v[64:67], v[96:111]
    s_waitcnt lgkmcnt(1)
    v_cvt_pk_bf16_f32 v70, v44, v45
    v_cvt_pk_bf16_f32 v71, v46, v47
    v_exp_f32 v48, v48
    v_exp_f32 v49, v49
    v_exp_f32 v50, v50
    v_exp_f32_e64 v51, v51
    v_mfma_f32_32x32x16_bf16 v[32:47], a[0:3], v[18:21], 0
    s_waitcnt lgkmcnt(0)
    v_cvt_pk_bf16_f32 v72, v48, v49
    v_cvt_pk_bf16_f32 v73, v50, v51
    v_exp_f32 v52, v52
    v_exp_f32 v53, v53
    v_exp_f32 v54, v54
    v_exp_f32_e64 v55, v55
    v_mfma_f32_32x32x8_bf16 v[32:47], a[64:65], v[22:23], v[32:47]
    v_cmp_ne_u32_e64 vcc, v249, v7
    v_cvt_pk_bf16_f32 v74, v52, v53
    v_cvt_pk_bf16_f32 v75, v54, v55
    v_exp_f32 v56, v56
    v_exp_f32 v57, v57
    v_exp_f32 v58, v58
    v_exp_f32 v59, v59
    v_mfma_f32_32x32x16_bf16 v[96:111], a[212:215], v[68:71], v[96:111]
    s_cbranch_vccnz CH_4
CR_4:
    v_cvt_pk_bf16_f32 v76, v56, v57
    v_cvt_pk_bf16_f32 v77, v58, v59
    v_exp_f32 v60, v60
    v_exp_f32 v61, v61
    v_exp_f32 v62, v62
    v_exp_f32_e64 v63, v63
    v_mfma_f32_32x32x16_bf16 v[96:111], a[216:219], v[72:75], v[96:111]
    buffer_load_dwordx4 v[156:159], v5, s[28:31], s61 offen offset:2048 sc1
    v_cvt_pk_bf16_f32 v78, v60, v61
    v_cvt_pk_bf16_f32 v79, v62, v63
    v_exp_f32 v32, v32
    v_exp_f32 v33, v33
    v_exp_f32 v34, v34
    v_exp_f32 v35, v35
    v_mfma_f32_32x32x16_bf16 v[48:63], a[4:7], v[18:21], 0
    buffer_load_dwordx4 v[160:163], v5, s[28:31], s61 offen offset:3072 sc1
    v_cvt_pk_bf16_f32 v64, v32, v33
    v_cvt_pk_bf16_f32 v65, v34, v35
    v_exp_f32 v36, v36
    v_exp_f32 v37, v37
    v_exp_f32 v38, v38
    v_exp_f32 v39, v39
    v_mfma_f32_32x32x8_bf16 v[48:63], a[66:67], v[22:23], v[48:63]
    v_cvt_pk_bf16_f32 v66, v36, v37
    v_cvt_pk_bf16_f32 v67, v38, v39
    v_exp_f32 v40, v40
    v_exp_f32 v41, v41
    v_exp_f32 v42, v42
    v_exp_f32 v43, v43
    v_mfma_f32_32x32x16_bf16 v[96:111], a[220:223], v[76:79], v[96:111]
    s_add_u32 s61, s61, 4096
    v_cvt_pk_bf16_f32 v68, v40, v41
    v_cvt_pk_bf16_f32 v69, v42, v43
    v_exp_f32 v44, v44
    v_exp_f32 v45, v45
    v_exp_f32 v46, v46
    v_exp_f32 v47, v47
    v_mfma_f32_32x32x16_bf16 v[80:95], a[96:99], v[64:67], v[80:95]
    buffer_load_dwordx4 v[164:167], v5, s[28:31], s61 offen offset:0 sc1
    v_cvt_pk_bf16_f32 v70, v44, v45
    v_cvt_pk_bf16_f32 v71, v46, v47
    v_exp_f32 v48, v48
    v_exp_f32 v49, v49
    v_exp_f32 v50, v50
    v_exp_f32 v51, v51
    v_mfma_f32_32x32x16_bf16 v[32:47], a[8:11], v[18:21], 0
    buffer_load_dword v242, v16, s[28:31], s58 offen sc1
    v_cvt_pk_bf16_f32 v72, v48, v49
    v_cvt_pk_bf16_f32 v73, v50, v51
    v_exp_f32 v52, v52
    v_exp_f32 v53, v53
    v_exp_f32 v54, v54
    v_exp_f32 v55, v55
    v_mfma_f32_32x32x8_bf16 v[32:47], a[68:69], v[22:23], v[32:47]
    v_cvt_pk_bf16_f32 v74, v52, v53
    v_cvt_pk_bf16_f32 v75, v54, v55
    v_exp_f32 v56, v56
    v_exp_f32 v57, v57
    v_exp_f32 v58, v58
    v_exp_f32 v59, v59
    v_mfma_f32_32x32x16_bf16 v[80:95], a[100:103], v[68:71], v[80:95]
    s_add_u32 s58, s58, 8192
    v_cvt_pk_bf16_f32 v76, v56, v57
    v_cvt_pk_bf16_f32 v77, v58, v59
    v_exp_f32 v60, v60
    v_exp_f32 v61, v61
    v_exp_f32 v62, v62
    v_exp_f32 v63, v63
    v_mfma_f32_32x32x16_bf16 v[80:95], a[104:107], v[72:75], v[80:95]
    ds_write_b128 v247, v[96:99] offset:0
    v_cvt_pk_bf16_f32 v78, v60, v61
    v_cvt_pk_bf16_f32 v79, v62, v63
    v_exp_f32 v32, v32
    v_exp_f32 v33, v33
    v_exp_f32 v34, v34
    v_exp_f32 v35, v35
    v_mfma_f32_32x32x16_bf16 v[48:63], a[12:15], v[18:21], 0
    ds_write_b128 v247, v[100:103] offset:1024
    v_cvt_pk_bf16_f32 v64, v32, v33
    v_cvt_pk_bf16_f32 v65, v34, v35
    v_exp_f32 v36, v36
    v_exp_f32 v37, v37
    v_exp_f32 v38, v38
    v_exp_f32 v39, v39
    v_mfma_f32_32x32x8_bf16 v[48:63], a[70:71], v[22:23], v[48:63]
    v_cvt_pk_bf16_f32 v66, v36, v37
    v_cvt_pk_bf16_f32 v67, v38, v39
    v_exp_f32 v40, v40
    v_exp_f32 v41, v41
    v_exp_f32 v42, v42
    v_exp_f32 v43, v43
    v_mfma_f32_32x32x16_bf16 v[80:95], a[108:111], v[76:79], v[80:95]
    ds_write_b128 v247, v[104:107] offset:2048
    v_cvt_pk_bf16_f32 v68, v40, v41
    v_cvt_pk_bf16_f32 v69, v42, v43
    v_exp_f32 v44, v44
    v_exp_f32 v45, v45
    v_exp_f32 v46, v46
    v_exp_f32 v47, v47
    v_mfma_f32_32x32x16_bf16 v[80:95], a[112:115], v[64:67], v[80:95]
    ds_write_b32 v247, v10 offset:3072
    v_cvt_pk_bf16_f32 v70, v44, v45
    v_cvt_pk_bf16_f32 v71, v46, v47
    v_exp_f32 v48, v48
    v_exp_f32 v49, v49
    v_exp_f32 v50, v50
    v_exp_f32 v51, v51
    v_mfma_f32_32x32x16_bf16 v[32:47], a[16:19], v[18:21], 0
    buffer_load_dwordx4 v[168:171], v5, s[28:31], s61 offen offset:1024 sc1
    v_cvt_pk_bf16_f32 v72, v48, v49
    v_cvt_pk_bf16_f32 v73, v50, v51
    v_exp_f32 v52, v52
    v_exp_f32 v53, v53
    v_exp_f32 v54, v54
    v_exp_f32 v55, v55
    v_mfma_f32_32x32x8_bf16 v[32:47], a[72:73], v[22:23], v[32:47]
    v_cvt_pk_bf16_f32 v74, v52, v53
    v_cvt_pk_bf16_f32 v75, v54, v55
    v_exp_f32 v56, v56
    v_exp_f32 v57, v57
    v_exp_f32 v58, v58
    v_exp_f32 v59, v59
    v_mfma_f32_32x32x16_bf16 v[80:95], a[116:119], v[68:71], v[80:95]
    buffer_load_dwordx4 v[172:175], v5, s[28:31], s61 offen offset:2048 sc1
    v_cvt_pk_bf16_f32 v76, v56, v57
    v_cvt_pk_bf16_f32 v77, v58, v59
    v_exp_f32 v60, v60
    v_exp_f32 v61, v61
    v_exp_f32 v62, v62
    v_exp_f32 v63, v63
    v_mfma_f32_32x32x16_bf16 v[80:95], a[120:123], v[72:75], v[80:95]
    buffer_load_dwordx4 v[176:179], v5, s[28:31], s61 offen offset:3072 sc1
    v_cvt_pk_bf16_f32 v78, v60, v61
    v_cvt_pk_bf16_f32 v79, v62, v63
    v_exp_f32 v32, v32
    v_exp_f32 v33, v33
    v_exp_f32 v34, v34
    v_exp_f32 v35, v35
    v_mfma_f32_32x32x16_bf16 v[48:63], a[20:23], v[18:21], 0
    s_add_u32 s61, s61, 4096
    v_cvt_pk_bf16_f32 v64, v32, v33
    v_cvt_pk_bf16_f32 v65, v34, v35
    v_exp_f32 v36, v36
    v_exp_f32 v37, v37
    v_exp_f32 v38, v38
    v_exp_f32 v39, v39
    v_mfma_f32_32x32x8_bf16 v[48:63], a[74:75], v[22:23], v[48:63]
    v_cvt_pk_bf16_f32 v66, v36, v37
    v_cvt_pk_bf16_f32 v67, v38, v39
    v_exp_f32 v40, v40
    v_exp_f32 v41, v41
    v_exp_f32 v42, v42
    v_exp_f32 v43, v43
    v_mfma_f32_32x32x16_bf16 v[80:95], a[124:127], v[76:79], v[80:95]
    buffer_load_dwordx4 v[180:183], v5, s[28:31], s61 offen offset:0 sc1
    v_cvt_pk_bf16_f32 v68, v40, v41
    v_cvt_pk_bf16_f32 v69, v42, v43
    v_exp_f32 v44, v44
    v_exp_f32 v45, v45
    v_exp_f32 v46, v46
    v_exp_f32 v47, v47
    v_mfma_f32_32x32x16_bf16 v[80:95], a[128:131], v[64:67], v[80:95]
    buffer_load_dwordx4 v[232:235], v116, s[28:31], s38 offen offset:0 sc1
    v_cvt_pk_bf16_f32 v70, v44, v45
    v_cvt_pk_bf16_f32 v71, v46, v47
    v_exp_f32 v48, v48
    v_exp_f32 v49, v49
    v_exp_f32 v50, v50
    v_exp_f32 v51, v51
    v_mfma_f32_32x32x16_bf16 v[32:47], a[24:27], v[18:21], 0
    buffer_load_dwordx4 v[184:187], v5, s[28:31], s61 offen offset:1024 sc1
    v_cvt_pk_bf16_f32 v72, v48, v49
    v_cvt_pk_bf16_f32 v73, v50, v51
    v_exp_f32 v52, v52
    v_exp_f32 v53, v53
    v_exp_f32 v54, v54
    v_exp_f32 v55, v55
    v_mfma_f32_32x32x8_bf16 v[32:47], a[76:77], v[22:23], v[32:47]
    v_cvt_pk_bf16_f32 v74, v52, v53
    v_cvt_pk_bf16_f32 v75, v54, v55
    v_exp_f32 v56, v56
    v_exp_f32 v57, v57
    v_exp_f32 v58, v58
    v_exp_f32 v59, v59
    v_mfma_f32_32x32x16_bf16 v[80:95], a[132:135], v[68:71], v[80:95]
    buffer_load_dwordx4 v[188:191], v5, s[28:31], s61 offen offset:2048 sc1
    v_cvt_pk_bf16_f32 v76, v56, v57
    v_cvt_pk_bf16_f32 v77, v58, v59
    v_exp_f32 v60, v60
    v_exp_f32 v61, v61
    v_exp_f32 v62, v62
    v_exp_f32 v63, v63
    v_mfma_f32_32x32x16_bf16 v[80:95], a[136:139], v[72:75], v[80:95]
    buffer_load_dwordx4 v[192:195], v5, s[28:31], s61 offen offset:3072 sc1
    v_cvt_pk_bf16_f32 v78, v60, v61
    v_cvt_pk_bf16_f32 v79, v62, v63
    v_exp_f32 v32, v32
    v_exp_f32 v33, v33
    v_exp_f32 v34, v34
    v_exp_f32 v35, v35
    v_mfma_f32_32x32x16_bf16 v[48:63], a[28:31], v[18:21], 0
    s_add_u32 s61, s61, 4096
    v_cvt_pk_bf16_f32 v64, v32, v33
    v_cvt_pk_bf16_f32 v65, v34, v35
    v_exp_f32 v36, v36
    v_exp_f32 v37, v37
    v_exp_f32 v38, v38
    v_exp_f32 v39, v39
    v_mfma_f32_32x32x8_bf16 v[48:63], a[78:79], v[22:23], v[48:63]
    v_cvt_pk_bf16_f32 v66, v36, v37
    v_cvt_pk_bf16_f32 v67, v38, v39
    v_exp_f32 v40, v40
    v_exp_f32 v41, v41
    v_exp_f32 v42, v42
    v_exp_f32 v43, v43
    v_mfma_f32_32x32x16_bf16 v[80:95], a[140:143], v[76:79], v[80:95]
    v_cvt_pk_bf16_f32 v68, v40, v41
    v_cvt_pk_bf16_f32 v69, v42, v43
    v_exp_f32 v44, v44
    v_exp_f32 v45, v45
    v_exp_f32 v46, v46
    v_exp_f32 v47, v47
    v_mfma_f32_32x32x16_bf16 v[80:95], a[144:147], v[64:67], v[80:95]
    buffer_load_dwordx4 v[196:199], v5, s[28:31], s61 offen offset:0 sc1
    v_cvt_pk_bf16_f32 v70, v44, v45
    v_cvt_pk_bf16_f32 v71, v46, v47
    v_exp_f32 v48, v48
    v_exp_f32 v49, v49
    v_exp_f32 v50, v50
    v_exp_f32 v51, v51
    v_mfma_f32_32x32x16_bf16 v[32:47], a[32:35], v[18:21], 0
    buffer_load_dwordx4 v[200:203], v5, s[28:31], s61 offen offset:1024 sc1
    v_cvt_pk_bf16_f32 v72, v48, v49
    v_cvt_pk_bf16_f32 v73, v50, v51
    v_exp_f32 v52, v52
    v_exp_f32 v53, v53
    v_exp_f32 v54, v54
    v_exp_f32 v55, v55
    v_mfma_f32_32x32x8_bf16 v[32:47], a[80:81], v[22:23], v[32:47]
    v_cvt_pk_bf16_f32 v74, v52, v53
    v_cvt_pk_bf16_f32 v75, v54, v55
    v_exp_f32 v56, v56
    v_exp_f32 v57, v57
    v_exp_f32 v58, v58
    v_exp_f32 v59, v59
    v_mfma_f32_32x32x16_bf16 v[80:95], a[148:151], v[68:71], v[80:95]
    buffer_load_dwordx4 v[236:239], v116, s[28:31], s38 offen offset:16 sc1
    v_cvt_pk_bf16_f32 v76, v56, v57
    v_cvt_pk_bf16_f32 v77, v58, v59
    v_exp_f32 v60, v60
    v_exp_f32 v61, v61
    v_exp_f32 v62, v62
    v_exp_f32 v63, v63
    v_mfma_f32_32x32x16_bf16 v[80:95], a[152:155], v[72:75], v[80:95]
    s_getpc_b64 s[14:15]
    s_add_u32 s14, s14, 3072
    s_addc_u32 s15, s15, 0
    v_cvt_pk_bf16_f32 v78, v60, v61
    v_cvt_pk_bf16_f32 v79, v62, v63
    v_exp_f32 v32, v32
    v_exp_f32 v33, v33
    v_exp_f32 v34, v34
    v_exp_f32 v35, v35
    v_mfma_f32_32x32x16_bf16 v[48:63], a[36:39], v[18:21], 0
    global_load_dword v242, v245, s[14:15]
    v_cvt_pk_bf16_f32 v64, v32, v33
    v_cvt_pk_bf16_f32 v65, v34, v35
    v_exp_f32 v36, v36
    v_exp_f32 v37, v37
    v_exp_f32 v38, v38
    v_exp_f32 v39, v39
    v_mfma_f32_32x32x8_bf16 v[48:63], a[82:83], v[22:23], v[48:63]
    v_cvt_pk_bf16_f32 v66, v36, v37
    v_cvt_pk_bf16_f32 v67, v38, v39
    v_exp_f32 v40, v40
    v_exp_f32 v41, v41
    v_exp_f32 v42, v42
    v_exp_f32 v43, v43
    v_mfma_f32_32x32x16_bf16 v[80:95], a[156:159], v[76:79], v[80:95]
    buffer_load_dwordx4 v[204:207], v5, s[28:31], s61 offen offset:2048 sc1
    v_cvt_pk_bf16_f32 v68, v40, v41
    v_cvt_pk_bf16_f32 v69, v42, v43
    v_exp_f32 v44, v44
    v_exp_f32 v45, v45
    v_exp_f32 v46, v46
    v_exp_f32 v47, v47
    v_mfma_f32_32x32x16_bf16 v[96:111], a[160:163], v[64:67], v[80:95]
    buffer_load_dwordx4 v[208:211], v5, s[28:31], s61 offen offset:3072 sc1
    v_cvt_pk_bf16_f32 v70, v44, v45
    v_cvt_pk_bf16_f32 v71, v46, v47
    v_exp_f32 v48, v48
    v_exp_f32 v49, v49
    v_exp_f32 v50, v50
    v_exp_f32 v51, v51
    v_mfma_f32_32x32x16_bf16 v[32:47], a[40:43], v[18:21], 0
    s_add_u32 s61, s61, 4096
    v_cvt_pk_bf16_f32 v72, v48, v49
    v_cvt_pk_bf16_f32 v73, v50, v51
    v_exp_f32 v52, v52
    v_exp_f32 v53, v53
    v_exp_f32 v54, v54
    v_exp_f32 v55, v55
    v_mfma_f32_32x32x8_bf16 v[32:47], a[84:85], v[22:23], v[32:47]
    v_cvt_pk_bf16_f32 v74, v52, v53
    v_cvt_pk_bf16_f32 v75, v54, v55
    v_exp_f32 v56, v56
    v_exp_f32 v57, v57
    v_exp_f32 v58, v58
    v_exp_f32 v59, v59
    v_mfma_f32_32x32x16_bf16 v[96:111], a[164:167], v[68:71], v[96:111]
    ds_read_b32 v249, v248 offset:3072
    v_cvt_pk_bf16_f32 v76, v56, v57
    v_cvt_pk_bf16_f32 v77, v58, v59
    v_exp_f32 v60, v60
    v_exp_f32 v61, v61
    v_exp_f32 v62, v62
    v_exp_f32 v63, v63
    v_mfma_f32_32x32x16_bf16 v[96:111], a[168:171], v[72:75], v[96:111]
    ds_read_b128 v[80:83], v248 offset:0
    v_cvt_pk_bf16_f32 v78, v60, v61
    v_cvt_pk_bf16_f32 v79, v62, v63
    v_exp_f32 v32, v32
    v_exp_f32 v33, v33
    v_exp_f32 v34, v34
    v_exp_f32 v35, v35
    v_mfma_f32_32x32x16_bf16 v[48:63], a[44:47], v[18:21], 0
    ds_read_b128 v[84:87], v248 offset:1024
    v_cvt_pk_bf16_f32 v64, v32, v33
    v_cvt_pk_bf16_f32 v65, v34, v35
    v_exp_f32 v36, v36
    v_exp_f32 v37, v37
    v_exp_f32 v38, v38
    v_exp_f32 v39, v39
    v_mfma_f32_32x32x8_bf16 v[48:63], a[86:87], v[22:23], v[48:63]
    v_cvt_pk_bf16_f32 v66, v36, v37
    v_cvt_pk_bf16_f32 v67, v38, v39
    v_exp_f32 v40, v40
    v_exp_f32 v41, v41
    v_exp_f32 v42, v42
    v_exp_f32 v43, v43
    v_mfma_f32_32x32x16_bf16 v[96:111], a[172:175], v[76:79], v[96:111]
    ds_read_b128 v[88:91], v248 offset:2048
    v_cvt_pk_bf16_f32 v68, v40, v41
    v_cvt_pk_bf16_f32 v69, v42, v43
    v_exp_f32 v44, v44
    v_exp_f32 v45, v45
    v_exp_f32 v46, v46
    v_exp_f32 v47, v47
    v_mfma_f32_32x32x16_bf16 v[96:111], a[176:179], v[64:67], v[96:111]
    buffer_load_dwordx4 v[212:215], v5, s[28:31], s61 offen offset:0 sc1
    v_cvt_pk_bf16_f32 v70, v44, v45
    v_cvt_pk_bf16_f32 v71, v46, v47
    v_exp_f32 v48, v48
    v_exp_f32 v49, v49
    v_exp_f32 v50, v50
    v_exp_f32 v51, v51
    v_mfma_f32_32x32x16_bf16 v[32:47], a[48:51], v[18:21], 0
    buffer_load_dword v242, v16, s[28:31], s58 offen sc1
    v_cvt_pk_bf16_f32 v72, v48, v49
    v_cvt_pk_bf16_f32 v73, v50, v51
    v_exp_f32 v52, v52
    v_exp_f32 v53, v53
    v_exp_f32 v54, v54
    v_exp_f32 v55, v55
    v_mfma_f32_32x32x8_bf16 v[32:47], a[88:89], v[22:23], v[32:47]
    v_cvt_pk_bf16_f32 v74, v52, v53
    v_cvt_pk_bf16_f32 v75, v54, v55
    v_exp_f32 v56, v56
    v_exp_f32 v57, v57
    v_exp_f32 v58, v58
    v_exp_f32 v59, v59
    v_mfma_f32_32x32x16_bf16 v[96:111], a[180:183], v[68:71], v[96:111]
    s_add_u32 s58, s58, 8192
    v_cvt_pk_bf16_f32 v76, v56, v57
    v_cvt_pk_bf16_f32 v77, v58, v59
    v_exp_f32 v60, v60
    v_exp_f32 v61, v61
    v_exp_f32 v62, v62
    v_exp_f32 v63, v63
    v_mfma_f32_32x32x16_bf16 v[96:111], a[184:187], v[72:75], v[96:111]
    buffer_load_dwordx4 v[216:219], v5, s[28:31], s61 offen offset:1024 sc1
    v_cvt_pk_bf16_f32 v78, v60, v61
    v_cvt_pk_bf16_f32 v79, v62, v63
    v_exp_f32 v32, v32
    v_exp_f32 v33, v33
    v_exp_f32 v34, v34
    v_exp_f32 v35, v35
    v_mfma_f32_32x32x16_bf16 v[48:63], a[52:55], v[18:21], 0
    buffer_load_dwordx4 v[220:223], v5, s[28:31], s61 offen offset:2048 sc1
    v_cvt_pk_bf16_f32 v64, v32, v33
    v_cvt_pk_bf16_f32 v65, v34, v35
    v_exp_f32 v36, v36
    v_exp_f32 v37, v37
    v_exp_f32 v38, v38
    v_exp_f32 v39, v39
    v_mfma_f32_32x32x8_bf16 v[48:63], a[90:91], v[22:23], v[48:63]
    v_cvt_pk_bf16_f32 v66, v36, v37
    v_cvt_pk_bf16_f32 v67, v38, v39
    v_exp_f32 v40, v40
    v_exp_f32 v41, v41
    v_exp_f32 v42, v42
    v_exp_f32 v43, v43
    v_mfma_f32_32x32x16_bf16 v[96:111], a[188:191], v[76:79], v[96:111]
    buffer_load_dwordx4 v[224:227], v5, s[28:31], s61 offen offset:3072 sc1
    v_cvt_pk_bf16_f32 v68, v40, v41
    v_cvt_pk_bf16_f32 v69, v42, v43
    v_exp_f32 v44, v44
    v_exp_f32 v45, v45
    v_exp_f32 v46, v46
    v_exp_f32 v47, v47
    v_mfma_f32_32x32x16_bf16 v[96:111], a[192:195], v[64:67], v[96:111]
    s_add_u32 s61, s61, 4096
    v_cvt_pk_bf16_f32 v70, v44, v45
    v_cvt_pk_bf16_f32 v71, v46, v47
    v_exp_f32 v48, v48
    v_exp_f32 v49, v49
    v_exp_f32 v50, v50
    v_exp_f32 v51, v51
    v_mfma_f32_32x32x16_bf16 v[32:47], a[56:59], v[18:21], 0
    buffer_load_dwordx4 v[228:231], v5, s[28:31], s61 offen offset:0 sc1
    v_cvt_pk_bf16_f32 v72, v48, v49
    v_cvt_pk_bf16_f32 v73, v50, v51
    v_exp_f32 v52, v52
    v_exp_f32 v53, v53
    v_exp_f32 v54, v54
    v_exp_f32 v55, v55
    v_mfma_f32_32x32x8_bf16 v[32:47], a[92:93], v[22:23], v[32:47]
    v_cvt_pk_bf16_f32 v74, v52, v53
    v_cvt_pk_bf16_f32 v75, v54, v55
    v_exp_f32 v56, v56
    v_exp_f32 v57, v57
    v_exp_f32 v58, v58
    v_exp_f32 v59, v59
    v_mfma_f32_32x32x16_bf16 v[96:111], a[196:199], v[68:71], v[96:111]
    v_cvt_pk_bf16_f32 v76, v56, v57
    v_cvt_pk_bf16_f32 v77, v58, v59
    v_exp_f32 v60, v60
    v_exp_f32 v61, v61
    v_exp_f32 v62, v62
    v_exp_f32 v63, v63
    v_mfma_f32_32x32x16_bf16 v[96:111], a[200:203], v[72:75], v[96:111]
    buffer_load_dwordx4 v5, s[28:31], s62 offen offset:0 sc1 lds
    v_cvt_pk_bf16_f32 v78, v60, v61
    v_cvt_pk_bf16_f32 v79, v62, v63
    v_exp_f32 v32, v32
    v_exp_f32 v33, v33
    v_exp_f32 v34, v34
    v_exp_f32 v35, v35
    v_mfma_f32_32x32x16_bf16 v[48:63], a[60:63], v[18:21], 0
    ds_read2_b64 v[18:21], v131 offset0:0 offset1:8
    v_cvt_pk_bf16_f32 v64, v32, v33
    v_cvt_pk_bf16_f32 v65, v34, v35
    v_exp_f32 v36, v36
    v_exp_f32 v37, v37
    v_exp_f32 v38, v38
    v_exp_f32 v39, v39
    v_mfma_f32_32x32x8_bf16 v[48:63], a[94:95], v[22:23], v[48:63]
    v_cvt_pk_bf16_f32 v66, v36, v37
    v_cvt_pk_bf16_f32 v67, v38, v39
    v_exp_f32 v40, v40
    v_exp_f32 v41, v41
    v_exp_f32 v42, v42
    v_exp_f32 v43, v43
    v_mfma_f32_32x32x16_bf16 v[96:111], a[204:207], v[76:79], v[96:111]
    ds_read_b64 v[22:23], v255 offset:0
    v_cvt_pk_bf16_f32 v68, v40, v41
    v_cvt_pk_bf16_f32 v69, v42, v43
    v_exp_f32 v44, v44
    v_exp_f32 v45, v45
    v_exp_f32 v46, v46
    v_exp_f32 v47, v47
    v_mfma_f32_32x32x16_bf16 v[96:111], a[208:211], v[64:67], v[96:111]
    s_waitcnt lgkmcnt(1)
    v_cvt_pk_bf16_f32 v70, v44, v45
    v_cvt_pk_bf16_f32 v71, v46, v47
    v_exp_f32 v48, v48
    v_exp_f32 v49, v49
    v_exp_f32 v50, v50
    v_exp_f32_e64 v51, v51
    v_mfma_f32_32x32x16_bf16 v[32:47], a[0:3], v[18:21], 0
    s_waitcnt lgkmcnt(0)
    v_cvt_pk_bf16_f32 v72, v48, v49
    v_cvt_pk_bf16_f32 v73, v50, v51
    v_exp_f32 v52, v52
    v_exp_f32 v53, v53
    v_exp_f32 v54, v54
    v_exp_f32_e64 v55, v55
    v_mfma_f32_32x32x8_bf16 v[32:47], a[64:65], v[22:23], v[32:47]
    v_cmp_ne_u32_e64 vcc, v249, v10
    v_cvt_pk_bf16_f32 v74, v52, v53
    v_cvt_pk_bf16_f32 v75, v54, v55
    v_exp_f32 v56, v56
    v_exp_f32 v57, v57
    v_exp_f32 v58, v58
    v_exp_f32 v59, v59
    v_mfma_f32_32x32x16_bf16 v[96:111], a[212:215], v[68:71], v[96:111]
    s_cbranch_vccnz CH_5
CR_5:
    v_cvt_pk_bf16_f32 v76, v56, v57
    v_cvt_pk_bf16_f32 v77, v58, v59
    v_exp_f32 v60, v60
    v_exp_f32 v61, v61
    v_exp_f32 v62, v62
    v_exp_f32_e64 v63, v63
    v_mfma_f32_32x32x16_bf16 v[96:111], a[216:219], v[72:75], v[96:111]
    buffer_load_dwordx4 v5, s[28:31], s62 offen offset:1024 sc1 lds
    v_cvt_pk_bf16_f32 v78, v60, v61
    v_cvt_pk_bf16_f32 v79, v62, v63
    v_exp_f32 v32, v32
    v_exp_f32 v33, v33
    v_exp_f32 v34, v34
    v_exp_f32 v35, v35
    v_mfma_f32_32x32x16_bf16 v[48:63], a[4:7], v[18:21], 0
    buffer_load_dwordx4 v5, s[28:31], s62 offen offset:2048 sc1 lds
    v_cvt_pk_bf16_f32 v64, v32, v33
    v_cvt_pk_bf16_f32 v65, v34, v35
    v_exp_f32 v36, v36
    v_exp_f32 v37, v37
    v_exp_f32 v38, v38
    v_exp_f32 v39, v39
    v_mfma_f32_32x32x8_bf16 v[48:63], a[66:67], v[22:23], v[48:63]
    v_cvt_pk_bf16_f32 v66, v36, v37
    v_cvt_pk_bf16_f32 v67, v38, v39
    v_exp_f32 v40, v40
    v_exp_f32 v41, v41
    v_exp_f32 v42, v42
    v_exp_f32 v43, v43
    v_mfma_f32_32x32x16_bf16 v[96:111], a[220:223], v[76:79], v[96:111]
    buffer_load_dwordx4 v5, s[28:31], s62 offen offset:3072 sc1 lds
    v_cvt_pk_bf16_f32 v68, v40, v41
    v_cvt_pk_bf16_f32 v69, v42, v43
    v_exp_f32 v44, v44
    v_exp_f32 v45, v45
    v_exp_f32 v46, v46
    v_exp_f32 v47, v47
    v_mfma_f32_32x32x16_bf16 v[80:95], a[96:99], v[64:67], v[80:95]
    s_add_u32 s62, s62, 4096
    v_cvt_pk_bf16_f32 v70, v44, v45
    v_cvt_pk_bf16_f32 v71, v46, v47
    v_exp_f32 v48, v48
    v_exp_f32 v49, v49
    v_exp_f32 v50, v50
    v_exp_f32 v51, v51
    v_mfma_f32_32x32x16_bf16 v[32:47], a[8:11], v[18:21], 0
    s_addk_i32 m0, 4096
    v_cvt_pk_bf16_f32 v72, v48, v49
    v_cvt_pk_bf16_f32 v73, v50, v51
    v_exp_f32 v52, v52
    v_exp_f32 v53, v53
    v_exp_f32 v54, v54
    v_exp_f32_e64 v55, v55
    v_mfma_f32_32x32x8_bf16 v[32:47], a[68:69], v[22:23], v[32:47]
    v_cvt_pk_bf16_f32 v74, v52, v53
    v_cvt_pk_bf16_f32 v75, v54, v55
    v_exp_f32 v56, v56
    v_exp_f32 v57, v57
    v_exp_f32 v58, v58
    v_exp_f32 v59, v59
    v_mfma_f32_32x32x16_bf16 v[80:95], a[100:103], v[68:71], v[80:95]
    buffer_load_dwordx4 v5, s[28:31], s62 offen offset:0 sc1 lds
    v_cvt_pk_bf16_f32 v76, v56, v57
    v_cvt_pk_bf16_f32 v77, v58, v59
    v_exp_f32 v60, v60
    v_exp_f32 v61, v61
    v_exp_f32 v62, v62
    v_exp_f32 v63, v63
    v_mfma_f32_32x32x16_bf16 v[80:95], a[104:107], v[72:75], v[80:95]
    ds_write_b128 v247, v[96:99] offset:4096
    v_cvt_pk_bf16_f32 v78, v60, v61
    v_cvt_pk_bf16_f32 v79, v62, v63
    v_exp_f32 v32, v32
    v_exp_f32 v33, v33
    v_exp_f32 v34, v34
    v_exp_f32 v35, v35
    v_mfma_f32_32x32x16_bf16 v[48:63], a[12:15], v[18:21], 0
    ds_write_b128 v247, v[100:103] offset:5120
    v_cvt_pk_bf16_f32 v64, v32, v33
    v_cvt_pk_bf16_f32 v65, v34, v35
    v_exp_f32 v36, v36
    v_exp_f32 v37, v37
    v_exp_f32 v38, v38
    v_exp_f32 v39, v39
    v_mfma_f32_32x32x8_bf16 v[48:63], a[70:71], v[22:23], v[48:63]
    v_cvt_pk_bf16_f32 v66, v36, v37
    v_cvt_pk_bf16_f32 v67, v38, v39
    v_exp_f32 v40, v40
    v_exp_f32 v41, v41
    v_exp_f32 v42, v42
    v_exp_f32 v43, v43
    v_mfma_f32_32x32x16_bf16 v[80:95], a[108:111], v[76:79], v[80:95]
    ds_write_b128 v247, v[104:107] offset:6144
    v_cvt_pk_bf16_f32 v68, v40, v41
    v_cvt_pk_bf16_f32 v69, v42, v43
    v_exp_f32 v44, v44
    v_exp_f32 v45, v45
    v_exp_f32 v46, v46
    v_exp_f32 v47, v47
    v_mfma_f32_32x32x16_bf16 v[80:95], a[112:115], v[64:67], v[80:95]
    ds_write_b32 v247, v10 offset:7168
    v_cvt_pk_bf16_f32 v70, v44, v45
    v_cvt_pk_bf16_f32 v71, v46, v47
    v_exp_f32 v48, v48
    v_exp_f32 v49, v49
    v_exp_f32 v50, v50
    v_exp_f32 v51, v51
    v_mfma_f32_32x32x16_bf16 v[32:47], a[16:19], v[18:21], 0
    buffer_load_dwordx4 v5, s[28:31], s62 offen offset:1024 sc1 lds
    v_cvt_pk_bf16_f32 v72, v48, v49
    v_cvt_pk_bf16_f32 v73, v50, v51
    v_exp_f32 v52, v52
    v_exp_f32 v53, v53
    v_exp_f32 v54, v54
    v_exp_f32 v55, v55
    v_mfma_f32_32x32x8_bf16 v[32:47], a[72:73], v[22:23], v[32:47]
    v_cvt_pk_bf16_f32 v74, v52, v53
    v_cvt_pk_bf16_f32 v75, v54, v55
    v_exp_f32 v56, v56
    v_exp_f32 v57, v57
    v_exp_f32 v58, v58
    v_exp_f32 v59, v59
    v_mfma_f32_32x32x16_bf16 v[80:95], a[116:119], v[68:71], v[80:95]
    buffer_load_dwordx4 v5, s[28:31], s62 offen offset:2048 sc1 lds
    v_cvt_pk_bf16_f32 v76, v56, v57
    v_cvt_pk_bf16_f32 v77, v58, v59
    v_exp_f32 v60, v60
    v_exp_f32 v61, v61
    v_exp_f32 v62, v62
    v_exp_f32 v63, v63
    v_mfma_f32_32x32x16_bf16 v[80:95], a[120:123], v[72:75], v[80:95]
    buffer_load_dwordx4 v5, s[28:31], s62 offen offset:3072 sc1 lds
    v_cvt_pk_bf16_f32 v78, v60, v61
    v_cvt_pk_bf16_f32 v79, v62, v63
    v_exp_f32 v32, v32
    v_exp_f32 v33, v33
    v_exp_f32 v34, v34
    v_exp_f32 v35, v35
    v_mfma_f32_32x32x16_bf16 v[48:63], a[20:23], v[18:21], 0
    s_add_u32 s62, s62, 4096
    v_cvt_pk_bf16_f32 v64, v32, v33
    v_cvt_pk_bf16_f32 v65, v34, v35
    v_exp_f32 v36, v36
    v_exp_f32 v37, v37
    v_exp_f32 v38, v38
    v_exp_f32 v39, v39
    v_mfma_f32_32x32x8_bf16 v[48:63], a[74:75], v[22:23], v[48:63]
    v_cvt_pk_bf16_f32 v66, v36, v37
    v_cvt_pk_bf16_f32 v67, v38, v39
    v_exp_f32 v40, v40
    v_exp_f32 v41, v41
    v_exp_f32 v42, v42
    v_exp_f32 v43, v43
    v_mfma_f32_32x32x16_bf16 v[80:95], a[124:127], v[76:79], v[80:95]
    s_addk_i32 m0, 4096
    v_cvt_pk_bf16_f32 v68, v40, v41
    v_cvt_pk_bf16_f32 v69, v42, v43
    v_exp_f32 v44, v44
    v_exp_f32 v45, v45
    v_exp_f32 v46, v46
    v_exp_f32_e64 v47, v47
    v_mfma_f32_32x32x16_bf16 v[80:95], a[128:131], v[64:67], v[80:95]
    buffer_load_dwordx4 v5, s[28:31], s62 offen offset:0 sc1 lds
    v_cvt_pk_bf16_f32 v70, v44, v45
    v_cvt_pk_bf16_f32 v71, v46, v47
    v_exp_f32 v48, v48
    v_exp_f32 v49, v49
    v_exp_f32 v50, v50
    v_exp_f32 v51, v51
    v_mfma_f32_32x32x16_bf16 v[32:47], a[24:27], v[18:21], 0
    buffer_load_dword v242, v16, s[28:31], s58 offen sc1
    v_cvt_pk_bf16_f32 v72, v48, v49
    v_cvt_pk_bf16_f32 v73, v50, v51
    v_exp_f32 v52, v52
    v_exp_f32 v53, v53
    v_exp_f32 v54, v54
    v_exp_f32 v55, v55
    v_mfma_f32_32x32x8_bf16 v[32:47], a[76:77], v[22:23], v[32:47]
    v_cvt_pk_bf16_f32 v74, v52, v53
    v_cvt_pk_bf16_f32 v75, v54, v55
    v_exp_f32 v56, v56
    v_exp_f32 v57, v57
    v_exp_f32 v58, v58
    v_exp_f32 v59, v59
    v_mfma_f32_32x32x16_bf16 v[80:95], a[132:135], v[68:71], v[80:95]
    s_add_u32 s58, s58, 8192
    v_cvt_pk_bf16_f32 v76, v56, v57
    v_cvt_pk_bf16_f32 v77, v58, v59
    v_exp_f32 v60, v60
    v_exp_f32 v61, v61
    v_exp_f32 v62, v62
    v_exp_f32 v63, v63
    v_mfma_f32_32x32x16_bf16 v[80:95], a[136:139], v[72:75], v[80:95]
    buffer_load_dwordx4 v5, s[28:31], s62 offen offset:1024 sc1 lds
    v_cvt_pk_bf16_f32 v78, v60, v61
    v_cvt_pk_bf16_f32 v79, v62, v63
    v_exp_f32 v32, v32
    v_exp_f32 v33, v33
    v_exp_f32 v34, v34
    v_exp_f32 v35, v35
    v_mfma_f32_32x32x16_bf16 v[48:63], a[28:31], v[18:21], 0
    buffer_load_dwordx4 v5, s[28:31], s62 offen offset:2048 sc1 lds
    v_cvt_pk_bf16_f32 v64, v32, v33
    v_cvt_pk_bf16_f32 v65, v34, v35
    v_exp_f32 v36, v36
    v_exp_f32 v37, v37
    v_exp_f32 v38, v38
    v_exp_f32 v39, v39
    v_mfma_f32_32x32x8_bf16 v[48:63], a[78:79], v[22:23], v[48:63]
    v_cvt_pk_bf16_f32 v66, v36, v37
    v_cvt_pk_bf16_f32 v67, v38, v39
    v_exp_f32 v40, v40
    v_exp_f32 v41, v41
    v_exp_f32 v42, v42
    v_exp_f32 v43, v43
    v_mfma_f32_32x32x16_bf16 v[80:95], a[140:143], v[76:79], v[80:95]
    v_cvt_pk_bf16_f32 v68, v40, v41
    v_cvt_pk_bf16_f32 v69, v42, v43
    v_exp_f32 v44, v44
    v_exp_f32 v45, v45
    v_exp_f32 v46, v46
    v_exp_f32 v47, v47
    v_mfma_f32_32x32x16_bf16 v[80:95], a[144:147], v[64:67], v[80:95]
    buffer_load_dwordx4 v5, s[28:31], s62 offen offset:3072 sc1 lds
    v_cvt_pk_bf16_f32 v70, v44, v45
    v_cvt_pk_bf16_f32 v71, v46, v47
    v_exp_f32 v48, v48
    v_exp_f32 v49, v49
    v_exp_f32 v50, v50
    v_exp_f32 v51, v51
    v_mfma_f32_32x32x16_bf16 v[32:47], a[32:35], v[18:21], 0
    s_add_u32 s62, s62, 4096
    v_cvt_pk_bf16_f32 v72, v48, v49
    v_cvt_pk_bf16_f32 v73, v50, v51
    v_exp_f32 v52, v52
    v_exp_f32 v53, v53
    v_exp_f32 v54, v54
    v_exp_f32 v55, v55
    v_mfma_f32_32x32x8_bf16 v[32:47], a[80:81], v[22:23], v[32:47]
    v_cvt_pk_bf16_f32 v74, v52, v53
    v_cvt_pk_bf16_f32 v75, v54, v55
    v_exp_f32 v56, v56
    v_exp_f32 v57, v57
    v_exp_f32 v58, v58
    v_exp_f32 v59, v59
    v_mfma_f32_32x32x16_bf16 v[80:95], a[148:151], v[68:71], v[80:95]
    s_addk_i32 m0, 4096
    v_cvt_pk_bf16_f32 v76, v56, v57
    v_cvt_pk_bf16_f32 v77, v58, v59
    v_exp_f32 v60, v60
    v_exp_f32 v61, v61
    v_exp_f32 v62, v62
    v_exp_f32_e64 v63, v63
    v_mfma_f32_32x32x16_bf16 v[80:95], a[152:155], v[72:75], v[80:95]
    s_waitcnt vmcnt(13)
    v_cvt_pk_bf16_f32 v78, v60, v61
    v_cvt_pk_bf16_f32 v79, v62, v63
    v_exp_f32 v32, v32
    v_exp_f32 v33, v33
    v_exp_f32 v34, v34
    v_exp_f32_e64 v35, v35
    v_mfma_f32_32x32x16_bf16 v[48:63], a[36:39], v[18:21], 0
    buffer_load_dwordx4 v5, s[28:31], s62 offen offset:0 sc1 lds
    v_cvt_pk_bf16_f32 v64, v32, v33
    v_cvt_pk_bf16_f32 v65, v34, v35
    v_exp_f32 v36, v36
    v_exp_f32 v37, v37
    v_exp_f32 v38, v38
    v_exp_f32 v39, v39
    v_mfma_f32_32x32x8_bf16 v[48:63], a[82:83], v[22:23], v[48:63]
    v_cvt_pk_bf16_f32 v66, v36, v37
    v_cvt_pk_bf16_f32 v67, v38, v39
    v_exp_f32 v40, v40
    v_exp_f32 v41, v41
    v_exp_f32 v42, v42
    v_exp_f32 v43, v43
    v_mfma_f32_32x32x16_bf16 v[80:95], a[156:159], v[76:79], v[80:95]
    v_cvt_pk_bf16_f32 v68, v40, v41
    v_cvt_pk_bf16_f32 v69, v42, v43
    v_exp_f32 v44, v44
    v_exp_f32 v45, v45
    v_exp_f32 v46, v46
    v_exp_f32 v47, v47
    v_mfma_f32_32x32x16_bf16 v[96:111], a[160:163], v[64:67], v[80:95]
    buffer_load_dwordx4 v5, s[28:31], s62 offen offset:1024 sc1 lds
    v_cvt_pk_bf16_f32 v70, v44, v45
    v_cvt_pk_bf16_f32 v71, v46, v47
    v_exp_f32 v48, v48
    v_exp_f32 v49, v49
    v_exp_f32 v50, v50
    v_exp_f32 v51, v51
    v_mfma_f32_32x32x16_bf16 v[32:47], a[40:43], v[18:21], 0
    buffer_load_dwordx4 v5, s[28:31], s62 offen offset:2048 sc1 lds
    v_cvt_pk_bf16_f32 v72, v48, v49
    v_cvt_pk_bf16_f32 v73, v50, v51
    v_exp_f32 v52, v52
    v_exp_f32 v53, v53
    v_exp_f32 v54, v54
    v_exp_f32 v55, v55
    v_mfma_f32_32x32x8_bf16 v[32:47], a[84:85], v[22:23], v[32:47]
    v_cvt_pk_bf16_f32 v74, v52, v53
    v_cvt_pk_bf16_f32 v75, v54, v55
    v_exp_f32 v56, v56
    v_exp_f32 v57, v57
    v_exp_f32 v58, v58
    v_exp_f32 v59, v59
    v_mfma_f32_32x32x16_bf16 v[96:111], a[164:167], v[68:71], v[96:111]
    ds_read_b32 v249, v248 offset:7168
    v_cvt_pk_bf16_f32 v76, v56, v57
    v_cvt_pk_bf16_f32 v77, v58, v59
    v_exp_f32 v60, v60
    v_exp_f32 v61, v61
    v_exp_f32 v62, v62
    v_exp_f32 v63, v63
    v_mfma_f32_32x32x16_bf16 v[96:111], a[168:171], v[72:75], v[96:111]
    ds_read_b128 v[80:83], v248 offset:4096
    v_cvt_pk_bf16_f32 v78, v60, v61
    v_cvt_pk_bf16_f32 v79, v62, v63
    v_exp_f32 v32, v32
    v_exp_f32 v33, v33
    v_exp_f32 v34, v34
    v_exp_f32 v35, v35
    v_mfma_f32_32x32x16_bf16 v[48:63], a[44:47], v[18:21], 0
    ds_read_b128 v[84:87], v248 offset:5120
    v_cvt_pk_bf16_f32 v64, v32, v33
    v_cvt_pk_bf16_f32 v65, v34, v35
    v_exp_f32 v36, v36
    v_exp_f32 v37, v37
    v_exp_f32 v38, v38
    v_exp_f32 v39, v39
    v_mfma_f32_32x32x8_bf16 v[48:63], a[86:87], v[22:23], v[48:63]
    v_cvt_pk_bf16_f32 v66, v36, v37
    v_cvt_pk_bf16_f32 v67, v38, v39
    v_exp_f32 v40, v40
    v_exp_f32 v41, v41
    v_exp_f32 v42, v42
    v_exp_f32 v43, v43
    v_mfma_f32_32x32x16_bf16 v[96:111], a[172:175], v[76:79], v[96:111]
    ds_read_b128 v[88:91], v248 offset:6144
    v_cvt_pk_bf16_f32 v68, v40, v41
    v_cvt_pk_bf16_f32 v69, v42, v43
    v_exp_f32 v44, v44
    v_exp_f32 v45, v45
    v_exp_f32 v46, v46
    v_exp_f32 v47, v47
    v_mfma_f32_32x32x16_bf16 v[96:111], a[176:179], v[64:67], v[96:111]
    buffer_load_dwordx4 v5, s[28:31], s62 offen offset:3072 sc1 lds
    v_cvt_pk_bf16_f32 v70, v44, v45
    v_cvt_pk_bf16_f32 v71, v46, v47
    v_exp_f32 v48, v48
    v_exp_f32 v49, v49
    v_exp_f32 v50, v50
    v_exp_f32 v51, v51
    v_mfma_f32_32x32x16_bf16 v[32:47], a[48:51], v[18:21], 0
    s_add_u32 s62, s62, 4096
    v_cvt_pk_bf16_f32 v72, v48, v49
    v_cvt_pk_bf16_f32 v73, v50, v51
    v_exp_f32 v52, v52
    v_exp_f32 v53, v53
    v_exp_f32 v54, v54
    v_exp_f32 v55, v55
    v_mfma_f32_32x32x8_bf16 v[32:47], a[88:89], v[22:23], v[32:47]
    v_cvt_pk_bf16_f32 v74, v52, v53
    v_cvt_pk_bf16_f32 v75, v54, v55
    v_exp_f32 v56, v56
    v_exp_f32 v57, v57
    v_exp_f32 v58, v58
    v_exp_f32 v59, v59
    v_mfma_f32_32x32x16_bf16 v[96:111], a[180:183], v[68:71], v[96:111]
    s_addk_i32 m0, 4096
    v_cvt_pk_bf16_f32 v76, v56, v57
    v_cvt_pk_bf16_f32 v77, v58, v59
    v_exp_f32 v60, v60
    v_exp_f32 v61, v61
    v_exp_f32 v62, v62
    v_exp_f32_e64 v63, v63
    v_mfma_f32_32x32x16_bf16 v[96:111], a[184:187], v[72:75], v[96:111]
    buffer_load_dwordx4 v5, s[28:31], s62 offen offset:0 sc1 lds
    v_cvt_pk_bf16_f32 v78, v60, v61
    v_cvt_pk_bf16_f32 v79, v62, v63
    v_exp_f32 v32, v32
    v_exp_f32 v33, v33
    v_exp_f32 v34, v34
    v_exp_f32 v35, v35
    v_mfma_f32_32x32x16_bf16 v[48:63], a[52:55], v[18:21], 0
    buffer_load_dword v242, v119, s[28:31], s56 offen sc1
    v_cvt_pk_bf16_f32 v64, v32, v33
    v_cvt_pk_bf16_f32 v65, v34, v35
    v_exp_f32 v36, v36
    v_exp_f32 v37, v37
    v_exp_f32 v38, v38
    v_exp_f32 v39, v39
    v_mfma_f32_32x32x8_bf16 v[48:63], a[90:91], v[22:23], v[48:63]
    v_cvt_pk_bf16_f32 v66, v36, v37
    v_cvt_pk_bf16_f32 v67, v38, v39
    v_exp_f32 v40, v40
    v_exp_f32 v41, v41
    v_exp_f32 v42, v42
    v_exp_f32 v43, v43
    v_mfma_f32_32x32x16_bf16 v[96:111], a[188:191], v[76:79], v[96:111]
    buffer_load_dwordx4 v5, s[28:31], s62 offen offset:1024 sc1 lds
    v_cvt_pk_bf16_f32 v68, v40, v41
    v_cvt_pk_bf16_f32 v69, v42, v43
    v_exp_f32 v44, v44
    v_exp_f32 v45, v45
    v_exp_f32 v46, v46
    v_exp_f32 v47, v47
    v_mfma_f32_32x32x16_bf16 v[96:111], a[192:195], v[64:67], v[96:111]
    buffer_load_dwordx4 v5, s[28:31], s62 offen offset:2048 sc1 lds
    v_cvt_pk_bf16_f32 v70, v44, v45
    v_cvt_pk_bf16_f32 v71, v46, v47
    v_exp_f32 v48, v48
    v_exp_f32 v49, v49
    v_exp_f32 v50, v50
    v_exp_f32 v51, v51
    v_mfma_f32_32x32x16_bf16 v[32:47], a[56:59], v[18:21], 0
    buffer_load_dwordx4 v5, s[28:31], s62 offen offset:3072 sc1 lds
    v_cvt_pk_bf16_f32 v72, v48, v49
    v_cvt_pk_bf16_f32 v73, v50, v51
    v_exp_f32 v52, v52
    v_exp_f32 v53, v53
    v_exp_f32 v54, v54
    v_exp_f32 v55, v55
    v_mfma_f32_32x32x8_bf16 v[32:47], a[92:93], v[22:23], v[32:47]
    v_cvt_pk_bf16_f32 v74, v52, v53
    v_cvt_pk_bf16_f32 v75, v54, v55
    v_exp_f32 v56, v56
    v_exp_f32 v57, v57
    v_exp_f32 v58, v58
    v_exp_f32 v59, v59
    v_mfma_f32_32x32x16_bf16 v[96:111], a[196:199], v[68:71], v[96:111]
    s_add_u32 s62, s62, 4096
    v_cvt_pk_bf16_f32 v76, v56, v57
    v_cvt_pk_bf16_f32 v77, v58, v59
    v_exp_f32 v60, v60
    v_exp_f32 v61, v61
    v_exp_f32 v62, v62
    v_exp_f32 v63, v63
    v_mfma_f32_32x32x16_bf16 v[96:111], a[200:203], v[72:75], v[96:111]
    s_addk_i32 m0, 4096
    v_cvt_pk_bf16_f32 v78, v60, v61
    v_cvt_pk_bf16_f32 v79, v62, v63
    v_exp_f32 v32, v32
    v_exp_f32 v33, v33
    v_exp_f32 v34, v34
    v_exp_f32_e64 v35, v35
    v_mfma_f32_32x32x16_bf16 v[48:63], a[60:63], v[18:21], 0
    ds_read2_b64 v[18:21], v131 offset0:1 offset1:9
    v_cvt_pk_bf16_f32 v64, v32, v33
    v_cvt_pk_bf16_f32 v65, v34, v35
    v_exp_f32 v36, v36
    v_exp_f32 v37, v37
    v_exp_f32 v38, v38
    v_exp_f32 v39, v39
    v_mfma_f32_32x32x8_bf16 v[48:63], a[94:95], v[22:23], v[48:63]
    v_cvt_pk_bf16_f32 v66, v36, v37
    v_cvt_pk_bf16_f32 v67, v38, v39
    v_exp_f32 v40, v40
    v_exp_f32 v41, v41
    v_exp_f32 v42, v42
    v_exp_f32 v43, v43
    v_mfma_f32_32x32x16_bf16 v[96:111], a[204:207], v[76:79], v[96:111]
    ds_read_b64 v[22:23], v255 offset:8
    v_cvt_pk_bf16_f32 v68, v40, v41
    v_cvt_pk_bf16_f32 v69, v42, v43
    v_exp_f32 v44, v44
    v_exp_f32 v45, v45
    v_exp_f32 v46, v46
    v_exp_f32 v47, v47
    v_mfma_f32_32x32x16_bf16 v[96:111], a[208:211], v[64:67], v[96:111]
    s_waitcnt lgkmcnt(1)
    v_cvt_pk_bf16_f32 v70, v44, v45
    v_cvt_pk_bf16_f32 v71, v46, v47
    v_exp_f32 v48, v48
    v_exp_f32 v49, v49
    v_exp_f32 v50, v50
    v_exp_f32_e64 v51, v51
    v_mfma_f32_32x32x16_bf16 v[32:47], a[0:3], v[18:21], 0
    s_waitcnt lgkmcnt(0)
    v_cvt_pk_bf16_f32 v72, v48, v49
    v_cvt_pk_bf16_f32 v73, v50, v51
    v_exp_f32 v52, v52
    v_exp_f32 v53, v53
    v_exp_f32 v54, v54
    v_exp_f32_e64 v55, v55
    v_mfma_f32_32x32x8_bf16 v[32:47], a[64:65], v[22:23], v[32:47]
    v_cmp_ne_u32_e64 vcc, v249, v10
    v_cvt_pk_bf16_f32 v74, v52, v53
    v_cvt_pk_bf16_f32 v75, v54, v55
    v_exp_f32 v56, v56
    v_exp_f32 v57, v57
    v_exp_f32 v58, v58
    v_exp_f32 v59, v59
    v_mfma_f32_32x32x16_bf16 v[96:111], a[212:215], v[68:71], v[96:111]
    s_cbranch_vccnz CH_6
CR_6:
    v_cvt_pk_bf16_f32 v76, v56, v57
    v_cvt_pk_bf16_f32 v77, v58, v59
    v_exp_f32 v60, v60
    v_exp_f32 v61, v61
    v_exp_f32 v62, v62
    v_exp_f32_e64 v63, v63
    v_mfma_f32_32x32x16_bf16 v[96:111], a[216:219], v[72:75], v[96:111]
    buffer_load_dwordx4 v5, s[28:31], s62 offen offset:0 sc1 lds
    v_cvt_pk_bf16_f32 v78, v60, v61
    v_cvt_pk_bf16_f32 v79, v62, v63
    v_exp_f32 v32, v32
    v_exp_f32 v33, v33
    v_exp_f32 v34, v34
    v_exp_f32 v35, v35
    v_mfma_f32_32x32x16_bf16 v[48:63], a[4:7], v[18:21], 0
    buffer_load_dword v242, v16, s[28:31], s58 offen sc1
    v_cvt_pk_bf16_f32 v64, v32, v33
    v_cvt_pk_bf16_f32 v65, v34, v35
    v_exp_f32 v36, v36
    v_exp_f32 v37, v37
    v_exp_f32 v38, v38
    v_exp_f32 v39, v39
    v_mfma_f32_32x32x8_bf16 v[48:63], a[66:67], v[22:23], v[48:63]
    v_cvt_pk_bf16_f32 v66, v36, v37
    v_cvt_pk_bf16_f32 v67, v38, v39
    v_exp_f32 v40, v40
    v_exp_f32 v41, v41
    v_exp_f32 v42, v42
    v_exp_f32 v43, v43
    v_mfma_f32_32x32x16_bf16 v[96:111], a[220:223], v[76:79], v[96:111]
    s_add_u32 s58, s58, 8192
    v_cvt_pk_bf16_f32 v68, v40, v41
    v_cvt_pk_bf16_f32 v69, v42, v43
    v_exp_f32 v44, v44
    v_exp_f32 v45, v45
    v_exp_f32 v46, v46
    v_exp_f32 v47, v47
    v_mfma_f32_32x32x16_bf16 v[80:95], a[96:99], v[64:67], v[80:95]
    buffer_load_dwordx4 v5, s[28:31], s62 offen offset:1024 sc1 lds
    v_cvt_pk_bf16_f32 v70, v44, v45
    v_cvt_pk_bf16_f32 v71, v46, v47
    v_exp_f32 v48, v48
    v_exp_f32 v49, v49
    v_exp_f32 v50, v50
    v_exp_f32 v51, v51
    v_mfma_f32_32x32x16_bf16 v[32:47], a[8:11], v[18:21], 0
    buffer_load_dwordx4 v5, s[28:31], s62 offen offset:2048 sc1 lds
    v_cvt_pk_bf16_f32 v72, v48, v49
    v_cvt_pk_bf16_f32 v73, v50, v51
    v_exp_f32 v52, v52
    v_exp_f32 v53, v53
    v_exp_f32 v54, v54
    v_exp_f32 v55, v55
    v_mfma_f32_32x32x8_bf16 v[32:47], a[68:69], v[22:23], v[32:47]
    v_cvt_pk_bf16_f32 v74, v52, v53
    v_cvt_pk_bf16_f32 v75, v54, v55
    v_exp_f32 v56, v56
    v_exp_f32 v57, v57
    v_exp_f32 v58, v58
    v_exp_f32 v59, v59
    v_mfma_f32_32x32x16_bf16 v[80:95], a[100:103], v[68:71], v[80:95]
    buffer_load_dwordx4 v5, s[28:31], s62 offen offset:3072 sc1 lds
    v_cvt_pk_bf16_f32 v76, v56, v57
    v_cvt_pk_bf16_f32 v77, v58, v59
    v_exp_f32 v60, v60
    v_exp_f32 v61, v61
    v_exp_f32 v62, v62
    v_exp_f32 v63, v63
    v_mfma_f32_32x32x16_bf16 v[80:95], a[104:107], v[72:75], v[80:95]
    s_add_u32 s62, s62, 4096
    v_cvt_pk_bf16_f32 v78, v60, v61
    v_cvt_pk_bf16_f32 v79, v62, v63
    v_exp_f32 v32, v32
    v_exp_f32 v33, v33
    v_exp_f32 v34, v34
    v_exp_f32 v35, v35
    v_mfma_f32_32x32x16_bf16 v[48:63], a[12:15], v[18:21], 0
    s_addk_i32 m0, 4096
    v_cvt_pk_bf16_f32 v64, v32, v33
    v_cvt_pk_bf16_f32 v65, v34, v35
    v_exp_f32 v36, v36
    v_exp_f32 v37, v37
    v_exp_f32 v38, v38
    v_exp_f32_e64 v39, v39
    v_mfma_f32_32x32x8_bf16 v[48:63], a[70:71], v[22:23], v[48:63]
    v_cvt_pk_bf16_f32 v66, v36, v37
    v_cvt_pk_bf16_f32 v67, v38, v39
    v_exp_f32 v40, v40
    v_exp_f32 v41, v41
    v_exp_f32 v42, v42
    v_exp_f32 v43, v43
    v_mfma_f32_32x32x16_bf16 v[80:95], a[108:111], v[76:79], v[80:95]
    buffer_load_dwordx4 v5, s[28:31], s62 offen offset:0 sc1 lds
    v_cvt_pk_bf16_f32 v68, v40, v41
    v_cvt_pk_bf16_f32 v69, v42, v43
    v_exp_f32 v44, v44
    v_exp_f32 v45, v45
    v_exp_f32 v46, v46
    v_exp_f32 v47, v47
    v_mfma_f32_32x32x16_bf16 v[80:95], a[112:115], v[64:67], v[80:95]
    buffer_load_dwordx4 a[224:227], v5, s[28:31], s37 offen offset:0 sc1
    v_mov_b32 v112, v104
    v_mov_b32 v113, v104
    s_nop 1
    v_permlane32_swap_b32 v112, v113
    v_rcp_f32_e64 v112, v113
    v_cvt_pk_bf16_f32 v70, v44, v45
    v_cvt_pk_bf16_f32 v71, v46, v47
    v_exp_f32 v48, v48
    v_exp_f32 v49, v49
    v_exp_f32 v50, v50
    v_exp_f32 v51, v51
    v_mfma_f32_32x32x16_bf16 v[32:47], a[16:19], v[18:21], 0
    buffer_load_dwordx4 a[228:231], v5, s[28:31], s37 offen offset:1024 sc1
    v_mul_f32 v96, v96, v112
    v_mul_f32 v97, v97, v112
    v_mul_f32_e64 v98, v98, v112
    v_cvt_pk_bf16_f32 v72, v48, v49
    v_cvt_pk_bf16_f32 v73, v50, v51
    v_exp_f32 v52, v52
    v_exp_f32 v53, v53
    v_exp_f32 v54, v54
    v_exp_f32 v55, v55
    v_mfma_f32_32x32x8_bf16 v[32:47], a[72:73], v[22:23], v[32:47]
    v_mul_f32 v99, v99, v112
    v_mul_f32 v100, v100, v112
    v_mul_f32_e64 v101, v101, v112
    v_cvt_pk_bf16_f32 v74, v52, v53
    v_cvt_pk_bf16_f32 v75, v54, v55
    v_exp_f32 v56, v56
    v_exp_f32 v57, v57
    v_exp_f32 v58, v58
    v_exp_f32 v59, v59
    v_mfma_f32_32x32x16_bf16 v[80:95], a[116:119], v[68:71], v[80:95]
    v_cvt_pk_bf16_f32 v76, v56, v57
    v_cvt_pk_bf16_f32 v77, v58, v59
    v_exp_f32 v60, v60
    v_exp_f32 v61, v61
    v_exp_f32 v62, v62
    v_exp_f32 v63, v63
    v_mfma_f32_32x32x16_bf16 v[80:95], a[120:123], v[72:75], v[80:95]
    buffer_load_dwordx4 a[232:235], v5, s[28:31], s37 offen offset:2048 sc1
    v_mul_f32 v102, v102, v112
    v_mul_f32 v103, v103, v112
    v_mul_f32_e64 v104, v104, v112
    v_cvt_pk_bf16_f32 v78, v60, v61
    v_cvt_pk_bf16_f32 v79, v62, v63
    v_exp_f32 v32, v32
    v_exp_f32 v33, v33
    v_exp_f32 v34, v34
    v_exp_f32 v35, v35
    v_mfma_f32_32x32x16_bf16 v[48:63], a[20:23], v[18:21], 0
    v_cvt_pk_bf16_f32 v64, v32, v33
    v_cvt_pk_bf16_f32 v65, v34, v35
    v_exp_f32 v36, v36
    v_exp_f32 v37, v37
    v_exp_f32 v38, v38
    v_exp_f32 v39, v39
    v_mfma_f32_32x32x8_bf16 v[48:63], a[74:75], v[22:23], v[48:63]
    v_mul_f32 v105, v105, v112
    v_mul_f32 v106, v106, v112
    v_mul_f32_e64 v107, v107, v112
    v_cvt_pk_bf16_f32 v66, v36, v37
    v_cvt_pk_bf16_f32 v67, v38, v39
    v_exp_f32 v40, v40
    v_exp_f32 v41, v41
    v_exp_f32 v42, v42
    v_exp_f32 v43, v43
    v_mfma_f32_32x32x16_bf16 v[80:95], a[124:127], v[76:79], v[80:95]
    v_cvt_pk_bf16_f32 v68, v40, v41
    v_cvt_pk_bf16_f32 v69, v42, v43
    v_exp_f32 v44, v44
    v_exp_f32 v45, v45
    v_exp_f32 v46, v46
    v_exp_f32 v47, v47
    v_mfma_f32_32x32x16_bf16 v[80:95], a[128:131], v[64:67], v[80:95]
    buffer_load_dwordx4 a[236:239], v5, s[28:31], s37 offen offset:3072 sc1
    v_cvt_pk_bf16_f32 v70, v44, v45
    v_cvt_pk_bf16_f32 v71, v46, v47
    v_exp_f32 v48, v48
    v_exp_f32 v49, v49
    v_exp_f32 v50, v50
    v_exp_f32 v51, v51
    v_mfma_f32_32x32x16_bf16 v[32:47], a[24:27], v[18:21], 0
    s_add_u32 s37, s37, 4096
    v_cvt_pk_bf16_f32 v114, v96, v97
    v_cvt_pk_bf16_f32 v115, v98, v99
    v_cvt_pk_bf16_f32 v116, v100, v101
    v_cvt_pk_bf16_f32 v72, v48, v49
    v_cvt_pk_bf16_f32 v73, v50, v51
    v_exp_f32 v52, v52
    v_exp_f32 v53, v53
    v_exp_f32 v54, v54
    v_exp_f32 v55, v55
    v_mfma_f32_32x32x8_bf16 v[32:47], a[76:77], v[22:23], v[32:47]
    v_cvt_pk_bf16_f32 v117, v102, v103
    v_cvt_pk_bf16_f32 v118, v104, v105
    v_cvt_pk_bf16_f32 v119, v106, v107
    v_cvt_pk_bf16_f32 v74, v52, v53
    v_cvt_pk_bf16_f32 v75, v54, v55
    v_exp_f32 v56, v56
    v_exp_f32 v57, v57
    v_exp_f32 v58, v58
    v_exp_f32 v59, v59
    v_mfma_f32_32x32x16_bf16 v[80:95], a[132:135], v[68:71], v[80:95]
    v_cvt_pk_bf16_f32 v76, v56, v57
    v_cvt_pk_bf16_f32 v77, v58, v59
    v_exp_f32 v60, v60
    v_exp_f32 v61, v61
    v_exp_f32 v62, v62
    v_exp_f32 v63, v63
    v_mfma_f32_32x32x16_bf16 v[80:95], a[136:139], v[72:75], v[80:95]
    buffer_load_dwordx4 a[240:243], v5, s[28:31], s37 offen offset:0 sc1
    v_cvt_pk_bf16_f32 v78, v60, v61
    v_cvt_pk_bf16_f32 v79, v62, v63
    v_exp_f32 v32, v32
    v_exp_f32 v33, v33
    v_exp_f32 v34, v34
    v_exp_f32 v35, v35
    v_mfma_f32_32x32x16_bf16 v[48:63], a[28:31], v[18:21], 0
    buffer_load_dwordx4 a[244:247], v5, s[28:31], s37 offen offset:1024 sc1
    v_cvt_pk_bf16_f32 v64, v32, v33
    v_cvt_pk_bf16_f32 v65, v34, v35
    v_exp_f32 v36, v36
    v_exp_f32 v37, v37
    v_exp_f32 v38, v38
    v_exp_f32 v39, v39
    v_mfma_f32_32x32x8_bf16 v[48:63], a[78:79], v[22:23], v[48:63]
    v_cvt_pk_bf16_f32 v66, v36, v37
    v_cvt_pk_bf16_f32 v67, v38, v39
    v_exp_f32 v40, v40
    v_exp_f32 v41, v41
    v_exp_f32 v42, v42
    v_exp_f32 v43, v43
    v_mfma_f32_32x32x16_bf16 v[80:95], a[140:143], v[76:79], v[80:95]
    buffer_store_dwordx4 v[114:117], v13, s[28:31], s42 offen offset:0
    v_cvt_pk_bf16_f32 v68, v40, v41
    v_cvt_pk_bf16_f32 v69, v42, v43
    v_exp_f32 v44, v44
    v_exp_f32 v45, v45
    v_exp_f32 v46, v46
    v_exp_f32 v47, v47
    v_mfma_f32_32x32x16_bf16 v[80:95], a[144:147], v[64:67], v[80:95]
    buffer_store_dwordx2 v[118:119], v14, s[28:31], s42 offen offset:0
    v_cvt_pk_bf16_f32 v70, v44, v45
    v_cvt_pk_bf16_f32 v71, v46, v47
    v_exp_f32 v48, v48
    v_exp_f32 v49, v49
    v_exp_f32 v50, v50
    v_exp_f32 v51, v51
    v_mfma_f32_32x32x16_bf16 v[32:47], a[32:35], v[18:21], 0
    buffer_load_dwordx4 a[248:251], v5, s[28:31], s37 offen offset:2048 sc1
    v_cvt_pk_bf16_f32 v72, v48, v49
    v_cvt_pk_bf16_f32 v73, v50, v51
    v_exp_f32 v52, v52
    v_exp_f32 v53, v53
    v_exp_f32 v54, v54
    v_exp_f32 v55, v55
    v_mfma_f32_32x32x8_bf16 v[32:47], a[80:81], v[22:23], v[32:47]
    v_cvt_pk_bf16_f32 v74, v52, v53
    v_cvt_pk_bf16_f32 v75, v54, v55
    v_exp_f32 v56, v56
    v_exp_f32 v57, v57
    v_exp_f32 v58, v58
    v_exp_f32 v59, v59
    v_mfma_f32_32x32x16_bf16 v[80:95], a[148:151], v[68:71], v[80:95]
    s_getpc_b64 s[14:15]
    s_add_u32 s14, s14, 3072
    s_addc_u32 s15, s15, 0
    v_cvt_pk_bf16_f32 v76, v56, v57
    v_cvt_pk_bf16_f32 v77, v58, v59
    v_exp_f32 v60, v60
    v_exp_f32 v61, v61
    v_exp_f32 v62, v62
    v_exp_f32 v63, v63
    v_mfma_f32_32x32x16_bf16 v[80:95], a[152:155], v[72:75], v[80:95]
    global_load_dword v242, v245, s[14:15]
    v_cvt_pk_bf16_f32 v78, v60, v61
    v_cvt_pk_bf16_f32 v79, v62, v63
    v_exp_f32 v32, v32
    v_exp_f32 v33, v33
    v_exp_f32 v34, v34
    v_exp_f32 v35, v35
    v_mfma_f32_32x32x16_bf16 v[48:63], a[36:39], v[18:21], 0
    buffer_load_dwordx4 a[252:255], v5, s[28:31], s37 offen offset:3072 sc1
    v_cvt_pk_bf16_f32 v64, v32, v33
    v_cvt_pk_bf16_f32 v65, v34, v35
    v_exp_f32 v36, v36
    v_exp_f32 v37, v37
    v_exp_f32 v38, v38
    v_exp_f32 v39, v39
    v_mfma_f32_32x32x8_bf16 v[48:63], a[82:83], v[22:23], v[48:63]
    v_cvt_pk_bf16_f32 v66, v36, v37
    v_cvt_pk_bf16_f32 v67, v38, v39
    v_exp_f32 v40, v40
    v_exp_f32 v41, v41
    v_exp_f32 v42, v42
    v_exp_f32 v43, v43
    v_mfma_f32_32x32x16_bf16 v[80:95], a[156:159], v[76:79], v[80:95]
    s_add_u32 s37, s37, 4096
    v_cvt_pk_bf16_f32 v68, v40, v41
    v_cvt_pk_bf16_f32 v69, v42, v43
    v_exp_f32 v44, v44
    v_exp_f32 v45, v45
    v_exp_f32 v46, v46
    v_exp_f32 v47, v47
    v_mfma_f32_32x32x16_bf16 v[96:111], a[160:163], v[64:67], v[80:95]
    buffer_load_dwordx4 v[24:27], v5, s[28:31], s37 offen offset:0 sc1
    v_cvt_pk_bf16_f32 v70, v44, v45
    v_cvt_pk_bf16_f32 v71, v46, v47
    v_exp_f32 v48, v48
    v_exp_f32 v49, v49
    v_exp_f32 v50, v50
    v_exp_f32 v51, v51
    v_mfma_f32_32x32x16_bf16 v[32:47], a[40:43], v[18:21], 0
    v_cvt_pk_bf16_f32 v72, v48, v49
    v_cvt_pk_bf16_f32 v73, v50, v51
    v_exp_f32 v52, v52
    v_exp_f32 v53, v53
    v_exp_f32 v54, v54
    v_exp_f32 v55, v55
    v_mfma_f32_32x32x8_bf16 v[32:47], a[84:85], v[22:23], v[32:47]
    v_cvt_pk_bf16_f32 v74, v52, v53
    v_cvt_pk_bf16_f32 v75, v54, v55
    v_exp_f32 v56, v56
    v_exp_f32 v57, v57
    v_exp_f32 v58, v58
    v_exp_f32 v59, v59
    v_mfma_f32_32x32x16_bf16 v[96:111], a[164:167], v[68:71], v[96:111]
    v_cvt_pk_bf16_f32 v76, v56, v57
    v_cvt_pk_bf16_f32 v77, v58, v59
    v_exp_f32 v60, v60
    v_exp_f32 v61, v61
    v_exp_f32 v62, v62
    v_exp_f32 v63, v63
    v_mfma_f32_32x32x16_bf16 v[96:111], a[168:171], v[72:75], v[96:111]
    buffer_load_dwordx4 v[28:31], v5, s[28:31], s37 offen offset:1024 sc1
    v_cvt_pk_bf16_f32 v78, v60, v61
    v_cvt_pk_bf16_f32 v79, v62, v63
    v_exp_f32 v32, v32
    v_exp_f32 v33, v33
    v_exp_f32 v34, v34
    v_exp_f32 v35, v35
    v_mfma_f32_32x32x16_bf16 v[48:63], a[44:47], v[18:21], 0
    v_cvt_pk_bf16_f32 v64, v32, v33
    v_cvt_pk_bf16_f32 v65, v34, v35
    v_exp_f32 v36, v36
    v_exp_f32 v37, v37
    v_exp_f32 v38, v38
    v_exp_f32 v39, v39
    v_mfma_f32_32x32x8_bf16 v[48:63], a[86:87], v[22:23], v[48:63]
    v_cvt_pk_bf16_f32 v66, v36, v37
    v_cvt_pk_bf16_f32 v67, v38, v39
    v_exp_f32 v40, v40
    v_exp_f32 v41, v41
    v_exp_f32 v42, v42
    v_exp_f32 v43, v43
    v_mfma_f32_32x32x16_bf16 v[96:111], a[172:175], v[76:79], v[96:111]
    v_cvt_pk_bf16_f32 v68, v40, v41
    v_cvt_pk_bf16_f32 v69, v42, v43
    v_exp_f32 v44, v44
    v_exp_f32 v45, v45
    v_exp_f32 v46, v46
    v_exp_f32 v47, v47
    v_mfma_f32_32x32x16_bf16 v[96:111], a[176:179], v[64:67], v[96:111]
    v_cvt_pk_bf16_f32 v70, v44, v45
    v_cvt_pk_bf16_f32 v71, v46, v47
    v_exp_f32 v48, v48
    v_exp_f32 v49, v49
    v_exp_f32 v50, v50
    v_exp_f32 v51, v51
    v_mfma_f32_32x32x16_bf16 v[32:47], a[48:51], v[18:21], 0
    v_cvt_pk_bf16_f32 v72, v48, v49
    v_cvt_pk_bf16_f32 v73, v50, v51
    v_exp_f32 v52, v52
    v_exp_f32 v53, v53
    v_exp_f32 v54, v54
    v_exp_f32 v55, v55
    v_mfma_f32_32x32x8_bf16 v[32:47], a[88:89], v[22:23], v[32:47]
    v_cvt_pk_bf16_f32 v74, v52, v53
    v_cvt_pk_bf16_f32 v75, v54, v55
    v_exp_f32 v56, v56
    v_exp_f32 v57, v57
    v_exp_f32 v58, v58
    v_exp_f32 v59, v59
    v_mfma_f32_32x32x16_bf16 v[96:111], a[180:183], v[68:71], v[96:111]
    v_cvt_pk_bf16_f32 v76, v56, v57
    v_cvt_pk_bf16_f32 v77, v58, v59
    v_exp_f32 v60, v60
    v_exp_f32 v61, v61
    v_exp_f32 v62, v62
    v_exp_f32 v63, v63
    v_mfma_f32_32x32x16_bf16 v[96:111], a[184:187], v[72:75], v[96:111]
    s_getpc_b64 s[14:15]
    s_add_u32 s14, s14, 9216
    s_addc_u32 s15, s15, 0
    v_cvt_pk_bf16_f32 v78, v60, v61
    v_cvt_pk_bf16_f32 v79, v62, v63
    v_exp_f32 v32, v32
    v_exp_f32 v33, v33
    v_exp_f32 v34, v34
    v_exp_f32 v35, v35
    v_mfma_f32_32x32x16_bf16 v[48:63], a[52:55], v[18:21], 0
    global_load_dword v242, v245, s[14:15]
    v_cvt_pk_bf16_f32 v64, v32, v33
    v_cvt_pk_bf16_f32 v65, v34, v35
    v_exp_f32 v36, v36
    v_exp_f32 v37, v37
    v_exp_f32 v38, v38
    v_exp_f32 v39, v39
    v_mfma_f32_32x32x8_bf16 v[48:63], a[90:91], v[22:23], v[48:63]
    v_cvt_pk_bf16_f32 v66, v36, v37
    v_cvt_pk_bf16_f32 v67, v38, v39
    v_exp_f32 v40, v40
    v_exp_f32 v41, v41
    v_exp_f32 v42, v42
    v_exp_f32 v43, v43
    v_mfma_f32_32x32x16_bf16 v[96:111], a[188:191], v[76:79], v[96:111]
    v_cvt_pk_bf16_f32 v68, v40, v41
    v_cvt_pk_bf16_f32 v69, v42, v43
    v_exp_f32 v44, v44
    v_exp_f32 v45, v45
    v_exp_f32 v46, v46
    v_exp_f32 v47, v47
    v_mfma_f32_32x32x16_bf16 v[96:111], a[192:195], v[64:67], v[96:111]
    v_cvt_pk_bf16_f32 v70, v44, v45
    v_cvt_pk_bf16_f32 v71, v46, v47
    v_exp_f32 v48, v48
    v_exp_f32 v49, v49
    v_exp_f32 v50, v50
    v_exp_f32 v51, v51
    v_mfma_f32_32x32x16_bf16 v[32:47], a[56:59], v[18:21], 0
    v_cvt_pk_bf16_f32 v72, v48, v49
    v_cvt_pk_bf16_f32 v73, v50, v51
    v_exp_f32 v52, v52
    v_exp_f32 v53, v53
    v_exp_f32 v54, v54
    v_exp_f32 v55, v55
    v_mfma_f32_32x32x8_bf16 v[32:47], a[92:93], v[22:23], v[32:47]
    v_cvt_pk_bf16_f32 v74, v52, v53
    v_cvt_pk_bf16_f32 v75, v54, v55
    v_exp_f32 v56, v56
    v_exp_f32 v57, v57
    v_exp_f32 v58, v58
    v_exp_f32 v59, v59
    v_mfma_f32_32x32x16_bf16 v[96:111], a[196:199], v[68:71], v[96:111]
    v_cvt_pk_bf16_f32 v76, v56, v57
    v_cvt_pk_bf16_f32 v77, v58, v59
    v_exp_f32 v60, v60
    v_exp_f32 v61, v61
    v_exp_f32 v62, v62
    v_exp_f32 v63, v63
    v_mfma_f32_32x32x16_bf16 v[96:111], a[200:203], v[72:75], v[96:111]
    v_cvt_pk_bf16_f32 v78, v60, v61
    v_cvt_pk_bf16_f32 v79, v62, v63
    v_exp_f32 v32, v32
    v_exp_f32 v33, v33
    v_exp_f32 v34, v34
    v_exp_f32 v35, v35
    v_mfma_f32_32x32x16_bf16 v[48:63], a[60:63], v[18:21], 0
    v_cvt_pk_bf16_f32 v64, v32, v33
    v_cvt_pk_bf16_f32 v65, v34, v35
    v_exp_f32 v36, v36
    v_exp_f32 v37, v37
    v_exp_f32 v38, v38
    v_exp_f32 v39, v39
    v_mfma_f32_32x32x8_bf16 v[48:63], a[94:95], v[22:23], v[48:63]
    v_cvt_pk_bf16_f32 v66, v36, v37
    v_cvt_pk_bf16_f32 v67, v38, v39
    v_exp_f32 v40, v40
    v_exp_f32 v41, v41
    v_exp_f32 v42, v42
    v_exp_f32 v43, v43
    v_mfma_f32_32x32x16_bf16 v[96:111], a[204:207], v[76:79], v[96:111]
    v_cvt_pk_bf16_f32 v68, v40, v41
    v_cvt_pk_bf16_f32 v69, v42, v43
    v_exp_f32 v44, v44
    v_exp_f32 v45, v45
    v_exp_f32 v46, v46
    v_exp_f32 v47, v47
    v_mfma_f32_32x32x16_bf16 v[96:111], a[208:211], v[64:67], v[96:111]
    v_cvt_pk_bf16_f32 v70, v44, v45
    v_cvt_pk_bf16_f32 v71, v46, v47
    v_exp_f32 v48, v48
    v_exp_f32 v49, v49
    v_exp_f32 v50, v50
    v_exp_f32 v51, v51
    v_cvt_pk_bf16_f32 v72, v48, v49
    v_cvt_pk_bf16_f32 v73, v50, v51
    v_exp_f32 v52, v52
    v_exp_f32 v53, v53
    v_exp_f32 v54, v54
    v_exp_f32 v55, v55
    v_cvt_pk_bf16_f32 v74, v52, v53
    v_cvt_pk_bf16_f32 v75, v54, v55
    v_exp_f32 v56, v56
    v_exp_f32 v57, v57
    v_exp_f32 v58, v58
    v_exp_f32 v59, v59
    v_mfma_f32_32x32x16_bf16 v[96:111], a[212:215], v[68:71], v[96:111]
    v_cvt_pk_bf16_f32 v76, v56, v57
    v_cvt_pk_bf16_f32 v77, v58, v59
    v_exp_f32 v60, v60
    v_exp_f32 v61, v61
    v_exp_f32 v62, v62
    v_exp_f32 v63, v63
    v_mfma_f32_32x32x16_bf16 v[96:111], a[216:219], v[72:75], v[96:111]
    v_cvt_pk_bf16_f32 v78, v60, v61
    v_cvt_pk_bf16_f32 v79, v62, v63
    s_nop 1
    v_mfma_f32_32x32x16_bf16 v[96:111], a[220:223], v[76:79], v[96:111]
    s_cmp_eq_u32 s32, 3
    s_cselect_b32 s60, 0x7f000000, 0
    v_or_b32 v6, s60, v5
    s_nop 8
    v_mov_b32 v112, v104
    v_mov_b32 v113, v104
    s_nop 1
    v_permlane32_swap_b32 v112, v113
    v_rcp_f32 v112, v113
    s_nop 0
    v_pk_mul_f32 v[96:97], v[96:97], v[112:113] op_sel_hi:[1,0]
    v_pk_mul_f32 v[98:99], v[98:99], v[112:113] op_sel_hi:[1,0]
    v_pk_mul_f32 v[100:101], v[100:101], v[112:113] op_sel_hi:[1,0]
    v_pk_mul_f32 v[102:103], v[102:103], v[112:113] op_sel_hi:[1,0]
    v_pk_mul_f32 v[104:105], v[104:105], v[112:113] op_sel_hi:[1,0]
    v_pk_mul_f32 v[106:107], v[106:107], v[112:113] op_sel_hi:[1,0]
    v_cvt_pk_bf16_f32 v114, v96, v97
    v_cvt_pk_bf16_f32 v115, v98, v99
    v_cvt_pk_bf16_f32 v116, v100, v101
    v_cvt_pk_bf16_f32 v117, v102, v103
    buffer_store_dwordx4 v[114:117], v13, s[28:31], s42 offen offset:16
    v_cvt_pk_bf16_f32 v118, v104, v105
    v_cvt_pk_bf16_f32 v119, v106, v107
    buffer_store_dwordx2 v[118:119], v14, s[28:31], s42 offen offset:16
K2_FINAL:
    s_add_u32 s63, s55, 0
    buffer_load_dwordx4 a[0:3], v5, s[28:31], s63 offen offset:0 sc1
    buffer_load_dwordx4 a[4:7], v5, s[28:31], s63 offen offset:1024 sc1
    buffer_load_dwordx4 a[8:11], v5, s[28:31], s63 offen offset:2048 sc1
    buffer_load_dwordx4 a[12:15], v5, s[28:31], s63 offen offset:3072 sc1
    s_add_u32 s63, s55, 4096
    buffer_load_dwordx4 a[16:19], v5, s[28:31], s63 offen offset:0 sc1
    buffer_load_dwordx4 a[20:23], v5, s[28:31], s63 offen offset:1024 sc1
    buffer_load_dwordx4 a[24:27], v5, s[28:31], s63 offen offset:2048 sc1
    buffer_load_dwordx4 a[28:31], v5, s[28:31], s63 offen offset:3072 sc1
    s_mul_i32 s35, s32, 5120
    s_add_u32 s35, s35, 0
    s_add_u32 s34, s32, 1
    s_and_b32 s34, s34, 3
    s_add_u32 s34, s34, s44
    s_mul_i32 s34, s34, 55296
    s_add_u32 s70, s34, s35
    s_add_u32 s34, s32, 2
    s_and_b32 s34, s34, 3
    s_add_u32 s34, s34, s44
    s_mul_i32 s34, s34, 55296
    s_add_u32 s71, s34, s35
    s_add_u32 s34, s32, 3
    s_and_b32 s34, s34, 3
    s_add_u32 s34, s34, s44
    s_mul_i32 s34, s34, 55296
    s_add_u32 s72, s34, s35
    s_add_u32 s34, s32, 4
    s_and_b32 s34, s34, 3
    s_add_u32 s34, s34, s44
    s_mul_i32 s34, s34, 55296
    s_add_u32 s73, s34, s35
    s_and_b32 s34, s33, 8
    s_lshl_b32 s34, s34, 2
    v_and_b32 v17, 31, v1
    v_add_u32 v17, s34, v17
    v_mov_b32_e64 v2, s57
    v_lshlrev_b32 v3, 24, v1
    s_cmp_eq_u32 s57, 1
    s_waitcnt vmcnt(8)
    s_cbranch_scc0 K2_SS2
    buffer_store_byte v2, v3, s[28:31], s59 offen offset:128
K2_SR2:
    s_add_u32 s63, s55, 8192
    buffer_load_dwordx4 a[32:35], v5, s[28:31], s63 offen offset:0 sc1
    buffer_load_dwordx4 a[36:39], v5, s[28:31], s63 offen offset:1024 sc1
    buffer_load_dwordx4 a[40:43], v5, s[28:31], s63 offen offset:2048 sc1
    buffer_load_dwordx4 a[44:47], v5, s[28:31], s63 offen offset:3072 sc1
    s_barrier
    s_mov_b32 s3, 0x100000
PL_11:
    buffer_load_ubyte v2, v17, s[28:31], s56 offen offset:128 sc1
    s_sub_u32 s3, s3, 1
    s_cbranch_scc1 PL_11x
    s_waitcnt vmcnt(0)
    v_cmp_eq_u32 vcc, 0, v2
    s_cbranch_vccnz PL_11
    v_cmp_ne_u32 vcc, 1, v2
    s_cbranch_vccnz PL_11a
PL_11x:
    buffer_load_dwordx4 a[144:147], v5, s[28:31], s70 offen offset:0 sc1
    buffer_load_dwordx4 a[148:151], v5, s[28:31], s70 offen offset:1024 sc1
    s_add_u32 s34, s32, 1
    s_and_b32 s34, s34, 3
    s_mul_i32 s34, s34, 10240
    s_add_u32 s34, s34, 102400
    v_add_u32_e64 v13, s34, v5
    s_add_u32 s34, s32, 2
    s_and_b32 s34, s34, 3
    buffer_load_dwordx4 a[152:155], v5, s[28:31], s70 offen offset:2048 sc1
    s_mul_i32 s34, s34, 10240
    s_add_u32 s34, s34, 107520
    v_add_u32_e64 v14, s34, v5
    s_add_u32 s34, s32, 3
    s_and_b32 s34, s34, 3
    s_mul_i32 s34, s34, 5120
    s_add_u32 s34, s34, 143360
    v_add_u32_e64 v15, s34, v5
    s_add_u32 s34, s32, 4
    s_and_b32 s34, s34, 3
    s_mul_i32 s34, s34, 10240
    buffer_load_dwordx4 a[156:159], v5, s[28:31], s70 offen offset:3072 sc1
    s_add_u32 s34, s34, 102400
    v_add_u32_e64 v16, s34, v5
    s_add_u32 s34, s32, 4
    s_and_b32 s34, s34, 3
    s_mul_i32 s34, s34, 5120
    s_add_u32 s34, s34, 143360
    v_add_u32 v23, s34, v5
    v_add_f32 v232, v232, v233
    v_add_f32 v234, v234, v235
    v_add_f32 v236, v236, v237
    s_add_u32 s70, s70, 4096
    buffer_load_dwordx4 a[160:163], v5, s[28:31], s70 offen offset:0 sc1
    v_add_f32 v238, v238, v239
    v_add_f32 v232, v232, v234
    v_add_f32 v236, v236, v238
    v_add_f32 v252, v232, v236
    v_lshlrev_b32 v253, 16, v253
    v_lshlrev_b32 v232, 16, v120
    v_and_b32 v233, 0xffff0000, v120
    v_lshlrev_b32_e64 v234, 16, v121
    v_and_b32 v235, 0xffff0000, v121
    v_lshlrev_b32_e64 v236, 16, v122
    buffer_load_dwordx4 a[164:167], v5, s[28:31], s71 offen offset:0 sc1
    v_and_b32 v237, 0xffff0000, v122
    v_lshlrev_b32_e64 v238, 16, v123
    v_and_b32 v239, 0xffff0000, v123
    v_lshlrev_b32_e64 v240, 16, v124
    v_and_b32 v241, 0xffff0000, v124
    v_lshlrev_b32_e64 v242, 16, v125
    v_and_b32 v243, 0xffff0000, v125
    v_lshlrev_b32_e64 v244, 16, v126
    v_and_b32 v245, 0xffff0000, v126
    v_lshlrev_b32_e64 v246, 16, v127
    v_and_b32 v247, 0xffff0000, v127
    buffer_load_dwordx4 a[168:171], v5, s[28:31], s71 offen offset:1024 sc1
    v_lshlrev_b32_e64 v248, 16, v128
    v_and_b32 v249, 0xffff0000, v128
    v_lshlrev_b32_e64 v250, 16, v129
    v_and_b32 v251, 0xffff0000, v129
    s_add_u32 s34, s44, s32
    s_mul_i32 s35, s34, 20480
    s_add_u32 s35, s35, 0
    s_lshl_b32 s60, s45, 10
    s_add_u32 s60, s60, s35
    s_lshl_b32 s61, s46, 7
    buffer_load_dwordx4 a[172:175], v5, s[28:31], s71 offen offset:2048 sc1
    s_add_u32 s61, s61, s47
    s_lshl_b32 s61, s61, 3
    s_add_u32 s61, s61, s35
    v_lshlrev_b32 v4, 3, v1
    s_lshl_b32 s34, s34, 3
    s_add_u32 s34, s34, s43
    s_lshl_b32 s34, s34, 7
    s_add_u32 s34, s34, 7340032
    v_mov_b32_e64 v18, 0
    v_mov_b32 v19, 0
    s_waitcnt vmcnt(7)
    v_mfma_f32_16x16x32_bf16 v[32:35], v[132:135], a[144:147], 0
    v_mfma_f32_16x16x32_bf16 v[36:39], v[136:139], a[144:147], 0
    buffer_load_dwordx4 a[176:179], v5, s[28:31], s71 offen offset:3072 sc1
    v_mfma_f32_16x16x32_bf16 v[40:43], v[140:143], a[144:147], 0
    v_mfma_f32_16x16x32_bf16 v[44:47], v[144:147], a[144:147], 0
    v_mfma_f32_16x16x32_bf16 v[48:51], v[148:151], a[144:147], 0
    s_waitcnt vmcnt(7)
    v_mfma_f32_16x16x32_bf16 v[32:35], v[152:155], a[148:151], v[32:35]
    v_mfma_f32_16x16x32_bf16 v[36:39], v[156:159], a[148:151], v[36:39]
    s_add_u32 s71, s71, 4096
    buffer_load_dwordx4 a[180:183], v5, s[28:31], s71 offen offset:0 sc1
    v_mfma_f32_16x16x32_bf16 v[40:43], v[160:163], a[148:151], v[40:43]
    v_mfma_f32_16x16x32_bf16 v[44:47], v[164:167], a[148:151], v[44:47]
    v_mfma_f32_16x16x32_bf16 v[48:51], v[168:171], a[148:151], v[48:51]
    s_waitcnt vmcnt(7)
    v_mfma_f32_16x16x32_bf16 v[32:35], v[172:175], a[152:155], v[32:35]
    v_mfma_f32_16x16x32_bf16 v[36:39], v[176:179], a[152:155], v[36:39]
    buffer_load_dwordx4 a[184:187], v5, s[28:31], s72 offen offset:0 sc1
    v_mfma_f32_16x16x32_bf16 v[40:43], v[180:183], a[152:155], v[40:43]
    v_mfma_f32_16x16x32_bf16 v[44:47], v[184:187], a[152:155], v[44:47]
    v_mfma_f32_16x16x32_bf16 v[48:51], v[188:191], a[152:155], v[48:51]
    s_waitcnt vmcnt(7)
    v_mfma_f32_16x16x32_bf16 v[32:35], v[192:195], a[156:159], v[32:35]
    v_mfma_f32_16x16x32_bf16 v[36:39], v[196:199], a[156:159], v[36:39]
    buffer_load_dwordx4 a[188:191], v5, s[28:31], s72 offen offset:1024 sc1
    v_mfma_f32_16x16x32_bf16 v[40:43], v[200:203], a[156:159], v[40:43]
    v_mfma_f32_16x16x32_bf16 v[44:47], v[204:207], a[156:159], v[44:47]
    v_mfma_f32_16x16x32_bf16 v[48:51], v[208:211], a[156:159], v[48:51]
    s_waitcnt vmcnt(7)
    v_mfma_f32_16x16x32_bf16 v[32:35], v[212:215], a[160:163], v[32:35]
    v_mfma_f32_16x16x32_bf16 v[36:39], v[216:219], a[160:163], v[36:39]
    buffer_load_dwordx4 a[192:195], v5, s[28:31], s72 offen offset:2048 sc1
    v_mfma_f32_16x16x32_bf16 v[40:43], v[220:223], a[160:163], v[40:43]
    v_mfma_f32_16x16x32_bf16 v[44:47], v[224:227], a[160:163], v[44:47]
    v_mfma_f32_16x16x32_bf16 v[48:51], v[228:231], a[160:163], v[48:51]
    s_waitcnt vmcnt(7)
    v_mfma_f32_16x16x32_bf16 v[52:55], v[132:135], a[164:167], 0
    v_mfma_f32_16x16x32_bf16 v[56:59], v[136:139], a[164:167], 0
    buffer_load_dwordx4 a[196:199], v5, s[28:31], s72 offen offset:3072 sc1
    v_mfma_f32_16x16x32_bf16 v[60:63], v[140:143], a[164:167], 0
    v_mfma_f32_16x16x32_bf16 v[64:67], v[144:147], a[164:167], 0
    v_mfma_f32_16x16x32_bf16 v[68:71], v[148:151], a[164:167], 0
    s_waitcnt vmcnt(7)
    ds_write_b128 v13, v[32:35] offset:0
    v_mfma_f32_16x16x32_bf16 v[52:55], v[152:155], a[168:171], v[52:55]
    ds_write_b128 v13, v[36:39] offset:1024
    v_mfma_f32_16x16x32_bf16 v[56:59], v[156:159], a[168:171], v[56:59]
    s_add_u32 s72, s72, 4096
    buffer_load_dwordx4 a[200:203], v5, s[28:31], s72 offen offset:0 sc1
    ds_write_b128 v13, v[40:43] offset:2048
    v_mfma_f32_16x16x32_bf16 v[60:63], v[160:163], a[168:171], v[60:63]
    ds_write_b128 v13, v[44:47] offset:3072
    v_mfma_f32_16x16x32_bf16 v[64:67], v[164:167], a[168:171], v[64:67]
    ds_write_b128 v13, v[48:51] offset:4096
    v_mfma_f32_16x16x32_bf16 v[68:71], v[168:171], a[168:171], v[68:71]
    s_waitcnt vmcnt(7)
    v_mfma_f32_16x16x32_bf16 v[52:55], v[172:175], a[172:175], v[52:55]
    v_mfma_f32_16x16x32_bf16 v[56:59], v[176:179], a[172:175], v[56:59]
    buffer_load_dwordx4 a[204:207], v5, s[28:31], s73 offen offset:0 sc1
    v_mfma_f32_16x16x32_bf16 v[60:63], v[180:183], a[172:175], v[60:63]
    v_mfma_f32_16x16x32_bf16 v[64:67], v[184:187], a[172:175], v[64:67]
    v_mfma_f32_16x16x32_bf16 v[68:71], v[188:191], a[172:175], v[68:71]
    s_waitcnt vmcnt(7)
    v_mfma_f32_16x16x32_bf16 v[52:55], v[192:195], a[176:179], v[52:55]
    v_mfma_f32_16x16x32_bf16 v[56:59], v[196:199], a[176:179], v[56:59]
    buffer_load_dwordx4 a[208:211], v5, s[28:31], s73 offen offset:1024 sc1
    v_mfma_f32_16x16x32_bf16 v[60:63], v[200:203], a[176:179], v[60:63]
    v_mfma_f32_16x16x32_bf16 v[64:67], v[204:207], a[176:179], v[64:67]
    v_mfma_f32_16x16x32_bf16 v[68:71], v[208:211], a[176:179], v[68:71]
    s_waitcnt vmcnt(7)
    v_mfma_f32_16x16x32_bf16 v[52:55], v[212:215], a[180:183], v[52:55]
    v_mfma_f32_16x16x32_bf16 v[56:59], v[216:219], a[180:183], v[56:59]
    buffer_load_dwordx4 a[212:215], v5, s[28:31], s73 offen offset:2048 sc1
    v_mfma_f32_16x16x32_bf16 v[60:63], v[220:223], a[180:183], v[60:63]
    v_mfma_f32_16x16x32_bf16 v[64:67], v[224:227], a[180:183], v[64:67]
    v_mfma_f32_16x16x32_bf16 v[68:71], v[228:231], a[180:183], v[68:71]
    s_waitcnt vmcnt(7)
    v_mfma_f32_16x16x32_bf16 v[32:35], v[132:135], a[184:187], 0
    s_add_u32 s63, s55, 12288
    buffer_load_dwordx4 a[48:51], v5, s[28:31], s63 offen offset:0 sc1
    v_mfma_f32_16x16x32_bf16 v[36:39], v[136:139], a[184:187], 0
    buffer_load_dwordx4 a[216:219], v5, s[28:31], s73 offen offset:3072 sc1
    v_mfma_f32_16x16x32_bf16 v[40:43], v[140:143], a[184:187], 0
    v_mfma_f32_16x16x32_bf16 v[44:47], v[144:147], a[184:187], 0
    v_mfma_f32_16x16x32_bf16 v[48:51], v[148:151], a[184:187], 0
    s_waitcnt vmcnt(8)
    ds_write_b128 v14, v[52:55] offset:0
    v_mfma_f32_16x16x32_bf16 v[32:35], v[152:155], a[188:191], v[32:35]
    ds_write_b128 v14, v[56:59] offset:1024
    buffer_load_dwordx4 a[52:55], v5, s[28:31], s63 offen offset:1024 sc1
    v_mfma_f32_16x16x32_bf16 v[36:39], v[156:159], a[188:191], v[36:39]
    s_add_u32 s73, s73, 4096
    buffer_load_dwordx4 a[220:223], v5, s[28:31], s73 offen offset:0 sc1
    ds_write_b128 v14, v[60:63] offset:2048
    v_mfma_f32_16x16x32_bf16 v[40:43], v[160:163], a[188:191], v[40:43]
    ds_write_b128 v14, v[64:67] offset:3072
    v_mfma_f32_16x16x32_bf16 v[44:47], v[164:167], a[188:191], v[44:47]
    ds_write_b128 v14, v[68:71] offset:4096
    v_mfma_f32_16x16x32_bf16 v[48:51], v[168:171], a[188:191], v[48:51]
    s_waitcnt vmcnt(9)
    v_mfma_f32_16x16x32_bf16 v[32:35], v[172:175], a[192:195], v[32:35]
    buffer_load_dwordx4 a[56:59], v5, s[28:31], s63 offen offset:2048 sc1
    v_mfma_f32_16x16x32_bf16 v[36:39], v[176:179], a[192:195], v[36:39]
    v_mfma_f32_16x16x32_bf16 v[40:43], v[180:183], a[192:195], v[40:43]
    v_mfma_f32_16x16x32_bf16 v[44:47], v[184:187], a[192:195], v[44:47]
    v_mfma_f32_16x16x32_bf16 v[48:51], v[188:191], a[192:195], v[48:51]
    s_waitcnt vmcnt(9)
    v_mfma_f32_16x16x32_bf16 v[32:35], v[192:195], a[196:199], v[32:35]
    buffer_load_dwordx4 a[60:63], v5, s[28:31], s63 offen offset:3072 sc1
    v_mfma_f32_16x16x32_bf16 v[36:39], v[196:199], a[196:199], v[36:39]
    v_mfma_f32_16x16x32_bf16 v[40:43], v[200:203], a[196:199], v[40:43]
    v_mfma_f32_16x16x32_bf16 v[44:47], v[204:207], a[196:199], v[44:47]
    v_mfma_f32_16x16x32_bf16 v[48:51], v[208:211], a[196:199], v[48:51]
    s_waitcnt vmcnt(9)
    v_mfma_f32_16x16x32_bf16 v[32:35], v[212:215], a[200:203], v[32:35]
    s_add_u32 s63, s55, 16384
    buffer_load_dwordx4 a[64:67], v5, s[28:31], s63 offen offset:0 sc1
    v_mfma_f32_16x16x32_bf16 v[36:39], v[216:219], a[200:203], v[36:39]
    v_mfma_f32_16x16x32_bf16 v[40:43], v[220:223], a[200:203], v[40:43]
    v_mfma_f32_16x16x32_bf16 v[44:47], v[224:227], a[200:203], v[44:47]
    v_mfma_f32_16x16x32_bf16 v[48:51], v[228:231], a[200:203], v[48:51]
    s_waitcnt vmcnt(9)
    v_mfma_f32_16x16x32_bf16 v[52:55], v[132:135], a[204:207], 0
    buffer_load_dwordx4 a[68:71], v5, s[28:31], s63 offen offset:1024 sc1
    v_mfma_f32_16x16x32_bf16 v[56:59], v[136:139], a[204:207], 0
    v_mfma_f32_16x16x32_bf16 v[60:63], v[140:143], a[204:207], 0
    v_mfma_f32_16x16x32_bf16 v[64:67], v[144:147], a[204:207], 0
    v_mfma_f32_16x16x32_bf16 v[68:71], v[148:151], a[204:207], 0
    s_waitcnt vmcnt(9)
    ds_write_b128 v15, v[32:35] offset:0
    v_mfma_f32_16x16x32_bf16 v[52:55], v[152:155], a[208:211], v[52:55]
    ds_write_b128 v15, v[36:39] offset:1024
    buffer_load_dwordx4 a[72:75], v5, s[28:31], s63 offen offset:2048 sc1
    v_mfma_f32_16x16x32_bf16 v[56:59], v[156:159], a[208:211], v[56:59]
    ds_write_b128 v15, v[40:43] offset:2048
    v_mfma_f32_16x16x32_bf16 v[60:63], v[160:163], a[208:211], v[60:63]
    ds_write_b128 v15, v[44:47] offset:3072
    v_mfma_f32_16x16x32_bf16 v[64:67], v[164:167], a[208:211], v[64:67]
    ds_write_b128 v15, v[48:51] offset:4096
    v_mfma_f32_16x16x32_bf16 v[68:71], v[168:171], a[208:211], v[68:71]
    s_waitcnt vmcnt(9)
    v_mfma_f32_16x16x32_bf16 v[52:55], v[172:175], a[212:215], v[52:55]
    buffer_load_dwordx4 a[76:79], v5, s[28:31], s63 offen offset:3072 sc1
    v_mfma_f32_16x16x32_bf16 v[56:59], v[176:179], a[212:215], v[56:59]
    s_waitcnt lgkmcnt(0)
    v_mfma_f32_16x16x32_bf16 v[60:63], v[180:183], a[212:215], v[60:63]
    s_barrier
    v_mfma_f32_16x16x32_bf16 v[64:67], v[184:187], a[212:215], v[64:67]
    ds_read_b128 v[72:75], v16 offset:0
    ds_read_b128 v[76:79], v16 offset:1024
    v_mfma_f32_16x16x32_bf16 v[68:71], v[188:191], a[212:215], v[68:71]
    s_waitcnt vmcnt(8)
    ds_read_b128 v[80:83], v16 offset:2048
    ds_read_b128 v[84:87], v16 offset:3072
    v_mfma_f32_16x16x32_bf16 v[52:55], v[192:195], a[216:219], v[52:55]
    ds_read_b128 v[88:91], v16 offset:4096
    ds_read_b128 v[92:95], v16 offset:5120
    s_add_u32 s63, s55, 20480
    buffer_load_dwordx4 a[80:83], v5, s[28:31], s63 offen offset:0 sc1
    v_mfma_f32_16x16x32_bf16 v[56:59], v[196:199], a[216:219], v[56:59]
    ds_read_b128 v[96:99], v16 offset:6144
    ds_read_b128 v[100:103], v16 offset:7168
    v_mfma_f32_16x16x32_bf16 v[60:63], v[200:203], a[216:219], v[60:63]
    ds_read_b128 v[104:107], v16 offset:8192
    ds_read_b128 v[108:111], v16 offset:9216
    v_mfma_f32_16x16x32_bf16 v[64:67], v[204:207], a[216:219], v[64:67]
    ds_read_b128 v[112:115], v23 offset:0
    ds_read_b128 v[116:119], v23 offset:1024
    v_mfma_f32_16x16x32_bf16 v[68:71], v[208:211], a[216:219], v[68:71]
    s_waitcnt vmcnt(7)
    ds_read_b128 v[120:123], v23 offset:2048
    ds_read_b128 v[124:127], v23 offset:3072
    v_mfma_f32_16x16x32_bf16 v[52:55], v[212:215], a[220:223], v[52:55]
    ds_read_b128 v[128:131], v23 offset:4096
    buffer_load_dwordx4 a[84:87], v5, s[28:31], s63 offen offset:1024 sc1
    v_mfma_f32_16x16x32_bf16 v[56:59], v[216:219], a[220:223], v[56:59]
    v_mfma_f32_16x16x32_bf16 v[60:63], v[220:223], a[220:223], v[60:63]
    v_mfma_f32_16x16x32_bf16 v[64:67], v[224:227], a[220:223], v[64:67]
    v_mfma_f32_16x16x32_bf16 v[68:71], v[228:231], a[220:223], v[68:71]
    s_waitcnt lgkmcnt(10)
    v_pk_add_f32 v[232:233], v[232:233], v[72:73]
    v_pk_add_f32 v[234:235], v[234:235], v[74:75]
    v_pk_add_f32 v[236:237], v[236:237], v[76:77]
    v_pk_add_f32 v[238:239], v[238:239], v[78:79]
    v_pk_add_f32 v[240:241], v[240:241], v[80:81]
    v_pk_add_f32 v[242:243], v[242:243], v[82:83]
    v_pk_add_f32 v[244:245], v[244:245], v[84:85]
    v_pk_add_f32 v[246:247], v[246:247], v[86:87]
    v_pk_add_f32 v[248:249], v[248:249], v[88:89]
    v_pk_add_f32 v[250:251], v[250:251], v[90:91]
    s_waitcnt lgkmcnt(5)
    v_pk_add_f32 v[232:233], v[232:233], v[92:93]
    v_pk_add_f32 v[234:235], v[234:235], v[94:95]
    v_pk_add_f32 v[236:237], v[236:237], v[96:97]
    v_pk_add_f32 v[238:239], v[238:239], v[98:99]
    v_pk_add_f32 v[240:241], v[240:241], v[100:101]
    v_pk_add_f32 v[242:243], v[242:243], v[102:103]
    v_pk_add_f32 v[244:245], v[244:245], v[104:105]
    v_pk_add_f32 v[246:247], v[246:247], v[106:107]
    v_pk_add_f32 v[248:249], v[248:249], v[108:109]
    v_pk_add_f32 v[250:251], v[250:251], v[110:111]
    s_waitcnt lgkmcnt(0)
    v_pk_add_f32 v[232:233], v[232:233], v[112:113]
    v_pk_add_f32 v[234:235], v[234:235], v[114:115]
    v_pk_add_f32 v[236:237], v[236:237], v[116:117]
    v_pk_add_f32 v[238:239], v[238:239], v[118:119]
    v_pk_add_f32 v[240:241], v[240:241], v[120:121]
    v_pk_add_f32 v[242:243], v[242:243], v[122:123]
    v_pk_add_f32 v[244:245], v[244:245], v[124:125]
    v_pk_add_f32 v[246:247], v[246:247], v[126:127]
    v_pk_add_f32 v[248:249], v[248:249], v[128:129]
    v_pk_add_f32 v[250:251], v[250:251], v[130:131]
    v_pk_add_f32 v[52:53], v[52:53], v[232:233]
    v_pk_add_f32 v[54:55], v[54:55], v[234:235]
    v_pk_add_f32 v[56:57], v[56:57], v[236:237]
    v_pk_add_f32 v[58:59], v[58:59], v[238:239]
    v_pk_add_f32 v[60:61], v[60:61], v[240:241]
    v_pk_add_f32 v[62:63], v[62:63], v[242:243]
    v_pk_add_f32 v[64:65], v[64:65], v[244:245]
    v_pk_add_f32 v[66:67], v[66:67], v[246:247]
    v_pk_add_f32 v[68:69], v[68:69], v[248:249]
    v_pk_add_f32 v[70:71], v[70:71], v[250:251]
    v_cvt_pk_bf16_f32 v212, v52, v53
    v_cvt_pk_bf16_f32 v213, v54, v55
    v_cvt_pk_bf16_f32 v214, v56, v57
    v_cvt_pk_bf16_f32 v215, v58, v59
    buffer_store_dwordx4 v[212:215], v5, s[24:27], s60 offen
    v_cvt_pk_bf16_f32 v216, v60, v61
    v_cvt_pk_bf16_f32 v217, v62, v63
    v_cvt_pk_bf16_f32 v218, v64, v65
    v_cvt_pk_bf16_f32 v219, v66, v67
    buffer_store_dwordx4 v[216:219], v5, s[24:27], s60 offen offset:1024
    v_cvt_pk_bf16_f32 v220, v68, v69
    v_cvt_pk_bf16_f32 v221, v70, v71
    buffer_store_dwordx2 v[220:221], v5, s[24:27], s61 offen
    v_dot2c_f32_bf16 v18, 0x3f803f80, v212
    v_dot2c_f32_bf16 v19, v212, v212
    v_dot2c_f32_bf16 v18, 0x3f803f80, v213
    v_dot2c_f32_bf16 v19, v213, v213
    v_dot2c_f32_bf16 v18, 0x3f803f80, v214
    v_dot2c_f32_bf16 v19, v214, v214
    v_dot2c_f32_bf16 v18, 0x3f803f80, v215
    v_dot2c_f32_bf16 v19, v215, v215
    v_dot2c_f32_bf16 v18, 0x3f803f80, v216
    v_dot2c_f32_bf16 v19, v216, v216
    v_dot2c_f32_bf16 v18, 0x3f803f80, v217
    v_dot2c_f32_bf16 v19, v217, v217
    v_dot2c_f32_bf16 v18, 0x3f803f80, v218
    v_dot2c_f32_bf16 v19, v218, v218
    v_dot2c_f32_bf16 v18, 0x3f803f80, v219
    v_dot2c_f32_bf16 v19, v219, v219
    v_dot2c_f32_bf16 v18, 0x3f803f80, v220
    v_dot2c_f32_bf16 v19, v220, v220
    v_dot2c_f32_bf16 v18, 0x3f803f80, v221
    v_dot2c_f32_bf16 v19, v221, v221
    s_nop 1
    v_mov_b32 v20, v18
    v_mov_b32 v21, v19
    s_nop 0
    v_permlane16_swap_b32 v18, v20
    v_permlane16_swap_b32 v19, v21
    v_pk_add_f32 v[18:19], v[18:19], v[20:21]
    v_mov_b32_e64 v20, v18
    v_mov_b32 v21, v19
    s_nop 0
    v_permlane32_swap_b32 v18, v20
    v_permlane32_swap_b32 v19, v21
    v_pk_add_f32 v[18:19], v[18:19], v[20:21]
    s_mov_b64 exec, 0xffff
    buffer_store_dwordx2 v[18:19], v4, s[28:31], s34 offen
    s_mov_b64 exec, -1
    buffer_load_dwordx4 a[88:91], v5, s[28:31], s63 offen offset:2048 sc1
    buffer_load_dwordx4 a[92:95], v5, s[28:31], s63 offen offset:3072 sc1
    s_add_u32 s63, s55, 24576
    buffer_load_dwordx4 a[96:99], v5, s[28:31], s63 offen offset:0 sc1
    buffer_load_dwordx4 a[100:103], v5, s[28:31], s63 offen offset:1024 sc1
    ds_write_b128 v16, a[224:227] offset:0
    ds_write_b128 v16, a[228:231] offset:1024
    ds_write_b128 v16, a[232:235] offset:2048
    ds_write_b128 v16, a[236:239] offset:3072
    ds_write_b128 v16, a[240:243] offset:4096
    s_lshr_b32 s34, s32, 1
    s_lshl_b32 s34, s34, 5
    s_and_b32 s35, s32, 1
    s_lshl_b32 s35, s35, 1
    s_add_u32 s34, s34, s35
    v_bfe_u32 v17, v1, 1, 3
    v_lshl_add_u32 v17, v17, 2, s34
    v_and_or_b32 v17, v1, 1, v17
    v_mov_b32_e64 v7, v5
    v_add_u32 v8, 57344, v5
    v_add_u32 v9, 114688, v5
    s_mul_i32 s60, s49, 20480
    s_add_u32 s60, s60, 0
    s_add_u32 s62, s60, 20480
    s_lshl_b32 s61, s49, 10
    s_add_u32 s61, s61, 7340032
    v_mov_b32_e64 v2, s57
    v_lshlrev_b32 v3, 24, v1
    s_cmp_eq_u32 s57, 1
    s_waitcnt vmcnt(4)
    s_cbranch_scc0 K2_SS3
    buffer_store_byte v2, v3, s[28:31], s59 offen offset:256
K2_SR3:
    ds_write_b128 v16, a[244:247] offset:5120
    ds_write_b128 v16, a[248:251] offset:6144
    ds_write_b128 v16, a[252:255] offset:7168
    ds_write_b128 v16, v[24:27] offset:8192
    ds_write_b128 v16, v[28:31] offset:9216
    s_mul_i32 s34, s32, 5120
    s_add_u32 s34, s34, 143360
    v_lshl_add_u32 v13, v1, 2, s34
    ds_write_b32 v13, v252
    ds_write_b32 v13, v253 offset:256
    buffer_load_dwordx4 a[104:107], v5, s[28:31], s63 offen offset:2048 sc1
    buffer_load_dwordx4 a[108:111], v5, s[28:31], s63 offen offset:3072 sc1
    s_add_u32 s63, s55, 28672
    buffer_load_dwordx4 a[112:115], v5, s[28:31], s63 offen offset:0 sc1
    buffer_load_dwordx4 a[116:119], v5, s[28:31], s63 offen offset:1024 sc1
    s_waitcnt lgkmcnt(0)
    s_barrier
    ds_read_b128 v[84:87], v7 offset:0
    ds_read_b128 v[88:91], v7 offset:1024
    ds_read_b128 v[92:95], v7 offset:2048
    ds_read_b128 v[96:99], v7 offset:3072
    ds_read_b128 v[100:103], v7 offset:4096
    ds_read_b128 v[104:107], v7 offset:5120
    ds_read_b128 v[108:111], v7 offset:6144
    s_mov_b32 s3, 0x100000
PL_12:
    buffer_load_ubyte v2, v17, s[28:31], s56 offen offset:256 sc1
    s_sub_u32 s3, s3, 1
    s_cbranch_scc1 PL_12x
    s_waitcnt vmcnt(0)
    v_cmp_eq_u32 vcc, 0, v2
    s_cbranch_vccnz PL_12
    v_cmp_ne_u32 vcc, 1, v2
    s_cbranch_vccnz PL_12a
PL_12x:
    buffer_load_dwordx4 v[116:119], v5, s[24:27], s60 offen offset:0 sc1
    buffer_load_dwordx4 v[120:123], v5, s[24:27], s62 offen offset:0 sc1
    v_and_b32 v11, 48, v1
    v_add_u32 v12, 143360, v11
    s_lshl_b32 s37, s45, 6
    s_lshl_b32 s38, s46, 3
    s_add_u32 s38, s38, s47
    buffer_load_dwordx4 v[124:127], v5, s[24:27], s60 offen offset:1024 sc1
    s_lshl_b32 s38, s38, 3
    s_mov_b32 s14, 0xbdd2d3e8
    s_mov_b32 s15, 0xbdd2d3e8
    v_mov_b32 v18, 0xc0135761
    v_mov_b32 v19, 0xc0135761
    s_mul_i32 s34, s49, 55296
    s_add_u32 s34, s34, 0
    buffer_load_dwordx4 v[128:131], v5, s[24:27], s62 offen offset:1024 sc1
    s_lshl_b32 s64, s50, 10
    s_add_u32 s64, s64, s34
    s_lshl_b32 s65, s51, 7
    s_add_u32 s65, s65, s52
    s_lshl_b32 s65, s65, 3
    s_add_u32 s65, s65, s34
    s_add_u32 s67, s64, 55296
    buffer_load_dwordx4 v[132:135], v5, s[24:27], s60 offen offset:2048 sc1
    s_add_u32 s68, s65, 55296
    s_cmp_eq_u32 s48, 15
    s_cselect_b32 s66, 25165824, s64
    s_cselect_b32 s69, 25165824, s67
    s_mov_b32 s20, s8
    s_and_b32 s21, s9, 0xffff
    s_mov_b32 s22, 1280
    s_mov_b32 s23, 0x20000
    s_mul_i32 s35, s32, 14336
    buffer_load_dwordx4 v[136:139], v5, s[24:27], s62 offen offset:2048 sc1
    s_add_u32 s35, s35, 0
    s_add_u32 s34, s32, 1
    s_and_b32 s34, s34, 3
    s_add_u32 s34, s34, s44
    s_mul_i32 s34, s34, 55296
    s_add_u32 s70, s34, s35
    s_add_u32 s34, s32, 2
    buffer_load_dwordx4 v[140:143], v5, s[24:27], s60 offen offset:3072 sc1
    s_and_b32 s34, s34, 3
    s_add_u32 s34, s34, s44
    s_mul_i32 s34, s34, 55296
    s_add_u32 s71, s34, s35
    s_add_u32 s34, s32, 3
    s_and_b32 s34, s34, 3
    s_add_u32 s34, s34, s44
    buffer_load_dwordx4 v[144:147], v5, s[24:27], s62 offen offset:3072 sc1
    s_mul_i32 s34, s34, 55296
    s_add_u32 s72, s34, s35
    s_add_u32 s34, s32, 4
    s_and_b32 s34, s34, 3
    s_add_u32 s34, s34, s44
    s_mul_i32 s34, s34, 55296
    s_add_u32 s73, s34, s35
    s_waitcnt vmcnt(6)
    s_waitcnt lgkmcnt(5)
    v_mfma_f32_16x16x32_bf16 v[28:31], v[84:87], v[116:119], 0
    ds_read_b128 v[112:115], v7 offset:7168
    s_add_u32 s60, s60, 4096
    v_mfma_f32_16x16x32_bf16 v[56:59], v[84:87], v[120:123], 0
    buffer_load_dwordx4 v[148:151], v5, s[24:27], s60 offen offset:0 sc1
    v_mfma_f32_16x16x32_bf16 v[32:35], v[88:91], v[116:119], 0
    ds_read_b128 v[84:87], v7 offset:8192
    s_add_u32 s62, s62, 4096
    v_mfma_f32_16x16x32_bf16 v[60:63], v[88:91], v[120:123], 0
    buffer_load_dwordx4 v[152:155], v5, s[24:27], s62 offen offset:0 sc1
    s_waitcnt lgkmcnt(5)
    v_mfma_f32_16x16x32_bf16 v[36:39], v[92:95], v[116:119], 0
    ds_read_b128 v[88:91], v7 offset:9216
    v_mfma_f32_16x16x32_bf16 v[64:67], v[92:95], v[120:123], 0
    v_mfma_f32_16x16x32_bf16 v[40:43], v[96:99], v[116:119], 0
    ds_read_b128 v[92:95], v7 offset:10240
    v_mfma_f32_16x16x32_bf16 v[68:71], v[96:99], v[120:123], 0
    s_waitcnt lgkmcnt(5)
    v_mfma_f32_16x16x32_bf16 v[44:47], v[100:103], v[116:119], 0
    ds_read_b128 v[96:99], v7 offset:11264
    v_mfma_f32_16x16x32_bf16 v[72:75], v[100:103], v[120:123], 0
    v_mfma_f32_16x16x32_bf16 v[48:51], v[104:107], v[116:119], 0
    ds_read_b128 v[100:103], v7 offset:12288
    v_mfma_f32_16x16x32_bf16 v[76:79], v[104:107], v[120:123], 0
    s_waitcnt lgkmcnt(5)
    v_mfma_f32_16x16x32_bf16 v[52:55], v[108:111], v[116:119], 0
    ds_read_b128 v[104:107], v7 offset:13312
    v_mfma_f32_16x16x32_bf16 v[80:83], v[108:111], v[120:123], 0
    s_waitcnt vmcnt(6)
    v_mfma_f32_16x16x32_bf16 v[28:31], v[112:115], v[124:127], v[28:31]
    ds_read_b128 v[108:111], v7 offset:14336
    buffer_load_dwordx4 v[116:119], v5, s[24:27], s60 offen offset:1024 sc1
    v_mfma_f32_16x16x32_bf16 v[56:59], v[112:115], v[128:131], v[56:59]
    buffer_load_dwordx4 v[120:123], v5, s[24:27], s62 offen offset:1024 sc1
    s_waitcnt lgkmcnt(5)
    v_mfma_f32_16x16x32_bf16 v[32:35], v[84:87], v[124:127], v[32:35]
    ds_read_b128 v[112:115], v7 offset:15360
    v_mfma_f32_16x16x32_bf16 v[60:63], v[84:87], v[128:131], v[60:63]
    v_mfma_f32_16x16x32_bf16 v[36:39], v[88:91], v[124:127], v[36:39]
    ds_read_b128 v[84:87], v7 offset:16384
    v_mfma_f32_16x16x32_bf16 v[64:67], v[88:91], v[128:131], v[64:67]
    s_waitcnt lgkmcnt(5)
    v_mfma_f32_16x16x32_bf16 v[40:43], v[92:95], v[124:127], v[40:43]
    ds_read_b128 v[88:91], v7 offset:17408
    ds_read_b128 v[156:159], v12 offset:0
    v_mfma_f32_16x16x32_bf16 v[68:71], v[92:95], v[128:131], v[68:71]
    ds_read_b128 v[184:187], v12 offset:256
    v_mfma_f32_16x16x32_bf16 v[44:47], v[96:99], v[124:127], v[44:47]
    ds_read_b128 v[92:95], v7 offset:18432
    ds_read_b128 v[160:163], v12 offset:64
    v_mfma_f32_16x16x32_bf16 v[72:75], v[96:99], v[128:131], v[72:75]
    ds_read_b128 v[188:191], v12 offset:320
    s_waitcnt lgkmcnt(9)
    v_mfma_f32_16x16x32_bf16 v[48:51], v[100:103], v[124:127], v[48:51]
    ds_read_b128 v[96:99], v7 offset:19456
    ds_read_b128 v[164:167], v12 offset:128
    v_mfma_f32_16x16x32_bf16 v[76:79], v[100:103], v[128:131], v[76:79]
    ds_read_b128 v[192:195], v12 offset:384
    v_mfma_f32_16x16x32_bf16 v[52:55], v[104:107], v[124:127], v[52:55]
    ds_read_b128 v[100:103], v7 offset:20480
    ds_read_b128 v[168:171], v12 offset:192
    v_mfma_f32_16x16x32_bf16 v[80:83], v[104:107], v[128:131], v[80:83]
    s_waitcnt vmcnt(6)
    s_waitcnt lgkmcnt(12)
    v_mfma_f32_16x16x32_bf16 v[28:31], v[108:111], v[132:135], v[28:31]
    ds_read_b128 v[104:107], v7 offset:21504
    buffer_load_dwordx4 v[124:127], v5, s[24:27], s60 offen offset:2048 sc1
    v_mfma_f32_16x16x32_bf16 v[56:59], v[108:111], v[136:139], v[56:59]
    buffer_load_dwordx4 v[128:131], v5, s[24:27], s62 offen offset:2048 sc1
    v_mfma_f32_16x16x32_bf16 v[32:35], v[112:115], v[132:135], v[32:35]
    ds_read_b128 v[108:111], v7 offset:22528
    ds_read_b128 v[196:199], v12 offset:448
    v_mfma_f32_16x16x32_bf16 v[60:63], v[112:115], v[136:139], v[60:63]
    s_waitcnt lgkmcnt(13)
    ds_read_b128 v[172:175], v12 offset:5120
    v_mfma_f32_16x16x32_bf16 v[36:39], v[84:87], v[132:135], v[36:39]
    ds_read_b128 v[112:115], v7 offset:23552
    s_waitcnt lgkmcnt(13)
    ds_read_b128 v[200:203], v12 offset:5376
    v_mfma_f32_16x16x32_bf16 v[64:67], v[84:87], v[136:139], v[64:67]
    ds_read_b128 v[176:179], v12 offset:5184
    v_mfma_f32_16x16x32_bf16 v[40:43], v[88:91], v[132:135], v[40:43]
    s_waitcnt lgkmcnt(13)
    ds_read_b128 v[84:87], v7 offset:24576
    ds_read_b128 v[204:207], v12 offset:5440
    v_mfma_f32_16x16x32_bf16 v[68:71], v[88:91], v[136:139], v[68:71]
    s_waitcnt lgkmcnt(13)
    ds_read_b128 v[180:183], v12 offset:5248
    v_mfma_f32_16x16x32_bf16 v[44:47], v[92:95], v[132:135], v[44:47]
    ds_read_b128 v[88:91], v7 offset:25600
    s_waitcnt lgkmcnt(13)
    ds_read_b128 v[208:211], v12 offset:5504
    v_mfma_f32_16x16x32_bf16 v[72:75], v[92:95], v[136:139], v[72:75]
    v_mfma_f32_16x16x32_bf16 v[48:51], v[96:99], v[132:135], v[48:51]
    ds_read_b128 v[92:95], v7 offset:26624
    v_mfma_f32_16x16x32_bf16 v[76:79], v[96:99], v[136:139], v[76:79]
    s_waitcnt lgkmcnt(12)
    v_mfma_f32_16x16x32_bf16 v[52:55], v[100:103], v[132:135], v[52:55]
    ds_read_b128 v[96:99], v7 offset:27648
    v_mfma_f32_16x16x32_bf16 v[80:83], v[100:103], v[136:139], v[80:83]
    s_waitcnt vmcnt(6)
    v_mfma_f32_16x16x32_bf16 v[28:31], v[104:107], v[140:143], v[28:31]
    ds_read_b128 v[100:103], v7 offset:28672
    buffer_load_dwordx4 v[132:135], v5, s[24:27], s60 offen offset:3072 sc1
    v_mfma_f32_16x16x32_bf16 v[56:59], v[104:107], v[144:147], v[56:59]
    buffer_load_dwordx4 v[136:139], v5, s[24:27], s62 offen offset:3072 sc1
    s_waitcnt lgkmcnt(10)
    v_mfma_f32_16x16x32_bf16 v[32:35], v[108:111], v[140:143], v[32:35]
    ds_read_b128 v[104:107], v7 offset:29696
    v_mfma_f32_16x16x32_bf16 v[60:63], v[108:111], v[144:147], v[60:63]
    v_mfma_f32_16x16x32_bf16 v[36:39], v[112:115], v[140:143], v[36:39]
    ds_read_b128 v[108:111], v7 offset:30720
    v_mfma_f32_16x16x32_bf16 v[64:67], v[112:115], v[144:147], v[64:67]
    s_waitcnt lgkmcnt(6)
    v_mfma_f32_16x16x32_bf16 v[40:43], v[84:87], v[140:143], v[40:43]
    ds_read_b128 v[112:115], v7 offset:31744
    buffer_load_dwordx2 v[20:21], v4, s[28:31], s61 offen offset:0 sc1
    v_mfma_f32_16x16x32_bf16 v[68:71], v[84:87], v[144:147], v[68:71]
    buffer_load_dwordx2 v[22:23], v4, s[28:31], s61 offen offset:512 sc1
    v_mfma_f32_16x16x32_bf16 v[44:47], v[88:91], v[140:143], v[44:47]
    ds_read_b128 v[84:87], v7 offset:32768
    buffer_load_dwordx2 v[24:25], v4, s[28:31], s61 offen offset:1024 sc1
    v_mfma_f32_16x16x32_bf16 v[72:75], v[88:91], v[144:147], v[72:75]
    buffer_load_dwordx2 v[26:27], v4, s[28:31], s61 offen offset:1536 sc1
    s_waitcnt lgkmcnt(5)
    v_mfma_f32_16x16x32_bf16 v[48:51], v[92:95], v[140:143], v[48:51]
    ds_read_b128 v[88:91], v7 offset:33792
    buffer_load_dwordx4 a[120:123], v5, s[28:31], s63 offen offset:2048 sc1
    v_mfma_f32_16x16x32_bf16 v[76:79], v[92:95], v[144:147], v[76:79]
    v_mfma_f32_16x16x32_bf16 v[52:55], v[96:99], v[140:143], v[52:55]
    ds_read_b128 v[92:95], v7 offset:34816
    v_mfma_f32_16x16x32_bf16 v[80:83], v[96:99], v[144:147], v[80:83]
    s_waitcnt vmcnt(11)
    s_waitcnt lgkmcnt(5)
    v_mfma_f32_16x16x32_bf16 v[28:31], v[100:103], v[148:151], v[28:31]
    ds_read_b128 v[96:99], v7 offset:35840
    s_add_u32 s60, s60, 4096
    v_mfma_f32_16x16x32_bf16 v[56:59], v[100:103], v[152:155], v[56:59]
    buffer_load_dwordx4 v[140:143], v5, s[24:27], s60 offen offset:0 sc1
    v_mfma_f32_16x16x32_bf16 v[32:35], v[104:107], v[148:151], v[32:35]
    ds_read_b128 v[100:103], v7 offset:36864
    s_add_u32 s62, s62, 4096
    v_mfma_f32_16x16x32_bf16 v[60:63], v[104:107], v[152:155], v[60:63]
    buffer_load_dwordx4 v[144:147], v5, s[24:27], s62 offen offset:0 sc1
    s_waitcnt lgkmcnt(5)
    v_mfma_f32_16x16x32_bf16 v[36:39], v[108:111], v[148:151], v[36:39]
    ds_read_b128 v[104:107], v7 offset:37888
    v_mfma_f32_16x16x32_bf16 v[64:67], v[108:111], v[152:155], v[64:67]
    v_mfma_f32_16x16x32_bf16 v[40:43], v[112:115], v[148:151], v[40:43]
    ds_read_b128 v[108:111], v7 offset:38912
    buffer_load_dwordx4 a[124:127], v5, s[28:31], s63 offen offset:3072 sc1
    v_mfma_f32_16x16x32_bf16 v[68:71], v[112:115], v[152:155], v[68:71]
    s_waitcnt lgkmcnt(5)
    v_mfma_f32_16x16x32_bf16 v[44:47], v[84:87], v[148:151], v[44:47]
    ds_read_b128 v[112:115], v7 offset:39936
    v_mfma_f32_16x16x32_bf16 v[72:75], v[84:87], v[152:155], v[72:75]
    v_mfma_f32_16x16x32_bf16 v[48:51], v[88:91], v[148:151], v[48:51]
    ds_read_b128 v[84:87], v7 offset:40960
    v_mfma_f32_16x16x32_bf16 v[76:79], v[88:91], v[152:155], v[76:79]
    s_waitcnt lgkmcnt(5)
    v_mfma_f32_16x16x32_bf16 v[52:55], v[92:95], v[148:151], v[52:55]
    ds_read_b128 v[88:91], v7 offset:41984
    v_mfma_f32_16x16x32_bf16 v[80:83], v[92:95], v[152:155], v[80:83]
    s_waitcnt vmcnt(12)
    v_mfma_f32_16x16x32_bf16 v[28:31], v[96:99], v[116:119], v[28:31]
    ds_read_b128 v[92:95], v7 offset:43008
    buffer_load_dwordx4 v[148:151], v5, s[24:27], s60 offen offset:1024 sc1
    v_mfma_f32_16x16x32_bf16 v[56:59], v[96:99], v[120:123], v[56:59]
    buffer_load_dwordx4 v[152:155], v5, s[24:27], s62 offen offset:1024 sc1
    s_waitcnt lgkmcnt(5)
    v_mfma_f32_16x16x32_bf16 v[32:35], v[100:103], v[116:119], v[32:35]
    ds_read_b128 v[96:99], v7 offset:44032
    v_mfma_f32_16x16x32_bf16 v[60:63], v[100:103], v[120:123], v[60:63]
    v_mfma_f32_16x16x32_bf16 v[36:39], v[104:107], v[116:119], v[36:39]
    ds_read_b128 v[100:103], v7 offset:45056
    v_mfma_f32_16x16x32_bf16 v[64:67], v[104:107], v[120:123], v[64:67]
    s_waitcnt lgkmcnt(5)
    v_mfma_f32_16x16x32_bf16 v[40:43], v[108:111], v[116:119], v[40:43]
    ds_read_b128 v[104:107], v7 offset:46080
    v_mfma_f32_16x16x32_bf16 v[68:71], v[108:111], v[120:123], v[68:71]
    v_mfma_f32_16x16x32_bf16 v[44:47], v[112:115], v[116:119], v[44:47]
    ds_read_b128 v[108:111], v7 offset:47104
    s_add_u32 s63, s55, 32768
    v_mfma_f32_16x16x32_bf16 v[72:75], v[112:115], v[120:123], v[72:75]
    buffer_load_dwordx4 a[128:131], v5, s[28:31], s63 offen offset:0 sc1
    s_waitcnt lgkmcnt(5)
    v_mfma_f32_16x16x32_bf16 v[48:51], v[84:87], v[116:119], v[48:51]
    ds_read_b128 v[112:115], v7 offset:48128
    s_waitcnt vmcnt(7)
    v_mfma_f32_16x16x32_bf16 v[76:79], v[84:87], v[120:123], v[76:79]
    v_add_f32 v20, v20, v22
    v_mfma_f32_16x16x32_bf16 v[52:55], v[88:91], v[116:119], v[52:55]
    ds_read_b128 v[84:87], v7 offset:49152
    v_add_f32_e64 v21, v21, v23
    v_mfma_f32_16x16x32_bf16 v[80:83], v[88:91], v[120:123], v[80:83]
    s_waitcnt lgkmcnt(5)
    v_mfma_f32_16x16x32_bf16 v[28:31], v[92:95], v[124:127], v[28:31]
    ds_read_b128 v[88:91], v7 offset:50176
    buffer_load_dwordx4 v[116:119], v5, s[24:27], s60 offen offset:2048 sc1
    v_mfma_f32_16x16x32_bf16 v[56:59], v[92:95], v[128:131], v[56:59]
    buffer_load_dwordx4 v[120:123], v5, s[24:27], s62 offen offset:2048 sc1
    v_mfma_f32_16x16x32_bf16 v[32:35], v[96:99], v[124:127], v[32:35]
    ds_read_b128 v[92:95], v7 offset:51200
    v_mov_b32 v22, v20
    v_mfma_f32_16x16x32_bf16 v[60:63], v[96:99], v[128:131], v[60:63]
    v_mov_b32 v23, v21
    s_waitcnt lgkmcnt(5)
    v_mfma_f32_16x16x32_bf16 v[36:39], v[100:103], v[124:127], v[36:39]
    ds_read_b128 v[96:99], v7 offset:52224
    v_permlane16_swap_b32 v20, v22
    v_mfma_f32_16x16x32_bf16 v[64:67], v[100:103], v[128:131], v[64:67]
    v_mfma_f32_16x16x32_bf16 v[40:43], v[104:107], v[124:127], v[40:43]
    ds_read_b128 v[100:103], v7 offset:53248
    v_permlane16_swap_b32 v21, v23
    v_mfma_f32_16x16x32_bf16 v[68:71], v[104:107], v[128:131], v[68:71]
    s_waitcnt lgkmcnt(5)
    v_mfma_f32_16x16x32_bf16 v[44:47], v[108:111], v[124:127], v[44:47]
    ds_read_b128 v[104:107], v7 offset:54272
    v_add_f32 v20, v20, v22
    v_mfma_f32_16x16x32_bf16 v[72:75], v[108:111], v[128:131], v[72:75]
    v_add_f32_e64 v21, v21, v23
    v_mfma_f32_16x16x32_bf16 v[48:51], v[112:115], v[124:127], v[48:51]
    ds_read_b128 v[108:111], v7 offset:55296
    buffer_load_dwordx4 a[132:135], v5, s[28:31], s63 offen offset:1024 sc1
    v_mfma_f32_16x16x32_bf16 v[76:79], v[112:115], v[128:131], v[76:79]
    v_mov_b32 v22, v20
    s_waitcnt lgkmcnt(5)
    v_mfma_f32_16x16x32_bf16 v[52:55], v[84:87], v[124:127], v[52:55]
    ds_read_b128 v[112:115], v7 offset:56320
    v_mov_b32_e64 v23, v21
    v_mfma_f32_16x16x32_bf16 v[80:83], v[84:87], v[128:131], v[80:83]
    v_mfma_f32_16x16x32_bf16 v[28:31], v[88:91], v[132:135], v[28:31]
    ds_read_b128 v[84:87], v8 offset:0
    buffer_load_dwordx4 v[124:127], v5, s[24:27], s60 offen offset:3072 sc1
    v_mfma_f32_16x16x32_bf16 v[56:59], v[88:91], v[136:139], v[56:59]
    buffer_load_dwordx4 v[128:131], v5, s[24:27], s62 offen offset:3072 sc1
    s_waitcnt lgkmcnt(5)
    v_mfma_f32_16x16x32_bf16 v[32:35], v[92:95], v[132:135], v[32:35]
    ds_read_b128 v[88:91], v8 offset:1024
    v_permlane32_swap_b32 v20, v22
    v_mfma_f32_16x16x32_bf16 v[60:63], v[92:95], v[136:139], v[60:63]
    v_permlane32_swap_b32 v21, v23
    v_mfma_f32_16x16x32_bf16 v[36:39], v[96:99], v[132:135], v[36:39]
    ds_read_b128 v[92:95], v8 offset:2048
    v_add_f32 v20, v20, v22
    v_mfma_f32_16x16x32_bf16 v[64:67], v[96:99], v[136:139], v[64:67]
    s_waitcnt lgkmcnt(5)
    v_mfma_f32_16x16x32_bf16 v[40:43], v[100:103], v[132:135], v[40:43]
    ds_read_b128 v[96:99], v8 offset:3072
    v_add_f32 v21, v21, v23
    v_mfma_f32_16x16x32_bf16 v[68:71], v[100:103], v[136:139], v[68:71]
    v_mul_f32 v20, 0x3acccccd, v20
    v_mfma_f32_16x16x32_bf16 v[44:47], v[104:107], v[132:135], v[44:47]
    ds_read_b128 v[100:103], v8 offset:4096
    v_mul_f32_e64 v2, v20, v20
    v_mfma_f32_16x16x32_bf16 v[72:75], v[104:107], v[136:139], v[72:75]
    s_waitcnt lgkmcnt(5)
    v_mfma_f32_16x16x32_bf16 v[48:51], v[108:111], v[132:135], v[48:51]
    ds_read_b128 v[104:107], v8 offset:5120
    v_mov_b32 v3, 0x3acccccd
    v_mfma_f32_16x16x32_bf16 v[76:79], v[108:111], v[136:139], v[76:79]
    buffer_load_dwordx4 a[136:139], v5, s[28:31], s63 offen offset:2048 sc1
    v_mfma_f32_16x16x32_bf16 v[52:55], v[112:115], v[132:135], v[52:55]
    ds_read_b128 v[108:111], v8 offset:6144
    v_fma_f32 v2, v21, v3, -v2
    v_mfma_f32_16x16x32_bf16 v[80:83], v[112:115], v[136:139], v[80:83]
    s_waitcnt vmcnt(10)
    s_waitcnt lgkmcnt(5)
    v_mfma_f32_16x16x32_bf16 v[28:31], v[84:87], v[140:143], v[28:31]
    ds_read_b128 v[112:115], v8 offset:7168
    s_add_u32 s60, s60, 4096
    v_mfma_f32_16x16x32_bf16 v[56:59], v[84:87], v[144:147], v[56:59]
    buffer_load_dwordx4 v[132:135], v5, s[24:27], s60 offen offset:0 sc1
    v_mfma_f32_16x16x32_bf16 v[32:35], v[88:91], v[140:143], v[32:35]
    ds_read_b128 v[84:87], v8 offset:8192
    s_add_u32 s62, s62, 4096
    v_mfma_f32_16x16x32_bf16 v[60:63], v[88:91], v[144:147], v[60:63]
    buffer_load_dwordx4 v[136:139], v5, s[24:27], s62 offen offset:0 sc1
    s_waitcnt lgkmcnt(5)
    v_mfma_f32_16x16x32_bf16 v[36:39], v[92:95], v[140:143], v[36:39]
    ds_read_b128 v[88:91], v8 offset:9216
    v_max_f32_e64 v2, 0, v2
    v_mfma_f32_16x16x32_bf16 v[64:67], v[92:95], v[144:147], v[64:67]
    v_add_f32 v21, 0x3727c5ac, v2
    v_mfma_f32_16x16x32_bf16 v[40:43], v[96:99], v[140:143], v[40:43]
    ds_read_b128 v[92:95], v8 offset:10240
    v_rcp_f32_e64 v22, v21
    v_mfma_f32_16x16x32_bf16 v[68:71], v[96:99], v[144:147], v[68:71]
    v_rsq_f32 v23, v21
    s_waitcnt lgkmcnt(5)
    v_mfma_f32_16x16x32_bf16 v[44:47], v[100:103], v[140:143], v[44:47]
    ds_read_b128 v[96:99], v8 offset:11264
    v_mov_b32 v3, 0x3727c5ac
    v_mfma_f32_16x16x32_bf16 v[72:75], v[100:103], v[144:147], v[72:75]
    v_fma_f32 v2, v2, v22, v3
    v_mfma_f32_16x16x32_bf16 v[48:51], v[104:107], v[140:143], v[48:51]
    ds_read_b128 v[100:103], v8 offset:12288
    v_rsq_f32_e64 v2, v2
    v_mfma_f32_16x16x32_bf16 v[76:79], v[104:107], v[144:147], v[76:79]
    buffer_load_dwordx4 a[140:143], v5, s[28:31], s63 offen offset:3072 sc1
    s_waitcnt lgkmcnt(5)
    v_mfma_f32_16x16x32_bf16 v[52:55], v[108:111], v[140:143], v[52:55]
    ds_read_b128 v[104:107], v8 offset:13312
    v_mul_f32 v22, v23, v2
    v_mfma_f32_16x16x32_bf16 v[80:83], v[108:111], v[144:147], v[80:83]
    s_waitcnt vmcnt(10)
    v_mfma_f32_16x16x32_bf16 v[28:31], v[112:115], v[148:151], v[28:31]
    ds_read_b128 v[108:111], v8 offset:14336
    buffer_load_dwordx4 v[140:143], v5, s[24:27], s60 offen offset:1024 sc1
    v_mfma_f32_16x16x32_bf16 v[56:59], v[112:115], v[152:155], v[56:59]
    buffer_load_dwordx4 v[144:147], v5, s[24:27], s62 offen offset:1024 sc1
    s_waitcnt lgkmcnt(5)
    v_mfma_f32_16x16x32_bf16 v[32:35], v[84:87], v[148:151], v[32:35]
    ds_read_b128 v[112:115], v8 offset:15360
    v_mul_f32_e64 v20, v20, v22
    v_mfma_f32_16x16x32_bf16 v[60:63], v[84:87], v[152:155], v[60:63]
    v_add_f32_e64 v24, v24, v26
    v_mfma_f32_16x16x32_bf16 v[36:39], v[88:91], v[148:151], v[36:39]
    ds_read_b128 v[84:87], v8 offset:16384
    v_add_f32_e64 v25, v25, v27
    v_mfma_f32_16x16x32_bf16 v[64:67], v[88:91], v[152:155], v[64:67]
    v_mov_b32 v26, v24
    s_waitcnt lgkmcnt(5)
    v_mfma_f32_16x16x32_bf16 v[40:43], v[92:95], v[148:151], v[40:43]
    ds_read_b128 v[88:91], v8 offset:17408
    v_mov_b32_e64 v27, v25
    v_mfma_f32_16x16x32_bf16 v[68:71], v[92:95], v[152:155], v[68:71]
    v_mfma_f32_16x16x32_bf16 v[44:47], v[96:99], v[148:151], v[44:47]
    ds_read_b128 v[92:95], v8 offset:18432
    v_permlane16_swap_b32 v24, v26
    v_mfma_f32_16x16x32_bf16 v[72:75], v[96:99], v[152:155], v[72:75]
    s_waitcnt lgkmcnt(5)
    v_mfma_f32_16x16x32_bf16 v[48:51], v[100:103], v[148:151], v[48:51]
    ds_read_b128 v[96:99], v8 offset:19456
    v_permlane16_swap_b32 v25, v27
    v_mfma_f32_16x16x32_bf16 v[76:79], v[100:103], v[152:155], v[76:79]
    v_mfma_f32_16x16x32_bf16 v[52:55], v[104:107], v[148:151], v[52:55]
    ds_read_b128 v[100:103], v8 offset:20480
    v_add_f32 v24, v24, v26
    v_mfma_f32_16x16x32_bf16 v[80:83], v[104:107], v[152:155], v[80:83]
    s_waitcnt vmcnt(9)
    s_waitcnt lgkmcnt(5)
    v_mfma_f32_16x16x32_bf16 v[28:31], v[108:111], v[116:119], v[28:31]
    ds_read_b128 v[104:107], v8 offset:21504
    buffer_load_dwordx4 v[148:151], v5, s[24:27], s60 offen offset:2048 sc1
    v_mfma_f32_16x16x32_bf16 v[56:59], v[108:111], v[120:123], v[56:59]
    buffer_load_dwordx4 v[152:155], v5, s[24:27], s62 offen offset:2048 sc1
    v_mfma_f32_16x16x32_bf16 v[32:35], v[112:115], v[116:119], v[32:35]
    ds_read_b128 v[108:111], v8 offset:22528
    s_add_u32 s63, s55, 36864
    v_mfma_f32_16x16x32_bf16 v[60:63], v[112:115], v[120:123], v[60:63]
    buffer_load_dwordx4 a[144:147], v5, s[28:31], s63 offen offset:0 sc1
    s_waitcnt lgkmcnt(5)
    v_mfma_f32_16x16x32_bf16 v[36:39], v[84:87], v[116:119], v[36:39]
    ds_read_b128 v[112:115], v8 offset:23552
    v_add_f32 v25, v25, v27
    v_mfma_f32_16x16x32_bf16 v[64:67], v[84:87], v[120:123], v[64:67]
    v_mov_b32_e64 v26, v24
    v_mfma_f32_16x16x32_bf16 v[40:43], v[88:91], v[116:119], v[40:43]
    ds_read_b128 v[84:87], v8 offset:24576
    v_mov_b32_e64 v27, v25
    v_mfma_f32_16x16x32_bf16 v[68:71], v[88:91], v[120:123], v[68:71]
    v_permlane32_swap_b32 v24, v26
    s_waitcnt lgkmcnt(5)
    v_mfma_f32_16x16x32_bf16 v[44:47], v[92:95], v[116:119], v[44:47]
    ds_read_b128 v[88:91], v8 offset:25600
    v_permlane32_swap_b32 v25, v27
    v_mfma_f32_16x16x32_bf16 v[72:75], v[92:95], v[120:123], v[72:75]
    v_add_f32 v24, v24, v26
    v_mfma_f32_16x16x32_bf16 v[48:51], v[96:99], v[116:119], v[48:51]
    ds_read_b128 v[92:95], v8 offset:26624
    v_add_f32_e64 v25, v25, v27
    v_mfma_f32_16x16x32_bf16 v[76:79], v[96:99], v[120:123], v[76:79]
    s_waitcnt lgkmcnt(5)
    v_mfma_f32_16x16x32_bf16 v[52:55], v[100:103], v[116:119], v[52:55]
    ds_read_b128 v[96:99], v8 offset:27648
    v_mul_f32 v24, 0x3acccccd, v24
    v_mfma_f32_16x16x32_bf16 v[80:83], v[100:103], v[120:123], v[80:83]
    s_waitcnt vmcnt(9)
    v_mfma_f32_16x16x32_bf16 v[28:31], v[104:107], v[124:127], v[28:31]
    ds_read_b128 v[100:103], v8 offset:28672
    buffer_load_dwordx4 v[116:119], v5, s[24:27], s60 offen offset:3072 sc1
    v_mfma_f32_16x16x32_bf16 v[56:59], v[104:107], v[128:131], v[56:59]
    buffer_load_dwordx4 v[120:123], v5, s[24:27], s62 offen offset:3072 sc1
    s_waitcnt lgkmcnt(5)
    v_mfma_f32_16x16x32_bf16 v[32:35], v[108:111], v[124:127], v[32:35]
    ds_read_b128 v[104:107], v8 offset:29696
    v_mul_f32 v2, v24, v24
    v_mfma_f32_16x16x32_bf16 v[60:63], v[108:111], v[128:131], v[60:63]
    buffer_load_dwordx4 a[148:151], v5, s[28:31], s63 offen offset:1024 sc1
    v_mfma_f32_16x16x32_bf16 v[36:39], v[112:115], v[124:127], v[36:39]
    ds_read_b128 v[108:111], v8 offset:30720
    v_mov_b32 v3, 0x3acccccd
    v_mfma_f32_16x16x32_bf16 v[64:67], v[112:115], v[128:131], v[64:67]
    v_fma_f32 v2, v25, v3, -v2
    s_waitcnt lgkmcnt(5)
    v_mfma_f32_16x16x32_bf16 v[40:43], v[84:87], v[124:127], v[40:43]
    ds_read_b128 v[112:115], v8 offset:31744
    v_max_f32 v2, 0, v2
    v_mfma_f32_16x16x32_bf16 v[68:71], v[84:87], v[128:131], v[68:71]
    v_add_f32 v25, 0x3727c5ac, v2
    v_mfma_f32_16x16x32_bf16 v[44:47], v[88:91], v[124:127], v[44:47]
    ds_read_b128 v[84:87], v8 offset:32768
    v_rcp_f32_e64 v26, v25
    v_mfma_f32_16x16x32_bf16 v[72:75], v[88:91], v[128:131], v[72:75]
    s_waitcnt lgkmcnt(5)
    v_mfma_f32_16x16x32_bf16 v[48:51], v[92:95], v[124:127], v[48:51]
    ds_read_b128 v[88:91], v8 offset:33792
    v_rsq_f32 v27, v25
    v_mfma_f32_16x16x32_bf16 v[76:79], v[92:95], v[128:131], v[76:79]
    v_mov_b32 v3, 0x3727c5ac
    v_mfma_f32_16x16x32_bf16 v[52:55], v[96:99], v[124:127], v[52:55]
    ds_read_b128 v[92:95], v8 offset:34816
    v_fma_f32 v2, v2, v26, v3
    v_mfma_f32_16x16x32_bf16 v[80:83], v[96:99], v[128:131], v[80:83]
    s_waitcnt vmcnt(9)
    s_waitcnt lgkmcnt(5)
    v_mfma_f32_16x16x32_bf16 v[28:31], v[100:103], v[132:135], v[28:31]
    ds_read_b128 v[96:99], v8 offset:35840
    s_add_u32 s60, s60, 4096
    v_mfma_f32_16x16x32_bf16 v[56:59], v[100:103], v[136:139], v[56:59]
    buffer_load_dwordx4 v[124:127], v5, s[24:27], s60 offen offset:0 sc1
    v_mfma_f32_16x16x32_bf16 v[32:35], v[104:107], v[132:135], v[32:35]
    ds_read_b128 v[100:103], v8 offset:36864
    s_add_u32 s62, s62, 4096
    v_mfma_f32_16x16x32_bf16 v[60:63], v[104:107], v[136:139], v[60:63]
    buffer_load_dwordx4 v[128:131], v5, s[24:27], s62 offen offset:0 sc1
    s_waitcnt lgkmcnt(5)
    v_mfma_f32_16x16x32_bf16 v[36:39], v[108:111], v[132:135], v[36:39]
    ds_read_b128 v[104:107], v8 offset:37888
    v_rsq_f32 v2, v2
    v_mfma_f32_16x16x32_bf16 v[64:67], v[108:111], v[136:139], v[64:67]
    buffer_load_dwordx4 a[152:155], v5, s[28:31], s63 offen offset:2048 sc1
    v_mfma_f32_16x16x32_bf16 v[40:43], v[112:115], v[132:135], v[40:43]
    ds_read_b128 v[108:111], v8 offset:38912
    v_mul_f32_e64 v26, v27, v2
    v_mfma_f32_16x16x32_bf16 v[68:71], v[112:115], v[136:139], v[68:71]
    v_mul_f32 v24, v24, v26
    s_waitcnt lgkmcnt(5)
    v_mfma_f32_16x16x32_bf16 v[44:47], v[84:87], v[132:135], v[44:47]
    ds_read_b128 v[112:115], v8 offset:39936
    v_sub_f32_e64 v21, v24, v20
    v_mfma_f32_16x16x32_bf16 v[72:75], v[84:87], v[136:139], v[72:75]
    v_fma_f32 v184, -v24, v156, v184
    v_mfma_f32_16x16x32_bf16 v[48:51], v[88:91], v[132:135], v[48:51]
    ds_read_b128 v[84:87], v8 offset:40960
    v_fma_f32 v185, -v24, v157, v185
    v_mfma_f32_16x16x32_bf16 v[76:79], v[88:91], v[136:139], v[76:79]
    v_fma_f32 v186, -v24, v158, v186
    s_waitcnt lgkmcnt(5)
    v_mfma_f32_16x16x32_bf16 v[52:55], v[92:95], v[132:135], v[52:55]
    ds_read_b128 v[88:91], v8 offset:41984
    v_fma_f32 v187, -v24, v159, v187
    v_mfma_f32_16x16x32_bf16 v[80:83], v[92:95], v[136:139], v[80:83]
    s_waitcnt vmcnt(9)
    v_mfma_f32_16x16x32_bf16 v[28:31], v[96:99], v[140:143], v[28:31]
    ds_read_b128 v[92:95], v8 offset:43008
    buffer_load_dwordx4 v[132:135], v5, s[24:27], s60 offen offset:1024 sc1
    v_mfma_f32_16x16x32_bf16 v[56:59], v[96:99], v[144:147], v[56:59]
    buffer_load_dwordx4 v[136:139], v5, s[24:27], s62 offen offset:1024 sc1
    s_waitcnt lgkmcnt(5)
    v_mfma_f32_16x16x32_bf16 v[32:35], v[100:103], v[140:143], v[32:35]
    ds_read_b128 v[96:99], v8 offset:44032
    v_fma_f32 v188, -v24, v160, v188
    v_mfma_f32_16x16x32_bf16 v[60:63], v[100:103], v[144:147], v[60:63]
    buffer_load_dwordx4 a[156:159], v5, s[28:31], s63 offen offset:3072 sc1
    v_mfma_f32_16x16x32_bf16 v[36:39], v[104:107], v[140:143], v[36:39]
    ds_read_b128 v[100:103], v8 offset:45056
    v_fma_f32 v189, -v24, v161, v189
    v_mfma_f32_16x16x32_bf16 v[64:67], v[104:107], v[144:147], v[64:67]
    v_fma_f32 v190, -v24, v162, v190
    s_waitcnt lgkmcnt(5)
    v_mfma_f32_16x16x32_bf16 v[40:43], v[108:111], v[140:143], v[40:43]
    ds_read_b128 v[104:107], v8 offset:46080
    v_fma_f32 v191, -v24, v163, v191
    v_mfma_f32_16x16x32_bf16 v[68:71], v[108:111], v[144:147], v[68:71]
    v_fma_f32 v192, -v24, v164, v192
    v_mfma_f32_16x16x32_bf16 v[44:47], v[112:115], v[140:143], v[44:47]
    ds_read_b128 v[108:111], v8 offset:47104
    v_fma_f32 v193, -v24, v165, v193
    v_mfma_f32_16x16x32_bf16 v[72:75], v[112:115], v[144:147], v[72:75]
    s_waitcnt lgkmcnt(5)
    v_mfma_f32_16x16x32_bf16 v[48:51], v[84:87], v[140:143], v[48:51]
    ds_read_b128 v[112:115], v8 offset:48128
    v_fma_f32 v194, -v24, v166, v194
    v_mfma_f32_16x16x32_bf16 v[76:79], v[84:87], v[144:147], v[76:79]
    v_mfma_f32_16x16x32_bf16 v[52:55], v[88:91], v[140:143], v[52:55]
    ds_read_b128 v[84:87], v8 offset:49152
    v_fma_f32 v195, -v24, v167, v195
    v_mfma_f32_16x16x32_bf16 v[80:83], v[88:91], v[144:147], v[80:83]
    s_waitcnt vmcnt(10)
    s_waitcnt lgkmcnt(5)
    v_mfma_f32_16x16x32_bf16 v[28:31], v[92:95], v[148:151], v[28:31]
    ds_read_b128 v[88:91], v8 offset:50176
    buffer_load_dwordx4 v[140:143], v5, s[24:27], s60 offen offset:2048 sc1
    v_mfma_f32_16x16x32_bf16 v[56:59], v[92:95], v[152:155], v[56:59]
    buffer_load_dwordx4 v[144:147], v5, s[24:27], s62 offen offset:2048 sc1
    v_mfma_f32_16x16x32_bf16 v[32:35], v[96:99], v[148:151], v[32:35]
    ds_read_b128 v[92:95], v8 offset:51200
    v_fma_f32 v196, -v24, v168, v196
    v_mfma_f32_16x16x32_bf16 v[60:63], v[96:99], v[152:155], v[60:63]
    v_fma_f32 v197, -v24, v169, v197
    s_waitcnt lgkmcnt(5)
    v_mfma_f32_16x16x32_bf16 v[36:39], v[100:103], v[148:151], v[36:39]
    ds_read_b128 v[96:99], v8 offset:52224
    v_fma_f32 v198, -v24, v170, v198
    v_mfma_f32_16x16x32_bf16 v[64:67], v[100:103], v[152:155], v[64:67]
    v_fma_f32 v199, -v24, v171, v199
    v_mfma_f32_16x16x32_bf16 v[40:43], v[104:107], v[148:151], v[40:43]
    ds_read_b128 v[100:103], v8 offset:53248
    v_fma_f32 v200, -v24, v172, v200
    v_mfma_f32_16x16x32_bf16 v[68:71], v[104:107], v[152:155], v[68:71]
    s_waitcnt lgkmcnt(5)
    v_mfma_f32_16x16x32_bf16 v[44:47], v[108:111], v[148:151], v[44:47]
    ds_read_b128 v[104:107], v8 offset:54272
    v_fma_f32 v201, -v24, v173, v201
    v_mfma_f32_16x16x32_bf16 v[72:75], v[108:111], v[152:155], v[72:75]
    s_add_u32 s63, s55, 40960
    v_mfma_f32_16x16x32_bf16 v[48:51], v[112:115], v[148:151], v[48:51]
    ds_read_b128 v[108:111], v8 offset:55296
    buffer_load_dwordx4 a[160:163], v5, s[28:31], s63 offen offset:0 sc1
    v_mfma_f32_16x16x32_bf16 v[76:79], v[112:115], v[152:155], v[76:79]
    v_fma_f32 v202, -v24, v174, v202
    s_waitcnt lgkmcnt(5)
    v_mfma_f32_16x16x32_bf16 v[52:55], v[84:87], v[148:151], v[52:55]
    ds_read_b128 v[112:115], v8 offset:56320
    v_fma_f32 v203, -v24, v175, v203
    v_mfma_f32_16x16x32_bf16 v[80:83], v[84:87], v[152:155], v[80:83]
    s_waitcnt vmcnt(10)
    v_mfma_f32_16x16x32_bf16 v[28:31], v[88:91], v[116:119], v[28:31]
    ds_read_b128 v[84:87], v9 offset:0
    buffer_load_dwordx4 v[148:151], v5, s[24:27], s60 offen offset:3072 sc1
    v_mfma_f32_16x16x32_bf16 v[56:59], v[88:91], v[120:123], v[56:59]
    buffer_load_dwordx4 v[152:155], v5, s[24:27], s62 offen offset:3072 sc1
    s_waitcnt lgkmcnt(5)
    v_mfma_f32_16x16x32_bf16 v[32:35], v[92:95], v[116:119], v[32:35]
    ds_read_b128 v[88:91], v9 offset:1024
    buffer_load_dwordx4 a[164:167], v5, s[28:31], s63 offen offset:1024 sc1
    v_mfma_f32_16x16x32_bf16 v[60:63], v[92:95], v[120:123], v[60:63]
    v_fma_f32 v204, -v24, v176, v204
    v_mfma_f32_16x16x32_bf16 v[36:39], v[96:99], v[116:119], v[36:39]
    ds_read_b128 v[92:95], v9 offset:2048
    v_fma_f32 v205, -v24, v177, v205
    v_mfma_f32_16x16x32_bf16 v[64:67], v[96:99], v[120:123], v[64:67]
    v_fma_f32 v206, -v24, v178, v206
    s_waitcnt lgkmcnt(5)
    v_mfma_f32_16x16x32_bf16 v[40:43], v[100:103], v[116:119], v[40:43]
    ds_read_b128 v[96:99], v9 offset:3072
    buffer_load_dwordx4 a[168:171], v5, s[28:31], s63 offen offset:2048 sc1
    v_mfma_f32_16x16x32_bf16 v[68:71], v[100:103], v[120:123], v[68:71]
    v_fma_f32 v207, -v24, v179, v207
    v_mfma_f32_16x16x32_bf16 v[44:47], v[104:107], v[116:119], v[44:47]
    ds_read_b128 v[100:103], v9 offset:4096
    v_fma_f32 v208, -v24, v180, v208
    v_mfma_f32_16x16x32_bf16 v[72:75], v[104:107], v[120:123], v[72:75]
    buffer_load_dwordx4 a[172:175], v5, s[28:31], s63 offen offset:3072 sc1
    s_waitcnt lgkmcnt(5)
    v_mfma_f32_16x16x32_bf16 v[48:51], v[108:111], v[116:119], v[48:51]
    ds_read_b128 v[104:107], v9 offset:5120
    v_fma_f32 v209, -v24, v181, v209
    v_mfma_f32_16x16x32_bf16 v[76:79], v[108:111], v[120:123], v[76:79]
    v_fma_f32 v210, -v24, v182, v210
    v_mfma_f32_16x16x32_bf16 v[52:55], v[112:115], v[116:119], v[52:55]
    ds_read_b128 v[108:111], v9 offset:6144
    s_add_u32 s63, s55, 45056
    v_mfma_f32_16x16x32_bf16 v[80:83], v[112:115], v[120:123], v[80:83]
    s_waitcnt vmcnt(12)
    s_waitcnt lgkmcnt(5)
    v_mfma_f32_16x16x32_bf16 v[28:31], v[84:87], v[124:127], v[28:31]
    ds_read_b128 v[112:115], v9 offset:7168
    buffer_load_dwordx4 a[176:179], v5, s[28:31], s63 offen offset:0 sc1
    v_mfma_f32_16x16x32_bf16 v[56:59], v[84:87], v[128:131], v[56:59]
    v_fma_f32 v211, -v24, v183, v211
    v_mfma_f32_16x16x32_bf16 v[32:35], v[88:91], v[124:127], v[32:35]
    ds_read_b128 v[84:87], v9 offset:8192
    v_fma_f32 v156, v21, v156, v184
    v_mfma_f32_16x16x32_bf16 v[60:63], v[88:91], v[128:131], v[60:63]
    v_fma_f32 v157, v21, v157, v185
    s_waitcnt lgkmcnt(5)
    v_mfma_f32_16x16x32_bf16 v[36:39], v[92:95], v[124:127], v[36:39]
    ds_read_b128 v[88:91], v9 offset:9216
    buffer_load_dwordx4 a[180:183], v5, s[28:31], s63 offen offset:1024 sc1
    v_mfma_f32_16x16x32_bf16 v[64:67], v[92:95], v[128:131], v[64:67]
    v_fma_f32 v158, v21, v158, v186
    v_mfma_f32_16x16x32_bf16 v[40:43], v[96:99], v[124:127], v[40:43]
    ds_read_b128 v[92:95], v9 offset:10240
    v_fma_f32 v159, v21, v159, v187
    v_mfma_f32_16x16x32_bf16 v[68:71], v[96:99], v[128:131], v[68:71]
    buffer_load_dwordx4 a[184:187], v5, s[28:31], s63 offen offset:2048 sc1
    s_waitcnt lgkmcnt(5)
    v_mfma_f32_16x16x32_bf16 v[44:47], v[100:103], v[124:127], v[44:47]
    ds_read_b128 v[96:99], v9 offset:11264
    v_fma_f32 v160, v21, v160, v188
    v_mfma_f32_16x16x32_bf16 v[72:75], v[100:103], v[128:131], v[72:75]
    v_fma_f32 v161, v21, v161, v189
    v_mfma_f32_16x16x32_bf16 v[48:51], v[104:107], v[124:127], v[48:51]
    ds_read_b128 v[100:103], v9 offset:12288
    buffer_load_dwordx4 a[188:191], v5, s[28:31], s63 offen offset:3072 sc1
    v_mfma_f32_16x16x32_bf16 v[76:79], v[104:107], v[128:131], v[76:79]
    v_fma_f32 v162, v21, v162, v190
    s_waitcnt lgkmcnt(5)
    v_mfma_f32_16x16x32_bf16 v[52:55], v[108:111], v[124:127], v[52:55]
    ds_read_b128 v[104:107], v9 offset:13312
    v_fma_f32 v163, v21, v163, v191
    v_mfma_f32_16x16x32_bf16 v[80:83], v[108:111], v[128:131], v[80:83]
    s_waitcnt vmcnt(13)
    v_mfma_f32_16x16x32_bf16 v[28:31], v[112:115], v[132:135], v[28:31]
    ds_read_b128 v[108:111], v9 offset:14336
    v_fma_f32 v164, v21, v164, v192
    v_mfma_f32_16x16x32_bf16 v[56:59], v[112:115], v[136:139], v[56:59]
    s_add_u32 s63, s55, 49152
    s_waitcnt lgkmcnt(5)
    v_mfma_f32_16x16x32_bf16 v[32:35], v[84:87], v[132:135], v[32:35]
    ds_read_b128 v[112:115], v9 offset:15360
    buffer_load_dwordx4 a[192:195], v5, s[28:31], s63 offen offset:0 sc1
    v_mfma_f32_16x16x32_bf16 v[60:63], v[84:87], v[136:139], v[60:63]
    v_fma_f32 v165, v21, v165, v193
    v_mfma_f32_16x16x32_bf16 v[36:39], v[88:91], v[132:135], v[36:39]
    ds_read_b128 v[84:87], v9 offset:16384
    v_fma_f32 v166, v21, v166, v194
    v_mfma_f32_16x16x32_bf16 v[64:67], v[88:91], v[136:139], v[64:67]
    v_fma_f32 v167, v21, v167, v195
    s_waitcnt lgkmcnt(5)
    v_mfma_f32_16x16x32_bf16 v[40:43], v[92:95], v[132:135], v[40:43]
    ds_read_b128 v[88:91], v9 offset:17408
    buffer_load_dwordx4 a[196:199], v5, s[28:31], s63 offen offset:1024 sc1
    v_mfma_f32_16x16x32_bf16 v[68:71], v[92:95], v[136:139], v[68:71]
    v_fma_f32 v168, v21, v168, v196
    v_mfma_f32_16x16x32_bf16 v[44:47], v[96:99], v[132:135], v[44:47]
    ds_read_b128 v[92:95], v9 offset:18432
    v_fma_f32 v169, v21, v169, v197
    v_mfma_f32_16x16x32_bf16 v[72:75], v[96:99], v[136:139], v[72:75]
    buffer_load_dwordx4 a[200:203], v5, s[28:31], s63 offen offset:2048 sc1
    s_waitcnt lgkmcnt(5)
    v_mfma_f32_16x16x32_bf16 v[48:51], v[100:103], v[132:135], v[48:51]
    ds_read_b128 v[96:99], v9 offset:19456
    v_fma_f32 v170, v21, v170, v198
    v_mfma_f32_16x16x32_bf16 v[76:79], v[100:103], v[136:139], v[76:79]
    v_fma_f32 v171, v21, v171, v199
    v_mfma_f32_16x16x32_bf16 v[52:55], v[104:107], v[132:135], v[52:55]
    ds_read_b128 v[100:103], v9 offset:20480
    v_fma_f32 v172, v21, v172, v200
    v_mfma_f32_16x16x32_bf16 v[80:83], v[104:107], v[136:139], v[80:83]
    s_waitcnt vmcnt(13)
    s_waitcnt lgkmcnt(5)
    v_mfma_f32_16x16x32_bf16 v[28:31], v[108:111], v[140:143], v[28:31]
    ds_read_b128 v[104:107], v9 offset:21504
    buffer_load_dwordx4 a[204:207], v5, s[28:31], s63 offen offset:3072 sc1
    v_mfma_f32_16x16x32_bf16 v[56:59], v[108:111], v[144:147], v[56:59]
    v_fma_f32 v173, v21, v173, v201
    v_mfma_f32_16x16x32_bf16 v[32:35], v[112:115], v[140:143], v[32:35]
    ds_read_b128 v[108:111], v9 offset:22528
    v_fma_f32 v174, v21, v174, v202
    v_mfma_f32_16x16x32_bf16 v[60:63], v[112:115], v[144:147], v[60:63]
    s_add_u32 s63, s55, 53248
    s_waitcnt lgkmcnt(5)
    v_mfma_f32_16x16x32_bf16 v[36:39], v[84:87], v[140:143], v[36:39]
    ds_read_b128 v[112:115], v9 offset:23552
    buffer_load_dwordx4 a[208:211], v5, s[28:31], s63 offen offset:0 sc1
    v_mfma_f32_16x16x32_bf16 v[64:67], v[84:87], v[144:147], v[64:67]
    v_fma_f32 v175, v21, v175, v203
    v_mfma_f32_16x16x32_bf16 v[40:43], v[88:91], v[140:143], v[40:43]
    ds_read_b128 v[84:87], v9 offset:24576
    v_fma_f32 v176, v21, v176, v204
    v_mfma_f32_16x16x32_bf16 v[68:71], v[88:91], v[144:147], v[68:71]
    buffer_load_dwordx4 a[212:215], v5, s[28:31], s63 offen offset:1024 sc1
    s_waitcnt lgkmcnt(5)
    v_mfma_f32_16x16x32_bf16 v[44:47], v[92:95], v[140:143], v[44:47]
    ds_read_b128 v[88:91], v9 offset:25600
    v_fma_f32 v177, v21, v177, v205
    v_mfma_f32_16x16x32_bf16 v[72:75], v[92:95], v[144:147], v[72:75]
    v_fma_f32 v178, v21, v178, v206
    v_mfma_f32_16x16x32_bf16 v[48:51], v[96:99], v[140:143], v[48:51]
    ds_read_b128 v[92:95], v9 offset:26624
    v_fma_f32 v179, v21, v179, v207
    v_mfma_f32_16x16x32_bf16 v[76:79], v[96:99], v[144:147], v[76:79]
    buffer_load_dwordx4 v[222:225], v11, s[20:23], s37 offen
    s_waitcnt lgkmcnt(5)
    v_mfma_f32_16x16x32_bf16 v[52:55], v[100:103], v[140:143], v[52:55]
    ds_read_b128 v[96:99], v9 offset:27648
    v_fma_f32 v180, v21, v180, v208
    v_mfma_f32_16x16x32_bf16 v[80:83], v[100:103], v[144:147], v[80:83]
    s_waitcnt vmcnt(14)
    v_mfma_f32_16x16x32_bf16 v[28:31], v[104:107], v[148:151], v[28:31]
    v_fma_f32 v181, v21, v181, v209
    buffer_load_dwordx4 v[226:229], v11, s[20:23], s37 offen offset:64
    v_mfma_f32_16x16x32_bf16 v[56:59], v[104:107], v[152:155], v[56:59]
    s_waitcnt lgkmcnt(4)
    v_mfma_f32_16x16x32_bf16 v[32:35], v[108:111], v[148:151], v[32:35]
    v_fma_f32 v182, v21, v182, v210
    v_mfma_f32_16x16x32_bf16 v[60:63], v[108:111], v[152:155], v[60:63]
    v_mfma_f32_16x16x32_bf16 v[36:39], v[112:115], v[148:151], v[36:39]
    v_fma_f32 v183, v21, v183, v211
    buffer_load_dwordx2 v[230:231], v11, s[20:23], s38 offen
    v_mfma_f32_16x16x32_bf16 v[64:67], v[112:115], v[152:155], v[64:67]
    s_waitcnt lgkmcnt(2)
    v_mfma_f32_16x16x32_bf16 v[40:43], v[84:87], v[148:151], v[40:43]
    v_mfma_f32_16x16x32_bf16 v[68:71], v[84:87], v[152:155], v[68:71]
    v_mfma_f32_16x16x32_bf16 v[44:47], v[88:91], v[148:151], v[44:47]
    v_mfma_f32_16x16x32_bf16 v[72:75], v[88:91], v[152:155], v[72:75]
    s_waitcnt lgkmcnt(0)
    v_mfma_f32_16x16x32_bf16 v[48:51], v[92:95], v[148:151], v[48:51]
    v_mfma_f32_16x16x32_bf16 v[76:79], v[92:95], v[152:155], v[76:79]
    v_mfma_f32_16x16x32_bf16 v[52:55], v[96:99], v[148:151], v[52:55]
    v_mfma_f32_16x16x32_bf16 v[80:83], v[96:99], v[152:155], v[80:83]
    v_pk_fma_f32 v[28:29], v[28:29], v[22:23], v[156:157] op_sel_hi:[1,0,1]
    buffer_load_dwordx4 a[216:219], v5, s[28:31], s63 offen offset:2048 sc1
    v_pk_fma_f32 v[30:31], v[30:31], v[22:23], v[158:159] op_sel_hi:[1,0,1]
    v_pk_fma_f32 v[32:33], v[32:33], v[22:23], v[160:161] op_sel_hi:[1,0,1]
    v_pk_fma_f32 v[34:35], v[34:35], v[22:23], v[162:163] op_sel_hi:[1,0,1]
    v_pk_fma_f32 v[36:37], v[36:37], v[22:23], v[164:165] op_sel_hi:[1,0,1]
    v_pk_fma_f32 v[38:39], v[38:39], v[22:23], v[166:167] op_sel_hi:[1,0,1]
    v_pk_fma_f32 v[40:41], v[40:41], v[22:23], v[168:169] op_sel_hi:[1,0,1]
    v_pk_fma_f32 v[42:43], v[42:43], v[22:23], v[170:171] op_sel_hi:[1,0,1]
    v_pk_mul_f32 v[84:85], v[28:29], v[28:29]
    v_pk_mul_f32 v[86:87], v[30:31], v[30:31]
    v_pk_mul_f32 v[88:89], v[32:33], v[32:33]
    v_pk_mul_f32 v[90:91], v[34:35], v[34:35]
    v_pk_mul_f32 v[92:93], v[36:37], v[36:37]
    v_pk_mul_f32 v[94:95], v[38:39], v[38:39]
    v_pk_mul_f32 v[96:97], v[40:41], v[40:41]
    buffer_load_dwordx4 a[220:223], v5, s[28:31], s63 offen offset:3072 sc1
    v_pk_mul_f32 v[98:99], v[42:43], v[42:43]
    v_pk_fma_f32 v[84:85], v[84:85], s[14:15], v[18:19]
    v_pk_fma_f32 v[86:87], v[86:87], s[14:15], v[18:19]
    v_pk_fma_f32 v[88:89], v[88:89], s[14:15], v[18:19]
    v_pk_fma_f32 v[90:91], v[90:91], s[14:15], v[18:19]
    v_pk_fma_f32 v[92:93], v[92:93], s[14:15], v[18:19]
    v_pk_fma_f32 v[94:95], v[94:95], s[14:15], v[18:19]
    v_pk_fma_f32 v[96:97], v[96:97], s[14:15], v[18:19]
    v_pk_fma_f32 v[98:99], v[98:99], s[14:15], v[18:19]
    v_pk_mul_f32 v[84:85], v[84:85], v[28:29]
    v_pk_mul_f32 v[86:87], v[86:87], v[30:31]
    v_pk_mul_f32 v[88:89], v[88:89], v[32:33]
    v_pk_mul_f32 v[90:91], v[90:91], v[34:35]
    v_pk_mul_f32 v[92:93], v[92:93], v[36:37]
    v_pk_mul_f32 v[94:95], v[94:95], v[38:39]
    s_add_u32 s63, s55, 57344
    buffer_load_dwordx4 a[224:227], v5, s[28:31], s63 offen offset:0 sc1
    v_pk_mul_f32 v[96:97], v[96:97], v[40:41]
    v_pk_mul_f32 v[98:99], v[98:99], v[42:43]
    v_exp_f32 v84, v84
    v_exp_f32 v85, v85
    v_exp_f32 v86, v86
    v_exp_f32 v87, v87
    v_exp_f32 v88, v88
    v_exp_f32 v89, v89
    v_exp_f32 v90, v90
    v_exp_f32 v91, v91
    v_exp_f32 v92, v92
    v_exp_f32 v93, v93
    v_exp_f32 v94, v94
    v_exp_f32 v95, v95
    v_exp_f32_e64 v96, v96
    buffer_load_dwordx4 a[228:231], v5, s[28:31], s63 offen offset:1024 sc1
    v_exp_f32 v97, v97
    v_exp_f32 v98, v98
    v_exp_f32_e64 v99, v99
    v_pk_add_f32 v[84:85], v[84:85], 1.0 op_sel_hi:[1,0]
    v_pk_add_f32 v[86:87], v[86:87], 1.0 op_sel_hi:[1,0]
    v_pk_add_f32 v[88:89], v[88:89], 1.0 op_sel_hi:[1,0]
    v_pk_add_f32 v[90:91], v[90:91], 1.0 op_sel_hi:[1,0]
    v_pk_add_f32 v[92:93], v[92:93], 1.0 op_sel_hi:[1,0]
    v_pk_add_f32 v[94:95], v[94:95], 1.0 op_sel_hi:[1,0]
    v_pk_add_f32 v[96:97], v[96:97], 1.0 op_sel_hi:[1,0]
    v_pk_add_f32 v[98:99], v[98:99], 1.0 op_sel_hi:[1,0]
    v_rcp_f32 v84, v84
    v_rcp_f32 v85, v85
    v_rcp_f32_e64 v86, v86
    buffer_load_dwordx4 a[232:235], v5, s[28:31], s63 offen offset:2048 sc1
    v_rcp_f32 v87, v87
    v_rcp_f32 v88, v88
    v_rcp_f32 v89, v89
    v_rcp_f32 v90, v90
    v_rcp_f32 v91, v91
    v_rcp_f32 v92, v92
    v_rcp_f32 v93, v93
    v_rcp_f32 v94, v94
    v_rcp_f32 v95, v95
    v_rcp_f32 v96, v96
    v_rcp_f32 v97, v97
    v_rcp_f32 v98, v98
    v_rcp_f32_e64 v99, v99
    v_pk_mul_f32 v[84:85], v[84:85], v[28:29]
    v_pk_mul_f32 v[86:87], v[86:87], v[30:31]
    buffer_load_dwordx4 a[236:239], v5, s[28:31], s63 offen offset:3072 sc1
    v_pk_mul_f32 v[88:89], v[88:89], v[32:33]
    v_pk_mul_f32 v[90:91], v[90:91], v[34:35]
    v_pk_mul_f32 v[92:93], v[92:93], v[36:37]
    v_pk_mul_f32 v[94:95], v[94:95], v[38:39]
    v_pk_mul_f32 v[96:97], v[96:97], v[40:41]
    v_pk_mul_f32 v[98:99], v[98:99], v[42:43]
    v_cvt_pk_bf16_f32 v100, v84, v85
    v_cvt_pk_bf16_f32 v101, v86, v87
    v_cvt_pk_bf16_f32 v102, v88, v89
    v_cvt_pk_bf16_f32 v103, v90, v91
    v_cvt_pk_bf16_f32 v104, v92, v93
    v_cvt_pk_bf16_f32 v105, v94, v95
    v_cvt_pk_bf16_f32 v106, v96, v97
    v_cvt_pk_bf16_f32 v107, v98, v99
    buffer_store_dwordx4 v[100:103], v5, s[28:31], s64 offen offset:0
    buffer_store_dwordx4 v[104:107], v5, s[28:31], s66 offen offset:1024
    v_pk_fma_f32 v[44:45], v[44:45], v[22:23], v[172:173] op_sel_hi:[1,0,1]
    s_add_u32 s63, s55, 61440
    buffer_load_dwordx4 a[240:243], v6, s[28:31], s63 offen offset:0 sc1
    v_pk_fma_f32 v[46:47], v[46:47], v[22:23], v[174:175] op_sel_hi:[1,0,1]
    v_pk_fma_f32 v[48:49], v[48:49], v[22:23], v[176:177] op_sel_hi:[1,0,1]
    v_pk_fma_f32 v[50:51], v[50:51], v[22:23], v[178:179] op_sel_hi:[1,0,1]
    v_pk_fma_f32 v[52:53], v[52:53], v[22:23], v[180:181] op_sel_hi:[1,0,1]
    v_pk_fma_f32 v[54:55], v[54:55], v[22:23], v[182:183] op_sel_hi:[1,0,1]
    v_pk_mul_f32 v[84:85], v[44:45], v[44:45]
    v_pk_mul_f32 v[86:87], v[46:47], v[46:47]
    v_pk_mul_f32 v[88:89], v[48:49], v[48:49]
    v_pk_mul_f32 v[90:91], v[50:51], v[50:51]
    v_pk_mul_f32 v[92:93], v[52:53], v[52:53]
    v_pk_mul_f32 v[94:95], v[54:55], v[54:55]
    buffer_load_dwordx4 a[244:247], v6, s[28:31], s63 offen offset:1024 sc1
    v_pk_fma_f32 v[84:85], v[84:85], s[14:15], v[18:19]
    v_pk_fma_f32 v[86:87], v[86:87], s[14:15], v[18:19]
    v_pk_fma_f32 v[88:89], v[88:89], s[14:15], v[18:19]
    v_pk_fma_f32 v[90:91], v[90:91], s[14:15], v[18:19]
    v_pk_fma_f32 v[92:93], v[92:93], s[14:15], v[18:19]
    v_pk_fma_f32 v[94:95], v[94:95], s[14:15], v[18:19]
    v_pk_mul_f32 v[84:85], v[84:85], v[44:45]
    v_pk_mul_f32 v[86:87], v[86:87], v[46:47]
    v_pk_mul_f32 v[88:89], v[88:89], v[48:49]
    v_pk_mul_f32 v[90:91], v[90:91], v[50:51]
    v_pk_mul_f32 v[92:93], v[92:93], v[52:53]
    buffer_load_dwordx4 a[248:251], v6, s[28:31], s63 offen offset:2048 sc1
    v_pk_mul_f32 v[94:95], v[94:95], v[54:55]
    v_exp_f32 v84, v84
    v_exp_f32 v85, v85
    v_exp_f32 v86, v86
    v_exp_f32 v87, v87
    v_exp_f32 v88, v88
    v_exp_f32 v89, v89
    v_exp_f32 v90, v90
    v_exp_f32 v91, v91
    v_exp_f32 v92, v92
    v_exp_f32 v93, v93
    buffer_load_dwordx4 a[252:255], v6, s[28:31], s63 offen offset:3072 sc1
    v_exp_f32 v94, v94
    v_exp_f32 v95, v95
    v_pk_add_f32 v[84:85], v[84:85], 1.0 op_sel_hi:[1,0]
    v_pk_add_f32 v[86:87], v[86:87], 1.0 op_sel_hi:[1,0]
    v_pk_add_f32 v[88:89], v[88:89], 1.0 op_sel_hi:[1,0]
    v_pk_add_f32 v[90:91], v[90:91], 1.0 op_sel_hi:[1,0]
    v_pk_add_f32 v[92:93], v[92:93], 1.0 op_sel_hi:[1,0]
    v_pk_add_f32 v[94:95], v[94:95], 1.0 op_sel_hi:[1,0]
    v_rcp_f32 v84, v84
    v_rcp_f32 v85, v85
    v_rcp_f32_e64 v86, v86
    s_add_u32 s63, s55, 65536
    buffer_load_dwordx4 v[232:235], v6, s[28:31], s63 offen offset:0 sc1
    v_rcp_f32 v87, v87
    v_rcp_f32 v88, v88
    v_rcp_f32 v89, v89
    v_rcp_f32 v90, v90
    v_rcp_f32 v91, v91
    v_rcp_f32 v92, v92
    v_rcp_f32 v93, v93
    v_rcp_f32 v94, v94
    v_rcp_f32_e64 v95, v95
    v_pk_mul_f32 v[84:85], v[84:85], v[44:45]
    v_pk_mul_f32 v[86:87], v[86:87], v[46:47]
    buffer_load_dwordx4 v[236:239], v6, s[28:31], s63 offen offset:1024 sc1
    v_pk_mul_f32 v[88:89], v[88:89], v[48:49]
    v_pk_mul_f32 v[90:91], v[90:91], v[50:51]
    v_pk_mul_f32 v[92:93], v[92:93], v[52:53]
    v_pk_mul_f32 v[94:95], v[94:95], v[54:55]
    v_cvt_pk_bf16_f32 v108, v84, v85
    v_cvt_pk_bf16_f32 v109, v86, v87
    v_cvt_pk_bf16_f32 v110, v88, v89
    v_cvt_pk_bf16_f32 v111, v90, v91
    v_cvt_pk_bf16_f32 v112, v92, v93
    v_cvt_pk_bf16_f32 v113, v94, v95
    buffer_store_dwordx4 v[108:111], v5, s[28:31], s66 offen offset:2048
    buffer_store_dwordx2 v[112:113], v5, s[28:31], s65 offen
    v_pk_fma_f32 v[56:57], v[56:57], v[26:27], v[184:185] op_sel_hi:[1,0,1]
    buffer_load_dwordx4 v[240:243], v6, s[28:31], s63 offen offset:2048 sc1
    v_pk_fma_f32 v[58:59], v[58:59], v[26:27], v[186:187] op_sel_hi:[1,0,1]
    v_pk_fma_f32 v[60:61], v[60:61], v[26:27], v[188:189] op_sel_hi:[1,0,1]
    v_pk_fma_f32 v[62:63], v[62:63], v[26:27], v[190:191] op_sel_hi:[1,0,1]
    v_pk_fma_f32 v[64:65], v[64:65], v[26:27], v[192:193] op_sel_hi:[1,0,1]
    v_pk_fma_f32 v[66:67], v[66:67], v[26:27], v[194:195] op_sel_hi:[1,0,1]
    v_pk_fma_f32 v[68:69], v[68:69], v[26:27], v[196:197] op_sel_hi:[1,0,1]
    v_pk_fma_f32 v[70:71], v[70:71], v[26:27], v[198:199] op_sel_hi:[1,0,1]
    v_pk_mul_f32 v[84:85], v[56:57], v[56:57]
    v_pk_mul_f32 v[86:87], v[58:59], v[58:59]
    v_pk_mul_f32 v[88:89], v[60:61], v[60:61]
    v_pk_mul_f32 v[90:91], v[62:63], v[62:63]
    v_pk_mul_f32 v[92:93], v[64:65], v[64:65]
    v_pk_mul_f32 v[94:95], v[66:67], v[66:67]
    v_pk_mul_f32 v[96:97], v[68:69], v[68:69]
    v_pk_mul_f32 v[98:99], v[70:71], v[70:71]
    v_pk_fma_f32 v[84:85], v[84:85], s[14:15], v[18:19]
    v_pk_fma_f32 v[86:87], v[86:87], s[14:15], v[18:19]
    v_pk_fma_f32 v[88:89], v[88:89], s[14:15], v[18:19]
    v_pk_fma_f32 v[90:91], v[90:91], s[14:15], v[18:19]
    v_pk_fma_f32 v[92:93], v[92:93], s[14:15], v[18:19]
    v_pk_fma_f32 v[94:95], v[94:95], s[14:15], v[18:19]
    v_pk_fma_f32 v[96:97], v[96:97], s[14:15], v[18:19]
    buffer_load_dwordx4 v[244:247], v6, s[28:31], s63 offen offset:3072 sc1
    v_pk_fma_f32 v[98:99], v[98:99], s[14:15], v[18:19]
    v_pk_mul_f32 v[84:85], v[84:85], v[56:57]
    v_pk_mul_f32 v[86:87], v[86:87], v[58:59]
    v_pk_mul_f32 v[88:89], v[88:89], v[60:61]
    v_pk_mul_f32 v[90:91], v[90:91], v[62:63]
    v_pk_mul_f32 v[92:93], v[92:93], v[64:65]
    v_pk_mul_f32 v[94:95], v[94:95], v[66:67]
    v_pk_mul_f32 v[96:97], v[96:97], v[68:69]
    v_pk_mul_f32 v[98:99], v[98:99], v[70:71]
    v_exp_f32 v84, v84
    v_exp_f32 v85, v85
    v_exp_f32 v86, v86
    v_exp_f32 v87, v87
    v_exp_f32 v88, v88
    v_exp_f32 v89, v89
    v_exp_f32 v90, v90
    v_exp_f32 v91, v91
    v_exp_f32 v92, v92
    v_exp_f32 v93, v93
    v_exp_f32 v94, v94
    v_exp_f32 v95, v95
    v_exp_f32_e64 v96, v96
    s_add_u32 s63, s55, 69632
    buffer_load_dwordx4 v[248:251], v6, s[28:31], s63 offen offset:0 sc1
    v_exp_f32 v97, v97
    v_exp_f32 v98, v98
    v_exp_f32_e64 v99, v99
    v_pk_add_f32 v[84:85], v[84:85], 1.0 op_sel_hi:[1,0]
    v_pk_add_f32 v[86:87], v[86:87], 1.0 op_sel_hi:[1,0]
    v_pk_add_f32 v[88:89], v[88:89], 1.0 op_sel_hi:[1,0]
    v_pk_add_f32 v[90:91], v[90:91], 1.0 op_sel_hi:[1,0]
    v_pk_add_f32 v[92:93], v[92:93], 1.0 op_sel_hi:[1,0]
    v_pk_add_f32 v[94:95], v[94:95], 1.0 op_sel_hi:[1,0]
    v_pk_add_f32 v[96:97], v[96:97], 1.0 op_sel_hi:[1,0]
    v_pk_add_f32 v[98:99], v[98:99], 1.0 op_sel_hi:[1,0]
    v_rcp_f32 v84, v84
    v_rcp_f32 v85, v85
    v_rcp_f32 v86, v86
    v_rcp_f32 v87, v87
    v_rcp_f32 v88, v88
    v_rcp_f32 v89, v89
    v_rcp_f32 v90, v90
    v_rcp_f32 v91, v91
    v_rcp_f32 v92, v92
    v_rcp_f32 v93, v93
    v_rcp_f32_e64 v94, v94
    buffer_load_dwordx4 v[252:255], v6, s[28:31], s63 offen offset:1024 sc1
    v_rcp_f32 v95, v95
    v_rcp_f32 v96, v96
    v_rcp_f32 v97, v97
    v_rcp_f32 v98, v98
    v_rcp_f32_e64 v99, v99
    v_pk_mul_f32 v[84:85], v[84:85], v[56:57]
    v_pk_mul_f32 v[86:87], v[86:87], v[58:59]
    v_pk_mul_f32 v[88:89], v[88:89], v[60:61]
    v_pk_mul_f32 v[90:91], v[90:91], v[62:63]
    v_pk_mul_f32 v[92:93], v[92:93], v[64:65]
    v_pk_mul_f32 v[94:95], v[94:95], v[66:67]
    v_pk_mul_f32 v[96:97], v[96:97], v[68:69]
    v_pk_mul_f32 v[98:99], v[98:99], v[70:71]
    v_cvt_pk_bf16_f32 v116, v84, v85
    v_cvt_pk_bf16_f32 v117, v86, v87
    v_cvt_pk_bf16_f32 v118, v88, v89
    v_cvt_pk_bf16_f32 v119, v90, v91
    v_cvt_pk_bf16_f32 v120, v92, v93
    v_cvt_pk_bf16_f32 v121, v94, v95
    v_cvt_pk_bf16_f32 v122, v96, v97
    v_cvt_pk_bf16_f32 v123, v98, v99
    buffer_store_dwordx4 v[116:119], v5, s[28:31], s67 offen offset:0
    buffer_store_dwordx4 v[120:123], v5, s[28:31], s69 offen offset:1024
    v_pk_fma_f32 v[72:73], v[72:73], v[26:27], v[200:201] op_sel_hi:[1,0,1]
    v_pk_fma_f32 v[74:75], v[74:75], v[26:27], v[202:203] op_sel_hi:[1,0,1]
    v_pk_fma_f32 v[76:77], v[76:77], v[26:27], v[204:205] op_sel_hi:[1,0,1]
    v_pk_fma_f32 v[78:79], v[78:79], v[26:27], v[206:207] op_sel_hi:[1,0,1]
    v_pk_fma_f32 v[80:81], v[80:81], v[26:27], v[208:209] op_sel_hi:[1,0,1]
    v_pk_fma_f32 v[82:83], v[82:83], v[26:27], v[210:211] op_sel_hi:[1,0,1]
    v_pk_mul_f32 v[84:85], v[72:73], v[72:73]
    v_pk_mul_f32 v[86:87], v[74:75], v[74:75]
    v_pk_mul_f32 v[88:89], v[76:77], v[76:77]
    v_pk_mul_f32 v[90:91], v[78:79], v[78:79]
    v_pk_mul_f32 v[92:93], v[80:81], v[80:81]
    v_pk_mul_f32 v[94:95], v[82:83], v[82:83]
    v_pk_fma_f32 v[84:85], v[84:85], s[14:15], v[18:19]
    v_pk_fma_f32 v[86:87], v[86:87], s[14:15], v[18:19]
    v_pk_fma_f32 v[88:89], v[88:89], s[14:15], v[18:19]
    v_pk_fma_f32 v[90:91], v[90:91], s[14:15], v[18:19]
    v_pk_fma_f32 v[92:93], v[92:93], s[14:15], v[18:19]
    v_pk_fma_f32 v[94:95], v[94:95], s[14:15], v[18:19]
    v_pk_mul_f32 v[84:85], v[84:85], v[72:73]
    v_pk_mul_f32 v[86:87], v[86:87], v[74:75]
    v_pk_mul_f32 v[88:89], v[88:89], v[76:77]
    v_pk_mul_f32 v[90:91], v[90:91], v[78:79]
    v_pk_mul_f32 v[92:93], v[92:93], v[80:81]
    v_pk_mul_f32 v[94:95], v[94:95], v[82:83]
    v_exp_f32 v84, v84
    v_exp_f32 v85, v85
    v_exp_f32 v86, v86
    v_exp_f32 v87, v87
    v_exp_f32 v88, v88
    v_exp_f32 v89, v89
    v_exp_f32 v90, v90
    v_exp_f32 v91, v91
    v_exp_f32 v92, v92
    v_exp_f32 v93, v93
    v_exp_f32 v94, v94
    v_exp_f32 v95, v95
    v_pk_add_f32 v[84:85], v[84:85], 1.0 op_sel_hi:[1,0]
    v_pk_add_f32 v[86:87], v[86:87], 1.0 op_sel_hi:[1,0]
    v_pk_add_f32 v[88:89], v[88:89], 1.0 op_sel_hi:[1,0]
    v_pk_add_f32 v[90:91], v[90:91], 1.0 op_sel_hi:[1,0]
    v_pk_add_f32 v[92:93], v[92:93], 1.0 op_sel_hi:[1,0]
    v_pk_add_f32 v[94:95], v[94:95], 1.0 op_sel_hi:[1,0]
    v_rcp_f32 v84, v84
    v_rcp_f32 v85, v85
    v_rcp_f32 v86, v86
    v_rcp_f32 v87, v87
    v_rcp_f32 v88, v88
    v_rcp_f32 v89, v89
    v_rcp_f32 v90, v90
    v_rcp_f32 v91, v91
    v_rcp_f32 v92, v92
    v_rcp_f32 v93, v93
    v_rcp_f32 v94, v94
    v_rcp_f32 v95, v95
    v_pk_mul_f32 v[84:85], v[84:85], v[72:73]
    v_pk_mul_f32 v[86:87], v[86:87], v[74:75]
    v_pk_mul_f32 v[88:89], v[88:89], v[76:77]
    v_pk_mul_f32 v[90:91], v[90:91], v[78:79]
    v_pk_mul_f32 v[92:93], v[92:93], v[80:81]
    v_pk_mul_f32 v[94:95], v[94:95], v[82:83]
    v_cvt_pk_bf16_f32 v124, v84, v85
    v_cvt_pk_bf16_f32 v125, v86, v87
    v_cvt_pk_bf16_f32 v126, v88, v89
    v_cvt_pk_bf16_f32 v127, v90, v91
    v_cvt_pk_bf16_f32 v128, v92, v93
    v_cvt_pk_bf16_f32 v129, v94, v95
    buffer_store_dwordx4 v[124:127], v5, s[28:31], s69 offen offset:2048
    buffer_store_dwordx2 v[128:129], v5, s[28:31], s68 offen
    s_lshl_b32 s34, s32, 4
    s_and_b32 s35, s33, 8
    s_lshr_b32 s35, s35, 2
    s_add_u32 s34, s34, s35
    v_bfe_u32 v17, v1, 1, 2
    v_lshl_add_u32 v17, v17, 2, s34
    v_and_or_b32 v17, v1, 1, v17
    s_add_u32 s34, s32, 1
    s_and_b32 s34, s34, 3
    s_mul_i32 s34, s34, 10240
    s_add_u32 s34, s34, 16384
    v_add_u32_e64 v13, s34, v5
    s_add_u32 s34, s32, 2
    s_and_b32 s34, s34, 3
    s_mul_i32 s34, s34, 10240
    s_add_u32 s34, s34, 21504
    v_add_u32_e64 v14, s34, v5
    s_add_u32 s34, s32, 3
    s_and_b32 s34, s34, 3
    s_mul_i32 s34, s34, 5120
    s_add_u32 s34, s34, 57344
    v_add_u32_e64 v15, s34, v5
    s_add_u32 s34, s32, 4
    s_and_b32 s34, s34, 3
    s_mul_i32 s34, s34, 10240
    s_add_u32 s34, s34, 16384
    v_add_u32_e64 v16, s34, v5
    s_add_u32 s34, s32, 4
    s_and_b32 s34, s34, 3
    s_mul_i32 s34, s34, 5120
    s_add_u32 s34, s34, 57344
    v_add_u32 v18, s34, v5
    v_mov_b32 v2, s57
    v_lshlrev_b32 v3, 24, v1
    s_cmp_eq_u32 s57, 1
    s_waitcnt vmcnt(0)
    s_cbranch_scc0 K2_SS4
    buffer_store_byte v2, v3, s[28:31], s59 offen offset:384
K2_SR4:
    s_barrier
    s_mov_b32 s3, 0x100000
PL_13:
    buffer_load_ubyte v2, v17, s[28:31], s56 offen offset:384 sc1
    s_sub_u32 s3, s3, 1
    s_cbranch_scc1 PL_13x
    s_waitcnt vmcnt(0)
    v_cmp_eq_u32 vcc, 0, v2
    s_cbranch_vccnz PL_13
    v_cmp_ne_u32 vcc, 1, v2
    s_cbranch_vccnz PL_13a
PL_13x:
    buffer_load_dwordx4 v[140:143], v5, s[28:31], s70 offen offset:0 sc1
    buffer_load_dwordx4 v[144:147], v5, s[28:31], s70 offen offset:1024 sc1
    v_lshlrev_b32_e64 v120, 16, v212
    v_and_b32 v121, 0xffff0000, v212
    v_lshlrev_b32_e64 v100, 16, v222
    v_and_b32 v101, 0xffff0000, v222
    v_lshlrev_b32_e64 v122, 16, v213
    v_and_b32 v123, 0xffff0000, v213
    v_lshlrev_b32_e64 v102, 16, v223
    v_and_b32 v103, 0xffff0000, v223
    buffer_load_dwordx4 v[148:151], v5, s[28:31], s70 offen offset:2048 sc1
    v_lshlrev_b32_e64 v124, 16, v214
    v_and_b32 v125, 0xffff0000, v214
    v_lshlrev_b32_e64 v104, 16, v224
    v_and_b32 v105, 0xffff0000, v224
    v_lshlrev_b32_e64 v126, 16, v215
    v_and_b32 v127, 0xffff0000, v215
    v_lshlrev_b32_e64 v106, 16, v225
    v_and_b32 v107, 0xffff0000, v225
    v_lshlrev_b32_e64 v128, 16, v216
    v_and_b32 v129, 0xffff0000, v216
    v_lshlrev_b32_e64 v108, 16, v226
    v_and_b32 v109, 0xffff0000, v226
    buffer_load_dwordx4 v[152:155], v5, s[28:31], s70 offen offset:3072 sc1
    v_lshlrev_b32_e64 v130, 16, v217
    v_and_b32 v131, 0xffff0000, v217
    v_lshlrev_b32_e64 v110, 16, v227
    v_and_b32 v111, 0xffff0000, v227
    v_lshlrev_b32_e64 v132, 16, v218
    v_and_b32 v133, 0xffff0000, v218
    v_lshlrev_b32_e64 v112, 16, v228
    v_and_b32 v113, 0xffff0000, v228
    v_lshlrev_b32_e64 v134, 16, v219
    v_and_b32 v135, 0xffff0000, v219
    v_lshlrev_b32_e64 v114, 16, v229
    s_add_u32 s70, s70, 4096
    buffer_load_dwordx4 v[156:159], v5, s[28:31], s70 offen offset:0 sc1
    v_and_b32 v115, 0xffff0000, v229
    v_lshlrev_b32_e64 v136, 16, v220
    v_and_b32 v137, 0xffff0000, v220
    v_lshlrev_b32_e64 v116, 16, v230
    v_and_b32 v117, 0xffff0000, v230
    v_lshlrev_b32_e64 v138, 16, v221
    v_and_b32 v139, 0xffff0000, v221
    v_lshlrev_b32_e64 v118, 16, v231
    v_and_b32 v119, 0xffff0000, v231
    v_pk_add_f32 v[120:121], v[120:121], v[100:101]
    v_pk_add_f32 v[122:123], v[122:123], v[102:103]
    buffer_load_dwordx4 v[160:163], v5, s[28:31], s70 offen offset:1024 sc1
    v_pk_add_f32 v[124:125], v[124:125], v[104:105]
    v_pk_add_f32 v[126:127], v[126:127], v[106:107]
    v_pk_add_f32 v[128:129], v[128:129], v[108:109]
    v_pk_add_f32 v[130:131], v[130:131], v[110:111]
    v_pk_add_f32 v[132:133], v[132:133], v[112:113]
    v_pk_add_f32 v[134:135], v[134:135], v[114:115]
    v_pk_add_f32 v[136:137], v[136:137], v[116:117]
    v_pk_add_f32 v[138:139], v[138:139], v[118:119]
    v_and_b32 v2, 15, v1
    v_lshrrev_b32 v3, 4, v1
    s_mul_i32 s35, s32, 2816
    v_mul_u32_u24 v7, 176, v2
    buffer_load_dwordx4 v[164:167], v5, s[28:31], s70 offen offset:2048 sc1
    v_add_u32_e64 v7, s35, v7
    v_lshl_add_u32 v8, v3, 3, v7
    v_lshl_add_u32 v7, v3, 4, v7
    v_lshrrev_b32 v2, 3, v1
    v_and_b32 v3, 7, v1
    v_mul_u32_u24 v9, 176, v2
    v_lshl_add_u32 v9, v3, 4, v9
    v_add_u32_e64 v9, s35, v9
    v_mul_u32_u24 v11, 1280, v2
    v_lshl_add_u32 v11, v3, 4, v11
    v_lshrrev_b32_e64 v2, 2, v1
    buffer_load_dwordx4 v[168:171], v5, s[28:31], s70 offen offset:3072 sc1
    v_and_b32_e64 v3, 3, v1
    v_mul_u32_u24 v10, 176, v2
    v_lshl_add_u32 v10, v3, 3, v10
    v_add_u32_e64 v10, s35, v10
    v_mul_u32_u24 v12, 1280, v2
    v_lshl_add_u32 v12, v3, 4, v12
    s_add_u32 s34, s44, s32
    s_mul_i32 s34, s34, 20480
    s_add_u32 s37, s37, s34
    s_add_u32 s38, s38, s34
    s_add_u32 s39, s37, 10240
    s_waitcnt vmcnt(7)
    v_mfma_f32_16x16x32_bf16 v[20:23], a[0:3], v[140:143], 0
    v_mfma_f32_16x16x32_bf16 v[24:27], a[4:7], v[140:143], 0
    s_add_u32 s70, s70, 4096
    buffer_load_dwordx4 v[172:175], v5, s[28:31], s70 offen offset:0 sc1
    v_mfma_f32_16x16x32_bf16 v[28:31], a[8:11], v[140:143], 0
    v_mfma_f32_16x16x32_bf16 v[32:35], a[12:15], v[140:143], 0
    v_mfma_f32_16x16x32_bf16 v[36:39], a[16:19], v[140:143], 0
    s_waitcnt vmcnt(7)
    v_mfma_f32_16x16x32_bf16 v[20:23], a[20:23], v[144:147], v[20:23]
    v_mfma_f32_16x16x32_bf16 v[24:27], a[24:27], v[144:147], v[24:27]
    buffer_load_dwordx4 v[176:179], v5, s[28:31], s70 offen offset:1024 sc1
    v_mfma_f32_16x16x32_bf16 v[28:31], a[28:31], v[144:147], v[28:31]
    v_mfma_f32_16x16x32_bf16 v[32:35], a[32:35], v[144:147], v[32:35]
    v_mfma_f32_16x16x32_bf16 v[36:39], a[36:39], v[144:147], v[36:39]
    s_waitcnt vmcnt(7)
    v_mfma_f32_16x16x32_bf16 v[20:23], a[40:43], v[148:151], v[20:23]
    v_mfma_f32_16x16x32_bf16 v[24:27], a[44:47], v[148:151], v[24:27]
    buffer_load_dwordx4 v[180:183], v5, s[28:31], s70 offen offset:2048 sc1
    v_mfma_f32_16x16x32_bf16 v[28:31], a[48:51], v[148:151], v[28:31]
    v_mfma_f32_16x16x32_bf16 v[32:35], a[52:55], v[148:151], v[32:35]
    v_mfma_f32_16x16x32_bf16 v[36:39], a[56:59], v[148:151], v[36:39]
    s_waitcnt vmcnt(7)
    v_mfma_f32_16x16x32_bf16 v[20:23], a[60:63], v[152:155], v[20:23]
    v_mfma_f32_16x16x32_bf16 v[24:27], a[64:67], v[152:155], v[24:27]
    buffer_load_dwordx4 v[184:187], v5, s[28:31], s70 offen offset:3072 sc1
    v_mfma_f32_16x16x32_bf16 v[28:31], a[68:71], v[152:155], v[28:31]
    v_mfma_f32_16x16x32_bf16 v[32:35], a[72:75], v[152:155], v[32:35]
    v_mfma_f32_16x16x32_bf16 v[36:39], a[76:79], v[152:155], v[36:39]
    s_waitcnt vmcnt(7)
    v_mfma_f32_16x16x32_bf16 v[20:23], a[80:83], v[156:159], v[20:23]
    v_mfma_f32_16x16x32_bf16 v[24:27], a[84:87], v[156:159], v[24:27]
    s_add_u32 s70, s70, 4096
    buffer_load_dwordx4 v[188:191], v6, s[28:31], s70 offen offset:0 sc1
    v_mfma_f32_16x16x32_bf16 v[28:31], a[88:91], v[156:159], v[28:31]
    v_mfma_f32_16x16x32_bf16 v[32:35], a[92:95], v[156:159], v[32:35]
    v_mfma_f32_16x16x32_bf16 v[36:39], a[96:99], v[156:159], v[36:39]
    s_waitcnt vmcnt(7)
    v_mfma_f32_16x16x32_bf16 v[20:23], a[100:103], v[160:163], v[20:23]
    v_mfma_f32_16x16x32_bf16 v[24:27], a[104:107], v[160:163], v[24:27]
    buffer_load_dwordx4 v[192:195], v6, s[28:31], s70 offen offset:1024 sc1
    v_mfma_f32_16x16x32_bf16 v[28:31], a[108:111], v[160:163], v[28:31]
    v_mfma_f32_16x16x32_bf16 v[32:35], a[112:115], v[160:163], v[32:35]
    v_mfma_f32_16x16x32_bf16 v[36:39], a[116:119], v[160:163], v[36:39]
    s_waitcnt vmcnt(7)
    v_mfma_f32_16x16x32_bf16 v[20:23], a[120:123], v[164:167], v[20:23]
    v_mfma_f32_16x16x32_bf16 v[24:27], a[124:127], v[164:167], v[24:27]
    buffer_load_dwordx4 v[196:199], v5, s[28:31], s71 offen offset:0 sc1
    v_mfma_f32_16x16x32_bf16 v[28:31], a[128:131], v[164:167], v[28:31]
    v_mfma_f32_16x16x32_bf16 v[32:35], a[132:135], v[164:167], v[32:35]
    v_mfma_f32_16x16x32_bf16 v[36:39], a[136:139], v[164:167], v[36:39]
    s_waitcnt vmcnt(7)
    v_mfma_f32_16x16x32_bf16 v[20:23], a[140:143], v[168:171], v[20:23]
    v_mfma_f32_16x16x32_bf16 v[24:27], a[144:147], v[168:171], v[24:27]
    buffer_load_dwordx4 v[200:203], v5, s[28:31], s71 offen offset:1024 sc1
    v_mfma_f32_16x16x32_bf16 v[28:31], a[148:151], v[168:171], v[28:31]
    v_mfma_f32_16x16x32_bf16 v[32:35], a[152:155], v[168:171], v[32:35]
    v_mfma_f32_16x16x32_bf16 v[36:39], a[156:159], v[168:171], v[36:39]
    s_waitcnt vmcnt(7)
    v_mfma_f32_16x16x32_bf16 v[20:23], a[160:163], v[172:175], v[20:23]
    v_mfma_f32_16x16x32_bf16 v[24:27], a[164:167], v[172:175], v[24:27]
    buffer_load_dwordx4 v[204:207], v5, s[28:31], s71 offen offset:2048 sc1
    v_mfma_f32_16x16x32_bf16 v[28:31], a[168:171], v[172:175], v[28:31]
    v_mfma_f32_16x16x32_bf16 v[32:35], a[172:175], v[172:175], v[32:35]
    v_mfma_f32_16x16x32_bf16 v[36:39], a[176:179], v[172:175], v[36:39]
    s_waitcnt vmcnt(7)
    v_mfma_f32_16x16x32_bf16 v[20:23], a[180:183], v[176:179], v[20:23]
    v_mfma_f32_16x16x32_bf16 v[24:27], a[184:187], v[176:179], v[24:27]
    buffer_load_dwordx4 v[208:211], v5, s[28:31], s71 offen offset:3072 sc1
    v_mfma_f32_16x16x32_bf16 v[28:31], a[188:191], v[176:179], v[28:31]
    v_mfma_f32_16x16x32_bf16 v[32:35], a[192:195], v[176:179], v[32:35]
    v_mfma_f32_16x16x32_bf16 v[36:39], a[196:199], v[176:179], v[36:39]
    s_waitcnt vmcnt(7)
    v_mfma_f32_16x16x32_bf16 v[20:23], a[200:203], v[180:183], v[20:23]
    v_mfma_f32_16x16x32_bf16 v[24:27], a[204:207], v[180:183], v[24:27]
    s_add_u32 s71, s71, 4096
    buffer_load_dwordx4 v[140:143], v5, s[28:31], s71 offen offset:0 sc1
    v_mfma_f32_16x16x32_bf16 v[28:31], a[208:211], v[180:183], v[28:31]
    v_mfma_f32_16x16x32_bf16 v[32:35], a[212:215], v[180:183], v[32:35]
    v_mfma_f32_16x16x32_bf16 v[36:39], a[216:219], v[180:183], v[36:39]
    s_waitcnt vmcnt(7)
    v_mfma_f32_16x16x32_bf16 v[20:23], a[220:223], v[184:187], v[20:23]
    v_mfma_f32_16x16x32_bf16 v[24:27], a[224:227], v[184:187], v[24:27]
    buffer_load_dwordx4 v[144:147], v5, s[28:31], s71 offen offset:1024 sc1
    v_mfma_f32_16x16x32_bf16 v[28:31], a[228:231], v[184:187], v[28:31]
    v_mfma_f32_16x16x32_bf16 v[32:35], a[232:235], v[184:187], v[32:35]
    v_mfma_f32_16x16x32_bf16 v[36:39], a[236:239], v[184:187], v[36:39]
    s_waitcnt vmcnt(7)
    v_mfma_f32_16x16x32_bf16 v[20:23], a[240:243], v[188:191], v[20:23]
    v_mfma_f32_16x16x32_bf16 v[24:27], a[244:247], v[188:191], v[24:27]
    buffer_load_dwordx4 v[148:151], v5, s[28:31], s71 offen offset:2048 sc1
    v_mfma_f32_16x16x32_bf16 v[28:31], a[248:251], v[188:191], v[28:31]
    v_mfma_f32_16x16x32_bf16 v[32:35], a[252:255], v[188:191], v[32:35]
    v_mfma_f32_16x16x32_bf16 v[36:39], v[232:235], v[188:191], v[36:39]
    s_waitcnt vmcnt(7)
    v_mfma_f32_16x16x32_bf16 v[20:23], v[236:239], v[192:195], v[20:23]
    v_mfma_f32_16x16x32_bf16 v[24:27], v[240:243], v[192:195], v[24:27]
    buffer_load_dwordx4 v[152:155], v5, s[28:31], s71 offen offset:3072 sc1
    v_mfma_f32_16x16x32_bf16 v[28:31], v[244:247], v[192:195], v[28:31]
    v_mfma_f32_16x16x32_bf16 v[32:35], v[248:251], v[192:195], v[32:35]
    v_mfma_f32_16x16x32_bf16 v[36:39], v[252:255], v[192:195], v[36:39]
    s_waitcnt vmcnt(7)
    v_mfma_f32_16x16x32_bf16 v[40:43], a[0:3], v[196:199], 0
    v_mfma_f32_16x16x32_bf16 v[44:47], a[4:7], v[196:199], 0
    s_add_u32 s71, s71, 4096
    buffer_load_dwordx4 v[156:159], v5, s[28:31], s71 offen offset:0 sc1
    v_mfma_f32_16x16x32_bf16 v[48:51], a[8:11], v[196:199], 0
    v_mfma_f32_16x16x32_bf16 v[52:55], a[12:15], v[196:199], 0
    v_mfma_f32_16x16x32_bf16 v[56:59], a[16:19], v[196:199], 0
    s_waitcnt vmcnt(7)
    ds_write_b128 v13, v[20:23] offset:0
    v_mfma_f32_16x16x32_bf16 v[40:43], a[20:23], v[200:203], v[40:43]
    ds_write_b128 v13, v[24:27] offset:1024
    v_mfma_f32_16x16x32_bf16 v[44:47], a[24:27], v[200:203], v[44:47]
    buffer_load_dwordx4 v[160:163], v5, s[28:31], s71 offen offset:1024 sc1
    ds_write_b128 v13, v[28:31] offset:2048
    v_mfma_f32_16x16x32_bf16 v[48:51], a[28:31], v[200:203], v[48:51]
    ds_write_b128 v13, v[32:35] offset:3072
    v_mfma_f32_16x16x32_bf16 v[52:55], a[32:35], v[200:203], v[52:55]
    ds_write_b128 v13, v[36:39] offset:4096
    v_mfma_f32_16x16x32_bf16 v[56:59], a[36:39], v[200:203], v[56:59]
    s_waitcnt vmcnt(7)
    v_mfma_f32_16x16x32_bf16 v[40:43], a[40:43], v[204:207], v[40:43]
    v_mfma_f32_16x16x32_bf16 v[44:47], a[44:47], v[204:207], v[44:47]
    buffer_load_dwordx4 v[164:167], v5, s[28:31], s71 offen offset:2048 sc1
    v_mfma_f32_16x16x32_bf16 v[48:51], a[48:51], v[204:207], v[48:51]
    v_mfma_f32_16x16x32_bf16 v[52:55], a[52:55], v[204:207], v[52:55]
    v_mfma_f32_16x16x32_bf16 v[56:59], a[56:59], v[204:207], v[56:59]
    s_waitcnt vmcnt(7)
    v_mfma_f32_16x16x32_bf16 v[40:43], a[60:63], v[208:211], v[40:43]
    v_mfma_f32_16x16x32_bf16 v[44:47], a[64:67], v[208:211], v[44:47]
    buffer_load_dwordx4 v[168:171], v5, s[28:31], s71 offen offset:3072 sc1
    v_mfma_f32_16x16x32_bf16 v[48:51], a[68:71], v[208:211], v[48:51]
    v_mfma_f32_16x16x32_bf16 v[52:55], a[72:75], v[208:211], v[52:55]
    v_mfma_f32_16x16x32_bf16 v[56:59], a[76:79], v[208:211], v[56:59]
    s_waitcnt vmcnt(7)
    v_mfma_f32_16x16x32_bf16 v[40:43], a[80:83], v[140:143], v[40:43]
    v_mfma_f32_16x16x32_bf16 v[44:47], a[84:87], v[140:143], v[44:47]
    s_add_u32 s71, s71, 4096
    buffer_load_dwordx4 v[172:175], v6, s[28:31], s71 offen offset:0 sc1
    v_mfma_f32_16x16x32_bf16 v[48:51], a[88:91], v[140:143], v[48:51]
    v_mfma_f32_16x16x32_bf16 v[52:55], a[92:95], v[140:143], v[52:55]
    v_mfma_f32_16x16x32_bf16 v[56:59], a[96:99], v[140:143], v[56:59]
    s_waitcnt vmcnt(7)
    v_mfma_f32_16x16x32_bf16 v[40:43], a[100:103], v[144:147], v[40:43]
    v_mfma_f32_16x16x32_bf16 v[44:47], a[104:107], v[144:147], v[44:47]
    buffer_load_dwordx4 v[176:179], v6, s[28:31], s71 offen offset:1024 sc1
    v_mfma_f32_16x16x32_bf16 v[48:51], a[108:111], v[144:147], v[48:51]
    v_mfma_f32_16x16x32_bf16 v[52:55], a[112:115], v[144:147], v[52:55]
    v_mfma_f32_16x16x32_bf16 v[56:59], a[116:119], v[144:147], v[56:59]
    s_waitcnt vmcnt(7)
    v_mfma_f32_16x16x32_bf16 v[40:43], a[120:123], v[148:151], v[40:43]
    v_mfma_f32_16x16x32_bf16 v[44:47], a[124:127], v[148:151], v[44:47]
    buffer_load_dwordx4 v[180:183], v5, s[28:31], s72 offen offset:0 sc1
    v_mfma_f32_16x16x32_bf16 v[48:51], a[128:131], v[148:151], v[48:51]
    v_mfma_f32_16x16x32_bf16 v[52:55], a[132:135], v[148:151], v[52:55]
    v_mfma_f32_16x16x32_bf16 v[56:59], a[136:139], v[148:151], v[56:59]
    s_waitcnt vmcnt(7)
    v_mfma_f32_16x16x32_bf16 v[40:43], a[140:143], v[152:155], v[40:43]
    v_mfma_f32_16x16x32_bf16 v[44:47], a[144:147], v[152:155], v[44:47]
    buffer_load_dwordx4 v[184:187], v5, s[28:31], s72 offen offset:1024 sc1
    v_mfma_f32_16x16x32_bf16 v[48:51], a[148:151], v[152:155], v[48:51]
    v_mfma_f32_16x16x32_bf16 v[52:55], a[152:155], v[152:155], v[52:55]
    v_mfma_f32_16x16x32_bf16 v[56:59], a[156:159], v[152:155], v[56:59]
    s_waitcnt vmcnt(7)
    v_mfma_f32_16x16x32_bf16 v[40:43], a[160:163], v[156:159], v[40:43]
    v_mfma_f32_16x16x32_bf16 v[44:47], a[164:167], v[156:159], v[44:47]
    buffer_load_dwordx4 v[188:191], v5, s[28:31], s72 offen offset:2048 sc1
    v_mfma_f32_16x16x32_bf16 v[48:51], a[168:171], v[156:159], v[48:51]
    v_mfma_f32_16x16x32_bf16 v[52:55], a[172:175], v[156:159], v[52:55]
    v_mfma_f32_16x16x32_bf16 v[56:59], a[176:179], v[156:159], v[56:59]
    s_waitcnt vmcnt(7)
    v_mfma_f32_16x16x32_bf16 v[40:43], a[180:183], v[160:163], v[40:43]
    v_mfma_f32_16x16x32_bf16 v[44:47], a[184:187], v[160:163], v[44:47]
    buffer_load_dwordx4 v[192:195], v5, s[28:31], s72 offen offset:3072 sc1
    v_mfma_f32_16x16x32_bf16 v[48:51], a[188:191], v[160:163], v[48:51]
    v_mfma_f32_16x16x32_bf16 v[52:55], a[192:195], v[160:163], v[52:55]
    v_mfma_f32_16x16x32_bf16 v[56:59], a[196:199], v[160:163], v[56:59]
    s_waitcnt vmcnt(7)
    v_mfma_f32_16x16x32_bf16 v[40:43], a[200:203], v[164:167], v[40:43]
    v_mfma_f32_16x16x32_bf16 v[44:47], a[204:207], v[164:167], v[44:47]
    s_add_u32 s72, s72, 4096
    buffer_load_dwordx4 v[196:199], v5, s[28:31], s72 offen offset:0 sc1
    v_mfma_f32_16x16x32_bf16 v[48:51], a[208:211], v[164:167], v[48:51]
    v_mfma_f32_16x16x32_bf16 v[52:55], a[212:215], v[164:167], v[52:55]
    v_mfma_f32_16x16x32_bf16 v[56:59], a[216:219], v[164:167], v[56:59]
    s_waitcnt vmcnt(7)
    v_mfma_f32_16x16x32_bf16 v[40:43], a[220:223], v[168:171], v[40:43]
    v_mfma_f32_16x16x32_bf16 v[44:47], a[224:227], v[168:171], v[44:47]
    buffer_load_dwordx4 v[200:203], v5, s[28:31], s72 offen offset:1024 sc1
    v_mfma_f32_16x16x32_bf16 v[48:51], a[228:231], v[168:171], v[48:51]
    v_mfma_f32_16x16x32_bf16 v[52:55], a[232:235], v[168:171], v[52:55]
    v_mfma_f32_16x16x32_bf16 v[56:59], a[236:239], v[168:171], v[56:59]
    s_waitcnt vmcnt(7)
    v_mfma_f32_16x16x32_bf16 v[40:43], a[240:243], v[172:175], v[40:43]
    v_mfma_f32_16x16x32_bf16 v[44:47], a[244:247], v[172:175], v[44:47]
    buffer_load_dwordx4 v[204:207], v5, s[28:31], s72 offen offset:2048 sc1
    v_mfma_f32_16x16x32_bf16 v[48:51], a[248:251], v[172:175], v[48:51]
    v_mfma_f32_16x16x32_bf16 v[52:55], a[252:255], v[172:175], v[52:55]
    v_mfma_f32_16x16x32_bf16 v[56:59], v[232:235], v[172:175], v[56:59]
    s_waitcnt vmcnt(7)
    v_mfma_f32_16x16x32_bf16 v[40:43], v[236:239], v[176:179], v[40:43]
    v_mfma_f32_16x16x32_bf16 v[44:47], v[240:243], v[176:179], v[44:47]
    buffer_load_dwordx4 v[208:211], v5, s[28:31], s72 offen offset:3072 sc1
    v_mfma_f32_16x16x32_bf16 v[48:51], v[244:247], v[176:179], v[48:51]
    v_mfma_f32_16x16x32_bf16 v[52:55], v[248:251], v[176:179], v[52:55]
    v_mfma_f32_16x16x32_bf16 v[56:59], v[252:255], v[176:179], v[56:59]
    s_waitcnt vmcnt(7)
    v_mfma_f32_16x16x32_bf16 v[20:23], a[0:3], v[180:183], 0
    v_mfma_f32_16x16x32_bf16 v[24:27], a[4:7], v[180:183], 0
    s_add_u32 s72, s72, 4096
    buffer_load_dwordx4 v[140:143], v5, s[28:31], s72 offen offset:0 sc1
    v_mfma_f32_16x16x32_bf16 v[28:31], a[8:11], v[180:183], 0
    v_mfma_f32_16x16x32_bf16 v[32:35], a[12:15], v[180:183], 0
    v_mfma_f32_16x16x32_bf16 v[36:39], a[16:19], v[180:183], 0
    s_waitcnt vmcnt(7)
    ds_write_b128 v14, v[40:43] offset:0
    v_mfma_f32_16x16x32_bf16 v[20:23], a[20:23], v[184:187], v[20:23]
    ds_write_b128 v14, v[44:47] offset:1024
    v_mfma_f32_16x16x32_bf16 v[24:27], a[24:27], v[184:187], v[24:27]
    buffer_load_dwordx4 v[144:147], v5, s[28:31], s72 offen offset:1024 sc1
    ds_write_b128 v14, v[48:51] offset:2048
    v_mfma_f32_16x16x32_bf16 v[28:31], a[28:31], v[184:187], v[28:31]
    ds_write_b128 v14, v[52:55] offset:3072
    v_mfma_f32_16x16x32_bf16 v[32:35], a[32:35], v[184:187], v[32:35]
    ds_write_b128 v14, v[56:59] offset:4096
    v_mfma_f32_16x16x32_bf16 v[36:39], a[36:39], v[184:187], v[36:39]
    s_waitcnt vmcnt(7)
    v_mfma_f32_16x16x32_bf16 v[20:23], a[40:43], v[188:191], v[20:23]
    v_mfma_f32_16x16x32_bf16 v[24:27], a[44:47], v[188:191], v[24:27]
    buffer_load_dwordx4 v[148:151], v5, s[28:31], s72 offen offset:2048 sc1
    v_mfma_f32_16x16x32_bf16 v[28:31], a[48:51], v[188:191], v[28:31]
    v_mfma_f32_16x16x32_bf16 v[32:35], a[52:55], v[188:191], v[32:35]
    v_mfma_f32_16x16x32_bf16 v[36:39], a[56:59], v[188:191], v[36:39]
    s_waitcnt vmcnt(7)
    v_mfma_f32_16x16x32_bf16 v[20:23], a[60:63], v[192:195], v[20:23]
    v_mfma_f32_16x16x32_bf16 v[24:27], a[64:67], v[192:195], v[24:27]
    buffer_load_dwordx4 v[152:155], v5, s[28:31], s72 offen offset:3072 sc1
    v_mfma_f32_16x16x32_bf16 v[28:31], a[68:71], v[192:195], v[28:31]
    v_mfma_f32_16x16x32_bf16 v[32:35], a[72:75], v[192:195], v[32:35]
    v_mfma_f32_16x16x32_bf16 v[36:39], a[76:79], v[192:195], v[36:39]
    s_waitcnt vmcnt(7)
    v_mfma_f32_16x16x32_bf16 v[20:23], a[80:83], v[196:199], v[20:23]
    v_mfma_f32_16x16x32_bf16 v[24:27], a[84:87], v[196:199], v[24:27]
    s_add_u32 s72, s72, 4096
    buffer_load_dwordx4 v[156:159], v6, s[28:31], s72 offen offset:0 sc1
    v_mfma_f32_16x16x32_bf16 v[28:31], a[88:91], v[196:199], v[28:31]
    v_mfma_f32_16x16x32_bf16 v[32:35], a[92:95], v[196:199], v[32:35]
    v_mfma_f32_16x16x32_bf16 v[36:39], a[96:99], v[196:199], v[36:39]
    s_waitcnt vmcnt(7)
    v_mfma_f32_16x16x32_bf16 v[20:23], a[100:103], v[200:203], v[20:23]
    v_mfma_f32_16x16x32_bf16 v[24:27], a[104:107], v[200:203], v[24:27]
    buffer_load_dwordx4 v[160:163], v6, s[28:31], s72 offen offset:1024 sc1
    v_mfma_f32_16x16x32_bf16 v[28:31], a[108:111], v[200:203], v[28:31]
    v_mfma_f32_16x16x32_bf16 v[32:35], a[112:115], v[200:203], v[32:35]
    v_mfma_f32_16x16x32_bf16 v[36:39], a[116:119], v[200:203], v[36:39]
    s_waitcnt vmcnt(7)
    v_mfma_f32_16x16x32_bf16 v[20:23], a[120:123], v[204:207], v[20:23]
    v_mfma_f32_16x16x32_bf16 v[24:27], a[124:127], v[204:207], v[24:27]
    buffer_load_dwordx4 v[164:167], v5, s[28:31], s73 offen offset:0 sc1
    v_mfma_f32_16x16x32_bf16 v[28:31], a[128:131], v[204:207], v[28:31]
    v_mfma_f32_16x16x32_bf16 v[32:35], a[132:135], v[204:207], v[32:35]
    v_mfma_f32_16x16x32_bf16 v[36:39], a[136:139], v[204:207], v[36:39]
    s_waitcnt vmcnt(7)
    v_mfma_f32_16x16x32_bf16 v[20:23], a[140:143], v[208:211], v[20:23]
    v_mfma_f32_16x16x32_bf16 v[24:27], a[144:147], v[208:211], v[24:27]
    buffer_load_dwordx4 v[168:171], v5, s[28:31], s73 offen offset:1024 sc1
    v_mfma_f32_16x16x32_bf16 v[28:31], a[148:151], v[208:211], v[28:31]
    v_mfma_f32_16x16x32_bf16 v[32:35], a[152:155], v[208:211], v[32:35]
    v_mfma_f32_16x16x32_bf16 v[36:39], a[156:159], v[208:211], v[36:39]
    s_waitcnt vmcnt(7)
    v_mfma_f32_16x16x32_bf16 v[20:23], a[160:163], v[140:143], v[20:23]
    v_mfma_f32_16x16x32_bf16 v[24:27], a[164:167], v[140:143], v[24:27]
    buffer_load_dwordx4 v[172:175], v5, s[28:31], s73 offen offset:2048 sc1
    v_mfma_f32_16x16x32_bf16 v[28:31], a[168:171], v[140:143], v[28:31]
    v_mfma_f32_16x16x32_bf16 v[32:35], a[172:175], v[140:143], v[32:35]
    v_mfma_f32_16x16x32_bf16 v[36:39], a[176:179], v[140:143], v[36:39]
    s_waitcnt vmcnt(7)
    v_mfma_f32_16x16x32_bf16 v[20:23], a[180:183], v[144:147], v[20:23]
    v_mfma_f32_16x16x32_bf16 v[24:27], a[184:187], v[144:147], v[24:27]
    buffer_load_dwordx4 v[176:179], v5, s[28:31], s73 offen offset:3072 sc1
    v_mfma_f32_16x16x32_bf16 v[28:31], a[188:191], v[144:147], v[28:31]
    v_mfma_f32_16x16x32_bf16 v[32:35], a[192:195], v[144:147], v[32:35]
    v_mfma_f32_16x16x32_bf16 v[36:39], a[196:199], v[144:147], v[36:39]
    s_waitcnt vmcnt(7)
    v_mfma_f32_16x16x32_bf16 v[20:23], a[200:203], v[148:151], v[20:23]
    v_mfma_f32_16x16x32_bf16 v[24:27], a[204:207], v[148:151], v[24:27]
    s_add_u32 s73, s73, 4096
    buffer_load_dwordx4 v[180:183], v5, s[28:31], s73 offen offset:0 sc1
    v_mfma_f32_16x16x32_bf16 v[28:31], a[208:211], v[148:151], v[28:31]
    v_mfma_f32_16x16x32_bf16 v[32:35], a[212:215], v[148:151], v[32:35]
    v_mfma_f32_16x16x32_bf16 v[36:39], a[216:219], v[148:151], v[36:39]
    s_waitcnt vmcnt(7)
    v_mfma_f32_16x16x32_bf16 v[20:23], a[220:223], v[152:155], v[20:23]
    v_mfma_f32_16x16x32_bf16 v[24:27], a[224:227], v[152:155], v[24:27]
    buffer_load_dwordx4 v[184:187], v5, s[28:31], s73 offen offset:1024 sc1
    v_mfma_f32_16x16x32_bf16 v[28:31], a[228:231], v[152:155], v[28:31]
    v_mfma_f32_16x16x32_bf16 v[32:35], a[232:235], v[152:155], v[32:35]
    v_mfma_f32_16x16x32_bf16 v[36:39], a[236:239], v[152:155], v[36:39]
    s_waitcnt vmcnt(7)
    v_mfma_f32_16x16x32_bf16 v[20:23], a[240:243], v[156:159], v[20:23]
    v_mfma_f32_16x16x32_bf16 v[24:27], a[244:247], v[156:159], v[24:27]
    buffer_load_dwordx4 v[188:191], v5, s[28:31], s73 offen offset:2048 sc1
    v_mfma_f32_16x16x32_bf16 v[28:31], a[248:251], v[156:159], v[28:31]
    v_mfma_f32_16x16x32_bf16 v[32:35], a[252:255], v[156:159], v[32:35]
    v_mfma_f32_16x16x32_bf16 v[36:39], v[232:235], v[156:159], v[36:39]
    s_waitcnt vmcnt(7)
    v_mfma_f32_16x16x32_bf16 v[20:23], v[236:239], v[160:163], v[20:23]
    v_mfma_f32_16x16x32_bf16 v[24:27], v[240:243], v[160:163], v[24:27]
    buffer_load_dwordx4 v[192:195], v5, s[28:31], s73 offen offset:3072 sc1
    v_mfma_f32_16x16x32_bf16 v[28:31], v[244:247], v[160:163], v[28:31]
    v_mfma_f32_16x16x32_bf16 v[32:35], v[248:251], v[160:163], v[32:35]
    v_mfma_f32_16x16x32_bf16 v[36:39], v[252:255], v[160:163], v[36:39]
    s_waitcnt vmcnt(7)
    v_mfma_f32_16x16x32_bf16 v[40:43], a[0:3], v[164:167], 0
    v_mfma_f32_16x16x32_bf16 v[44:47], a[4:7], v[164:167], 0
    s_add_u32 s73, s73, 4096
    buffer_load_dwordx4 v[196:199], v5, s[28:31], s73 offen offset:0 sc1
    v_mfma_f32_16x16x32_bf16 v[48:51], a[8:11], v[164:167], 0
    v_mfma_f32_16x16x32_bf16 v[52:55], a[12:15], v[164:167], 0
    v_mfma_f32_16x16x32_bf16 v[56:59], a[16:19], v[164:167], 0
    s_waitcnt vmcnt(7)
    ds_write_b128 v15, v[20:23] offset:0
    v_mfma_f32_16x16x32_bf16 v[40:43], a[20:23], v[168:171], v[40:43]
    ds_write_b128 v15, v[24:27] offset:1024
    v_mfma_f32_16x16x32_bf16 v[44:47], a[24:27], v[168:171], v[44:47]
    buffer_load_dwordx4 v[200:203], v5, s[28:31], s73 offen offset:1024 sc1
    ds_write_b128 v15, v[28:31] offset:2048
    v_mfma_f32_16x16x32_bf16 v[48:51], a[28:31], v[168:171], v[48:51]
    ds_write_b128 v15, v[32:35] offset:3072
    v_mfma_f32_16x16x32_bf16 v[52:55], a[32:35], v[168:171], v[52:55]
    ds_write_b128 v15, v[36:39] offset:4096
    v_mfma_f32_16x16x32_bf16 v[56:59], a[36:39], v[168:171], v[56:59]
    s_waitcnt vmcnt(7)
    v_mfma_f32_16x16x32_bf16 v[40:43], a[40:43], v[172:175], v[40:43]
    v_mfma_f32_16x16x32_bf16 v[44:47], a[44:47], v[172:175], v[44:47]
    buffer_load_dwordx4 v[204:207], v5, s[28:31], s73 offen offset:2048 sc1
    s_waitcnt lgkmcnt(0)
    v_mfma_f32_16x16x32_bf16 v[48:51], a[48:51], v[172:175], v[48:51]
    s_barrier
    v_mfma_f32_16x16x32_bf16 v[52:55], a[52:55], v[172:175], v[52:55]
    ds_read_b128 v[60:63], v16 offset:0
    ds_read_b128 v[64:67], v16 offset:1024
    v_mfma_f32_16x16x32_bf16 v[56:59], a[56:59], v[172:175], v[56:59]
    s_waitcnt vmcnt(7)
    ds_read_b128 v[68:71], v16 offset:2048
    ds_read_b128 v[72:75], v16 offset:3072
    v_mfma_f32_16x16x32_bf16 v[40:43], a[60:63], v[176:179], v[40:43]
    ds_read_b128 v[76:79], v16 offset:4096
    ds_read_b128 v[80:83], v16 offset:5120
    v_mfma_f32_16x16x32_bf16 v[44:47], a[64:67], v[176:179], v[44:47]
    buffer_load_dwordx4 v[208:211], v5, s[28:31], s73 offen offset:3072 sc1
    ds_read_b128 v[84:87], v16 offset:6144
    ds_read_b128 v[88:91], v16 offset:7168
    v_mfma_f32_16x16x32_bf16 v[48:51], a[68:71], v[176:179], v[48:51]
    ds_read_b128 v[92:95], v16 offset:8192
    ds_read_b128 v[96:99], v16 offset:9216
    v_mfma_f32_16x16x32_bf16 v[52:55], a[72:75], v[176:179], v[52:55]
    ds_read_b128 v[100:103], v18 offset:0
    ds_read_b128 v[104:107], v18 offset:1024
    v_mfma_f32_16x16x32_bf16 v[56:59], a[76:79], v[176:179], v[56:59]
    s_waitcnt vmcnt(7)
    ds_read_b128 v[108:111], v18 offset:2048
    ds_read_b128 v[112:115], v18 offset:3072
    v_mfma_f32_16x16x32_bf16 v[40:43], a[80:83], v[180:183], v[40:43]
    ds_read_b128 v[116:119], v18 offset:4096
    v_mfma_f32_16x16x32_bf16 v[44:47], a[84:87], v[180:183], v[44:47]
    s_add_u32 s73, s73, 4096
    buffer_load_dwordx4 v[140:143], v6, s[28:31], s73 offen offset:0 sc1
    v_mfma_f32_16x16x32_bf16 v[48:51], a[88:91], v[180:183], v[48:51]
    v_mfma_f32_16x16x32_bf16 v[52:55], a[92:95], v[180:183], v[52:55]
    v_mfma_f32_16x16x32_bf16 v[56:59], a[96:99], v[180:183], v[56:59]
    s_waitcnt vmcnt(7)
    s_waitcnt lgkmcnt(10)
    v_mfma_f32_16x16x32_bf16 v[40:43], a[100:103], v[184:187], v[40:43]
    v_add_f32 v120, v120, v60
    v_add_f32 v121, v121, v61
    v_mfma_f32_16x16x32_bf16 v[44:47], a[104:107], v[184:187], v[44:47]
    buffer_load_dwordx4 v[144:147], v6, s[28:31], s73 offen offset:1024 sc1
    v_add_f32 v122, v122, v62
    v_add_f32 v123, v123, v63
    v_mfma_f32_16x16x32_bf16 v[48:51], a[108:111], v[184:187], v[48:51]
    v_add_f32 v124, v124, v64
    v_add_f32 v125, v125, v65
    v_mfma_f32_16x16x32_bf16 v[52:55], a[112:115], v[184:187], v[52:55]
    v_add_f32 v126, v126, v66
    v_add_f32 v127, v127, v67
    v_mfma_f32_16x16x32_bf16 v[56:59], a[116:119], v[184:187], v[56:59]
    s_waitcnt vmcnt(7)
    v_add_f32 v128, v128, v68
    v_add_f32_e64 v129, v129, v69
    v_mfma_f32_16x16x32_bf16 v[40:43], a[120:123], v[188:191], v[40:43]
    v_add_f32 v130, v130, v70
    v_add_f32 v131, v131, v71
    v_mfma_f32_16x16x32_bf16 v[44:47], a[124:127], v[188:191], v[44:47]
    v_add_f32 v132, v132, v72
    v_add_f32 v133, v133, v73
    v_mfma_f32_16x16x32_bf16 v[48:51], a[128:131], v[188:191], v[48:51]
    v_add_f32 v134, v134, v74
    v_add_f32 v135, v135, v75
    v_mfma_f32_16x16x32_bf16 v[52:55], a[132:135], v[188:191], v[52:55]
    v_add_f32 v136, v136, v76
    v_add_f32 v137, v137, v77
    v_mfma_f32_16x16x32_bf16 v[56:59], a[136:139], v[188:191], v[56:59]
    s_waitcnt vmcnt(6)
    v_add_f32 v138, v138, v78
    v_add_f32_e64 v139, v139, v79
    v_mfma_f32_16x16x32_bf16 v[40:43], a[140:143], v[192:195], v[40:43]
    s_waitcnt lgkmcnt(5)
    v_mfma_f32_16x16x32_bf16 v[44:47], a[144:147], v[192:195], v[44:47]
    v_add_f32 v120, v120, v80
    v_add_f32_e64 v121, v121, v81
    v_mfma_f32_16x16x32_bf16 v[48:51], a[148:151], v[192:195], v[48:51]
    v_add_f32 v122, v122, v82
    v_add_f32 v123, v123, v83
    v_mfma_f32_16x16x32_bf16 v[52:55], a[152:155], v[192:195], v[52:55]
    v_add_f32 v124, v124, v84
    v_add_f32 v125, v125, v85
    v_mfma_f32_16x16x32_bf16 v[56:59], a[156:159], v[192:195], v[56:59]
    s_waitcnt vmcnt(5)
    v_add_f32 v126, v126, v86
    v_add_f32_e64 v127, v127, v87
    v_mfma_f32_16x16x32_bf16 v[40:43], a[160:163], v[196:199], v[40:43]
    v_add_f32 v128, v128, v88
    v_add_f32 v129, v129, v89
    v_mfma_f32_16x16x32_bf16 v[44:47], a[164:167], v[196:199], v[44:47]
    v_add_f32 v130, v130, v90
    v_add_f32 v131, v131, v91
    v_mfma_f32_16x16x32_bf16 v[48:51], a[168:171], v[196:199], v[48:51]
    v_add_f32 v132, v132, v92
    v_add_f32 v133, v133, v93
    v_mfma_f32_16x16x32_bf16 v[52:55], a[172:175], v[196:199], v[52:55]
    v_add_f32 v134, v134, v94
    v_add_f32 v135, v135, v95
    v_mfma_f32_16x16x32_bf16 v[56:59], a[176:179], v[196:199], v[56:59]
    s_waitcnt vmcnt(4)
    v_add_f32 v136, v136, v96
    v_add_f32_e64 v137, v137, v97
    v_mfma_f32_16x16x32_bf16 v[40:43], a[180:183], v[200:203], v[40:43]
    v_add_f32 v138, v138, v98
    v_add_f32 v139, v139, v99
    v_mfma_f32_16x16x32_bf16 v[44:47], a[184:187], v[200:203], v[44:47]
    s_waitcnt lgkmcnt(0)
    v_mfma_f32_16x16x32_bf16 v[48:51], a[188:191], v[200:203], v[48:51]
    v_add_f32 v120, v120, v100
    v_add_f32_e64 v121, v121, v101
    v_mfma_f32_16x16x32_bf16 v[52:55], a[192:195], v[200:203], v[52:55]
    v_add_f32 v122, v122, v102
    v_add_f32 v123, v123, v103
    v_mfma_f32_16x16x32_bf16 v[56:59], a[196:199], v[200:203], v[56:59]
    s_waitcnt vmcnt(3)
    v_add_f32 v124, v124, v104
    v_add_f32_e64 v125, v125, v105
    v_mfma_f32_16x16x32_bf16 v[40:43], a[200:203], v[204:207], v[40:43]
    v_add_f32 v126, v126, v106
    v_add_f32 v127, v127, v107
    v_mfma_f32_16x16x32_bf16 v[44:47], a[204:207], v[204:207], v[44:47]
    v_add_f32 v128, v128, v108
    v_add_f32 v129, v129, v109
    v_mfma_f32_16x16x32_bf16 v[48:51], a[208:211], v[204:207], v[48:51]
    v_add_f32 v130, v130, v110
    v_add_f32 v131, v131, v111
    v_mfma_f32_16x16x32_bf16 v[52:55], a[212:215], v[204:207], v[52:55]
    v_add_f32 v132, v132, v112
    v_add_f32 v133, v133, v113
    v_mfma_f32_16x16x32_bf16 v[56:59], a[216:219], v[204:207], v[56:59]
    s_waitcnt vmcnt(2)
    v_add_f32 v134, v134, v114
    v_add_f32_e64 v135, v135, v115
    v_mfma_f32_16x16x32_bf16 v[40:43], a[220:223], v[208:211], v[40:43]
    v_add_f32 v136, v136, v116
    v_add_f32 v137, v137, v117
    v_mfma_f32_16x16x32_bf16 v[44:47], a[224:227], v[208:211], v[44:47]
    v_add_f32 v138, v138, v118
    v_add_f32 v139, v139, v119
    v_mfma_f32_16x16x32_bf16 v[48:51], a[228:231], v[208:211], v[48:51]
    v_mfma_f32_16x16x32_bf16 v[52:55], a[232:235], v[208:211], v[52:55]
    v_mfma_f32_16x16x32_bf16 v[56:59], a[236:239], v[208:211], v[56:59]
    s_waitcnt vmcnt(1)
    v_mfma_f32_16x16x32_bf16 v[40:43], a[240:243], v[140:143], v[40:43]
    v_mfma_f32_16x16x32_bf16 v[44:47], a[244:247], v[140:143], v[44:47]
    v_mfma_f32_16x16x32_bf16 v[48:51], a[248:251], v[140:143], v[48:51]
    v_mfma_f32_16x16x32_bf16 v[52:55], a[252:255], v[140:143], v[52:55]
    v_mfma_f32_16x16x32_bf16 v[56:59], v[232:235], v[140:143], v[56:59]
    s_waitcnt vmcnt(0)
    v_mfma_f32_16x16x32_bf16 v[40:43], v[236:239], v[144:147], v[40:43]
    v_mfma_f32_16x16x32_bf16 v[44:47], v[240:243], v[144:147], v[44:47]
    v_mfma_f32_16x16x32_bf16 v[48:51], v[244:247], v[144:147], v[48:51]
    v_mfma_f32_16x16x32_bf16 v[52:55], v[248:251], v[144:147], v[52:55]
    v_mfma_f32_16x16x32_bf16 v[56:59], v[252:255], v[144:147], v[56:59]
    s_nop 3
    v_pk_add_f32 v[40:41], v[40:41], v[120:121]
    v_pk_add_f32 v[42:43], v[42:43], v[122:123]
    v_pk_add_f32 v[44:45], v[44:45], v[124:125]
    v_pk_add_f32 v[46:47], v[46:47], v[126:127]
    v_pk_add_f32 v[48:49], v[48:49], v[128:129]
    v_pk_add_f32 v[50:51], v[50:51], v[130:131]
    v_pk_add_f32 v[52:53], v[52:53], v[132:133]
    v_pk_add_f32 v[54:55], v[54:55], v[134:135]
    v_pk_add_f32 v[56:57], v[56:57], v[136:137]
    v_pk_add_f32 v[58:59], v[58:59], v[138:139]
    v_cvt_pk_bf16_f32 v212, v40, v41
    v_cvt_pk_bf16_f32 v213, v42, v43
    v_cvt_pk_bf16_f32 v214, v44, v45
    v_cvt_pk_bf16_f32 v215, v46, v47
    v_cvt_pk_bf16_f32 v216, v48, v49
    v_cvt_pk_bf16_f32 v217, v50, v51
    v_cvt_pk_bf16_f32 v218, v52, v53
    v_cvt_pk_bf16_f32 v219, v54, v55
    v_cvt_pk_bf16_f32 v220, v56, v57
    v_cvt_pk_bf16_f32 v221, v58, v59
    ds_write_b128 v7, v[212:215]
    ds_write_b128 v7, v[216:219] offset:64
    ds_write_b64 v8, v[220:221] offset:128
    ds_read_b128 v[20:23], v9
    ds_read_b128 v[24:27], v9 offset:1408
    ds_read_b64 v[28:29], v10 offset:128
    s_waitcnt lgkmcnt(2)
    buffer_store_dwordx4 v[20:23], v11, s[24:27], s37 offen
    s_waitcnt lgkmcnt(1)
    buffer_store_dwordx4 v[24:27], v11, s[24:27], s39 offen
    s_waitcnt lgkmcnt(0)
    buffer_store_dwordx2 v[28:29], v12, s[24:27], s38 offen
K2_END:
    s_endpgm
HOT_END:
BT_4w:
    s_mov_b32 s36, 0x100000
BT_4x:
    s_sleep 8
    global_load_dwordx2 v[22:23], v21, s[80:81] sc1
    s_sub_u32 s36, s36, 1
    s_cbranch_scc1 BT_4r
    s_waitcnt vmcnt(0)
    v_and_b32 v173, v23, v175
    v_cmp_ne_u32 vcc, v173, v175
    s_nop 3
    s_cbranch_vccnz BT_4x
    s_branch BT_4r
BT_5w:
    s_mov_b32 s36, 0x100000
BT_5x:
    s_sleep 8
    global_load_dwordx2 v[22:23], v21, s[80:81] sc1
    s_sub_u32 s36, s36, 1
    s_cbranch_scc1 BT_5r
    s_waitcnt vmcnt(0)
    v_and_b32_e64 v173, v23, v175
    v_cmp_ne_u32 vcc, v173, v175
    s_nop 3
    s_cbranch_vccnz BT_5x
    s_branch BT_5r
K2_SS0:
    buffer_wbl2 sc1
    s_waitcnt vmcnt(0)
    buffer_store_byte v2, v3, s[28:31], s59 offen offset:0 sc1
    s_branch K2_SR0
BT_6w:
    s_mov_b32 s36, 0x100000
BT_6x:
    s_sleep 8
    global_load_dwordx2 v[22:23], v21, s[80:81] sc1
    s_sub_u32 s36, s36, 1
    s_cbranch_scc1 BT_6r
    s_waitcnt vmcnt(0)
    v_and_b32_e64 v173, v23, v175
    v_cmp_ne_u32 vcc, v173, v175
    s_nop 3
    s_cbranch_vccnz BT_6x
    s_branch BT_6r
BT_7w:
    s_mov_b32 s36, 0x100000
BT_7x:
    s_sleep 8
    global_load_dwordx2 v[22:23], v21, s[80:81] sc1
    s_sub_u32 s36, s36, 1
    s_cbranch_scc1 BT_7r
    s_waitcnt vmcnt(0)
    v_and_b32_e64 v173, v23, v175
    v_cmp_ne_u32 vcc, v173, v175
    s_nop 3
    s_cbranch_vccnz BT_7x
    s_branch BT_7r
PL_9a:
    buffer_inv sc1
    s_waitcnt vmcnt(0)
    s_branch PL_9x
K2_SS1:
    buffer_wbl2 sc1
    s_waitcnt vmcnt(0)
    buffer_store_byte v2, v3, s[28:31], s59 offen offset:0 sc1
    s_branch K2_SR1
PL_10a:
    buffer_inv sc1
    s_waitcnt vmcnt(0)
    s_branch PL_10x
KV_SL:
    s_mov_b32 s61, 0x100000
KV_PL:
    s_sleep 6
    buffer_load_dword v24, v26, s[28:31], s62 offen sc1
    s_sub_u32 s61, s61, 1
    s_cbranch_scc1 KV_PY
    s_waitcnt vmcnt(0)
    v_cmp_eq_u32 vcc, 0, v24
    s_nop 3
    s_cbranch_vccnz KV_PL
    s_branch KV_PY
K2_PWa:
    s_mov_b32 s36, 0x100000
K2_PVa:
    s_sleep 4
    buffer_load_dword v240, v118, s[28:31], 0 offen sc1
    s_sub_u32 s36, s36, 1
    s_cbranch_scc1 K2_PRa
    s_waitcnt vmcnt(0)
    v_cmp_ne_u32 vcc, 64, v240
    s_nop 3
    s_cbranch_vccnz K2_PVa
    s_branch K2_PRa
K2_PWb:
    s_mov_b32 s36, 0x100000
K2_PVb:
    s_sleep 4
    buffer_load_dword v240, v118, s[28:31], 0 offen sc1
    s_sub_u32 s36, s36, 1
    s_cbranch_scc1 K2_PRb
    s_waitcnt vmcnt(0)
    v_cmp_ne_u32 vcc, 64, v240
    s_nop 3
    s_cbranch_vccnz K2_PVb
    s_branch K2_PRb
CH_1:
    ds_read_b32 v249, v246 offset:3072
    ds_read_b128 v[80:83], v246 offset:0
    ds_read_b128 v[84:87], v246 offset:1024
    ds_read_b128 v[88:91], v246 offset:2048
    s_waitcnt lgkmcnt(0)
    v_cmp_ne_u32 vcc, v249, v5
    s_nop 3
    s_cbranch_vccnz CH_1
    s_branch CR_1
CH_2:
    ds_read_b32 v249, v246 offset:7168
    ds_read_b128 v[80:83], v246 offset:4096
    ds_read_b128 v[84:87], v246 offset:5120
    ds_read_b128 v[88:91], v246 offset:6144
    s_waitcnt lgkmcnt(0)
    v_cmp_ne_u32 vcc, v249, v5
    s_nop 3
    s_cbranch_vccnz CH_2
    s_branch CR_2
CH_3:
    ds_read_b32 v249, v247 offset:3072
    ds_read_b128 v[80:83], v247 offset:0
    ds_read_b128 v[84:87], v247 offset:1024
    ds_read_b128 v[88:91], v247 offset:2048
    s_waitcnt lgkmcnt(0)
    v_cmp_ne_u32 vcc, v249, v7
    s_nop 3
    s_cbranch_vccnz CH_3
    s_branch CR_3
CH_4:
    ds_read_b32 v249, v247 offset:7168
    ds_read_b128 v[80:83], v247 offset:4096
    ds_read_b128 v[84:87], v247 offset:5120
    ds_read_b128 v[88:91], v247 offset:6144
    s_waitcnt lgkmcnt(0)
    v_cmp_ne_u32 vcc, v249, v7
    s_nop 3
    s_cbranch_vccnz CH_4
    s_branch CR_4
CH_5:
    ds_read_b32 v249, v248 offset:3072
    ds_read_b128 v[80:83], v248 offset:0
    ds_read_b128 v[84:87], v248 offset:1024
    ds_read_b128 v[88:91], v248 offset:2048
    s_waitcnt lgkmcnt(0)
    v_cmp_ne_u32 vcc, v249, v10
    s_nop 3
    s_cbranch_vccnz CH_5
    s_branch CR_5
CH_6:
    ds_read_b32 v249, v248 offset:7168
    ds_read_b128 v[80:83], v248 offset:4096
    ds_read_b128 v[84:87], v248 offset:5120
    ds_read_b128 v[88:91], v248 offset:6144
    s_waitcnt lgkmcnt(0)
    v_cmp_ne_u32 vcc, v249, v10
    s_nop 3
    s_cbranch_vccnz CH_6
    s_branch CR_6
K2_SS2:
    buffer_wbl2 sc1
    s_waitcnt vmcnt(0)
    buffer_store_byte v2, v3, s[28:31], s59 offen offset:128 sc1
    s_branch K2_SR2
PL_11a:
    buffer_inv sc1
    s_waitcnt vmcnt(0)
    s_branch PL_11x
K2_SS3:
    buffer_wbl2 sc1
    s_waitcnt vmcnt(0)
    buffer_store_byte v2, v3, s[28:31], s59 offen offset:256 sc1
    s_branch K2_SR3
PL_12a:
    buffer_inv sc1
    s_waitcnt vmcnt(0)
    s_branch PL_12x
K2_SS4:
    buffer_wbl2 sc1
    s_waitcnt vmcnt(0)
    buffer_store_byte v2, v3, s[28:31], s59 offen offset:384 sc1
    s_branch K2_SR4
PL_13a:
    buffer_inv sc1
    s_waitcnt vmcnt(0)
    s_branch PL_13x
K2_FALLBACK:
    buffer_load_dwordx4 a[112:115], v7, s[28:31], s38 offen offset:0 sc1
    buffer_load_dwordx4 a[116:119], v7, s[28:31], s38 offen offset:672 sc1
    buffer_load_dwordx4 a[120:123], v7, s[28:31], s38 offen offset:1344 sc1
    buffer_load_dwordx4 a[124:127], v7, s[28:31], s38 offen offset:2016 sc1
    buffer_load_dwordx4 a[16:19], v5, s[28:31], s76 offen sc1
    buffer_load_dwordx4 a[72:75], v6, s[28:31], s76 offen offset:2048 sc1
    buffer_load_dwordx4 a[20:23], v5, s[28:31], s76 offen offset:1024 sc1
    buffer_load_dwordx4 a[128:131], v7, s[28:31], s76 offen offset:0 sc1
    buffer_load_dwordx4 a[132:135], v7, s[28:31], s76 offen offset:672 sc1
    buffer_load_dwordx4 a[136:139], v7, s[28:31], s76 offen offset:1344 sc1
    buffer_load_dwordx4 a[140:143], v7, s[28:31], s76 offen offset:2016 sc1
    buffer_load_dwordx4 a[24:27], v5, s[28:31], s77 offen sc1
    buffer_load_dwordx4 a[76:79], v6, s[28:31], s77 offen offset:2048 sc1
    buffer_load_dwordx4 a[28:31], v5, s[28:31], s77 offen offset:1024 sc1
    buffer_load_dwordx4 a[144:147], v7, s[28:31], s77 offen offset:0 sc1
    buffer_load_dwordx4 a[148:151], v7, s[28:31], s77 offen offset:672 sc1
    buffer_load_dwordx4 a[152:155], v7, s[28:31], s77 offen offset:1344 sc1
    buffer_load_dwordx4 a[156:159], v7, s[28:31], s77 offen offset:2016 sc1
    buffer_load_dwordx4 a[32:35], v5, s[28:31], s78 offen sc1
    buffer_load_dwordx4 a[80:83], v6, s[28:31], s78 offen offset:2048 sc1
    buffer_load_dwordx4 a[36:39], v5, s[28:31], s78 offen offset:1024 sc1
    buffer_load_dwordx4 a[160:163], v7, s[28:31], s78 offen offset:0 sc1
    buffer_load_dwordx4 a[164:167], v7, s[28:31], s78 offen offset:672 sc1
    buffer_load_dwordx4 a[168:171], v7, s[28:31], s78 offen offset:1344 sc1
    buffer_load_dwordx4 a[172:175], v7, s[28:31], s78 offen offset:2016 sc1
    buffer_load_dwordx4 a[40:43], v5, s[28:31], s79 offen sc1
    buffer_load_dwordx4 a[84:87], v6, s[28:31], s79 offen offset:2048 sc1
    buffer_load_dwordx4 a[44:47], v5, s[28:31], s79 offen offset:1024 sc1
    buffer_load_dwordx4 a[176:179], v7, s[28:31], s79 offen offset:0 sc1
    buffer_load_dwordx4 a[180:183], v7, s[28:31], s79 offen offset:672 sc1
    buffer_load_dwordx4 a[184:187], v7, s[28:31], s79 offen offset:1344 sc1
    buffer_load_dwordx4 a[188:191], v7, s[28:31], s79 offen offset:2016 sc1
    buffer_load_dwordx4 a[48:51], v5, s[28:31], s80 offen sc1
    buffer_load_dwordx4 a[88:91], v6, s[28:31], s80 offen offset:2048 sc1
    buffer_load_dwordx4 a[52:55], v5, s[28:31], s80 offen offset:1024 sc1
    buffer_load_dwordx4 a[192:195], v7, s[28:31], s80 offen offset:0 sc1
    buffer_load_dwordx4 a[196:199], v7, s[28:31], s80 offen offset:672 sc1
    buffer_load_dwordx4 a[200:203], v7, s[28:31], s80 offen offset:1344 sc1
    buffer_load_dwordx4 a[204:207], v7, s[28:31], s80 offen offset:2016 sc1
    buffer_load_dwordx4 a[56:59], v5, s[28:31], s81 offen sc1
    buffer_load_dwordx4 a[92:95], v6, s[28:31], s81 offen offset:2048 sc1
    buffer_load_dwordx4 a[60:63], v5, s[28:31], s81 offen offset:1024 sc1
    buffer_load_dwordx4 a[208:211], v7, s[28:31], s81 offen offset:0 sc1
    buffer_load_dwordx4 a[212:215], v7, s[28:31], s81 offen offset:672 sc1
    buffer_load_dwordx4 a[216:219], v7, s[28:31], s81 offen offset:1344 sc1
    buffer_load_dwordx4 a[220:223], v7, s[28:31], s81 offen offset:2016 sc1
    s_lshl_b32 s34, s40, 3
    v_subrev_u32 v8, s34, v8
    v_subrev_u32 v9, s34, v9
    s_waitcnt vmcnt(0)
    s_add_u32 m0, s63, 0
    s_nop 0
    buffer_load_dwordx4 v132, s[64:67], s4 offen lds
    s_add_u32 m0, s63, 1024
    s_nop 0
    buffer_load_dwordx4 v132, s[64:67], s7 offen lds
    s_add_u32 m0, s63, 2048
    s_nop 0
    buffer_load_dwordx4 v133, s[64:67], s5 offen lds
    s_add_u32 m0, s63, 3072
    s_nop 0
    buffer_load_dwordx4 v133, s[64:67], s14 offen lds
    s_add_u32 m0, s63, 16384
    s_nop 0
    buffer_load_dwordx4 v134, s[64:67], s6 offen lds
    s_add_u32 m0, s63, 17408
    s_nop 0
    buffer_load_dwordx4 v134, s[64:67], s15 offen lds
    s_waitcnt vmcnt(0)
    ds_read_b64_tr_b16 v[136:137], v135 offset:0
    ds_read_b64_tr_b16 v[138:139], v135 offset:256
    ds_read_b64_tr_b16 v[140:141], v135 offset:8
    ds_read_b64_tr_b16 v[142:143], v135 offset:264
    ds_read_b64_tr_b16 v[144:145], v135 offset:2048
    ds_read_b64_tr_b16 v[146:147], v135 offset:2304
    ds_read_b64_tr_b16 v[148:149], v135 offset:2056
    ds_read_b64_tr_b16 v[150:151], v135 offset:2312
    ds_read_b64_tr_b16 v[152:153], v135 offset:16384
    ds_read_b64_tr_b16 v[154:155], v135 offset:16640
    ds_read_b64_tr_b16 v[156:157], v135 offset:16392
    ds_read_b64_tr_b16 v[158:159], v135 offset:16648
    s_waitcnt lgkmcnt(0)
    v_mfma_f32_16x16x32_bf16 v[160:163], v[168:171], v[136:139], 0
    v_mfma_f32_16x16x32_bf16 v[164:167], v[168:171], v[140:143], 0
    v_mfma_f32_16x16x32_bf16 v[160:163], v[168:171], v[144:147], v[160:163]
    v_mfma_f32_16x16x32_bf16 v[164:167], v[168:171], v[148:151], v[164:167]
    v_mfma_f32_16x16x32_bf16 v[160:163], v[168:171], v[152:155], v[160:163]
    v_mfma_f32_16x16x32_bf16 v[164:167], v[168:171], v[156:159], v[164:167]
    buffer_store_dwordx4 v[136:139], v5, s[28:31], s68 offen sc1
    buffer_store_dwordx4 v[140:143], v5, s[28:31], s69 offen sc1
    buffer_store_dwordx4 v[144:147], v5, s[28:31], s70 offen sc1
    buffer_store_dwordx4 v[148:151], v5, s[28:31], s71 offen sc1
    buffer_store_dwordx4 v[152:155], v5, s[28:31], s72 offen sc1
    buffer_store_dwordx4 v[156:159], v5, s[28:31], s73 offen sc1
    s_nop 0
    buffer_store_dword v160, v172, s[28:31], s74 offen sc1
    buffer_store_dword v164, v172, s[28:31], s75 offen sc1
    s_min_u32 s78, s50, s51
    s_mul_i32 s34, s49, 54
    s_add_u32 s78, s78, s34
    s_lshl_b32 s78, s78, 10
    s_min_u32 s79, s45, s46
    s_add_u32 s35, s44, s32
    s_mul_i32 s34, s35, 20
    s_add_u32 s79, s79, s34
    s_lshl_b32 s79, s79, 10
    s_add_u32 s79, s79, 0
    s_lshl_b32 s80, s35, 3
    s_add_u32 s80, s80, s43
    s_lshl_b32 s80, s80, 7
    s_add_u32 s80, s80, 7340032
    s_lshl_b32 s39, s58, 8
    s_add_u32 s39, s39, 7299072
    s_lshl_b32 s34, s34, 10
    s_lshl_b32 s81, s45, 6
    s_add_u32 s81, s81, s34
    s_lshl_b32 s60, s46, 3
    s_add_u32 s60, s60, s47
    s_lshl_b32 s60, s60, 3
    s_add_u32 s60, s60, s34
    s_lshl_b32 s61, s43, 2
    s_add_u32 s61, s61, s32
    s_mul_i32 s61, s61, 25600
    s_add_u32 s61, s61, 10223616
    s_mul_i32 s62, s32, 25600
    s_mov_b32 m0, s62
    s_add_u32 s62, s62, s53
    s_mul_i32 s37, s32, 10240
    s_add_u32 s37, s37, s53
    s_add_u32 s37, s37, 102400
    s_mul_i32 s38, s48, 3584
    s_add_u32 s38, s38, 7471104
    s_lshr_b32 s58, s33, 3
    s_lshl_b32 s58, s58, 11
    s_add_u32 s58, s58, s55
    buffer_load_dwordx4 v[120:123], v114, s[16:19], s81 offen
    buffer_load_dwordx4 v[124:127], v114, s[16:19], s81 offen offset:64
    buffer_load_dwordx2 v[128:129], v114, s[16:19], s60 offen
    buffer_load_ushort v253, v115, s[20:23], 0 offen
    s_waitcnt vmcnt(0)
    s_barrier
    s_waitcnt vmcnt(0)
    buffer_atomic_add v241, v117, s[28:31], s39 offen sc1
    v_cmp_gt_u32_e64 vcc, 32, v1
    s_lshl_b32 s34, s32, 8
    s_add_u32 s34, s34, 0
    v_cndmask_b32 v243, 0, -1, vcc
    v_lshlrev_b32 v245, 2, v1
    v_add_u32 v244, s34, v245
    v_add_u32 v245, 0, v245
    s_mov_b32 s41, 0
K2_FB1:
    s_lshl_b32 s34, s41, 3
    v_add_u32 v2, s34, v8
    v_add_u32_e64 v3, s34, v9
    ds_read2_b64 v[18:21], v2 offset0:0 offset1:8
    ds_read_b64 v[22:23], v3
    s_waitcnt lgkmcnt(0)
    v_and_b32 v22, v22, v243
    v_mov_b32 v28, 0xff800000
    v_mfma_f32_32x32x16_bf16 v[32:47], a[0:3], v[18:21], 0
    v_mfma_f32_32x32x8_bf16 v[32:47], a[64:65], v[22:23], v[32:47]
    s_nop 11
    v_max3_f32 v28, v32, v33, v28
    v_max3_f32 v28, v34, v35, v28
    v_max3_f32 v28, v36, v37, v28
    v_max3_f32 v28, v38, v39, v28
    v_max3_f32 v28, v40, v41, v28
    v_max3_f32 v28, v42, v43, v28
    v_max3_f32 v28, v44, v45, v28
    v_max3_f32 v28, v46, v47, v28
    v_mfma_f32_32x32x16_bf16 v[32:47], a[4:7], v[18:21], 0
    v_mfma_f32_32x32x8_bf16 v[32:47], a[66:67], v[22:23], v[32:47]
    s_nop 11
    v_max3_f32 v28, v32, v33, v28
    v_max3_f32 v28, v34, v35, v28
    v_max3_f32 v28, v36, v37, v28
    v_max3_f32 v28, v38, v39, v28
    v_max3_f32 v28, v40, v41, v28
    v_max3_f32 v28, v42, v43, v28
    v_max3_f32 v28, v44, v45, v28
    v_max3_f32 v28, v46, v47, v28
    v_mfma_f32_32x32x16_bf16 v[32:47], a[8:11], v[18:21], 0
    v_mfma_f32_32x32x8_bf16 v[32:47], a[68:69], v[22:23], v[32:47]
    s_nop 11
    v_max3_f32 v28, v32, v33, v28
    v_max3_f32 v28, v34, v35, v28
    v_max3_f32 v28, v36, v37, v28
    v_max3_f32 v28, v38, v39, v28
    v_max3_f32 v28, v40, v41, v28
    v_max3_f32 v28, v42, v43, v28
    v_max3_f32 v28, v44, v45, v28
    v_max3_f32 v28, v46, v47, v28
    v_mfma_f32_32x32x16_bf16 v[32:47], a[12:15], v[18:21], 0
    v_mfma_f32_32x32x8_bf16 v[32:47], a[70:71], v[22:23], v[32:47]
    s_nop 11
    v_max3_f32 v28, v32, v33, v28
    v_max3_f32 v28, v34, v35, v28
    v_max3_f32 v28, v36, v37, v28
    v_max3_f32 v28, v38, v39, v28
    v_max3_f32 v28, v40, v41, v28
    v_max3_f32 v28, v42, v43, v28
    v_max3_f32 v28, v44, v45, v28
    v_max3_f32 v28, v46, v47, v28
    v_mfma_f32_32x32x16_bf16 v[32:47], a[16:19], v[18:21], 0
    v_mfma_f32_32x32x8_bf16 v[32:47], a[72:73], v[22:23], v[32:47]
    s_nop 11
    v_max3_f32 v28, v32, v33, v28
    v_max3_f32 v28, v34, v35, v28
    v_max3_f32 v28, v36, v37, v28
    v_max3_f32 v28, v38, v39, v28
    v_max3_f32 v28, v40, v41, v28
    v_max3_f32 v28, v42, v43, v28
    v_max3_f32 v28, v44, v45, v28
    v_max3_f32 v28, v46, v47, v28
    v_mfma_f32_32x32x16_bf16 v[32:47], a[20:23], v[18:21], 0
    v_mfma_f32_32x32x8_bf16 v[32:47], a[74:75], v[22:23], v[32:47]
    s_nop 11
    v_max3_f32 v28, v32, v33, v28
    v_max3_f32 v28, v34, v35, v28
    v_max3_f32 v28, v36, v37, v28
    v_max3_f32 v28, v38, v39, v28
    v_max3_f32 v28, v40, v41, v28
    v_max3_f32 v28, v42, v43, v28
    v_max3_f32 v28, v44, v45, v28
    v_max3_f32 v28, v46, v47, v28
    v_mfma_f32_32x32x16_bf16 v[32:47], a[24:27], v[18:21], 0
    v_mfma_f32_32x32x8_bf16 v[32:47], a[76:77], v[22:23], v[32:47]
    s_nop 11
    v_max3_f32 v28, v32, v33, v28
    v_max3_f32 v28, v34, v35, v28
    v_max3_f32 v28, v36, v37, v28
    v_max3_f32 v28, v38, v39, v28
    v_max3_f32 v28, v40, v41, v28
    v_max3_f32 v28, v42, v43, v28
    v_max3_f32 v28, v44, v45, v28
    v_max3_f32 v28, v46, v47, v28
    v_mfma_f32_32x32x16_bf16 v[32:47], a[28:31], v[18:21], 0
    v_mfma_f32_32x32x8_bf16 v[32:47], a[78:79], v[22:23], v[32:47]
    s_nop 11
    v_max3_f32 v28, v32, v33, v28
    v_max3_f32 v28, v34, v35, v28
    v_max3_f32 v28, v36, v37, v28
    v_max3_f32 v28, v38, v39, v28
    v_max3_f32 v28, v40, v41, v28
    v_max3_f32 v28, v42, v43, v28
    v_max3_f32 v28, v44, v45, v28
    v_max3_f32 v28, v46, v47, v28
    v_mfma_f32_32x32x16_bf16 v[32:47], a[32:35], v[18:21], 0
    v_mfma_f32_32x32x8_bf16 v[32:47], a[80:81], v[22:23], v[32:47]
    s_nop 11
    v_max3_f32 v28, v32, v33, v28
    v_max3_f32 v28, v34, v35, v28
    v_max3_f32 v28, v36, v37, v28
    v_max3_f32 v28, v38, v39, v28
    v_max3_f32 v28, v40, v41, v28
    v_max3_f32 v28, v42, v43, v28
    v_max3_f32 v28, v44, v45, v28
    v_max3_f32 v28, v46, v47, v28
    v_mfma_f32_32x32x16_bf16 v[32:47], a[36:39], v[18:21], 0
    v_mfma_f32_32x32x8_bf16 v[32:47], a[82:83], v[22:23], v[32:47]
    s_nop 11
    v_max3_f32 v28, v32, v33, v28
    v_max3_f32 v28, v34, v35, v28
    v_max3_f32 v28, v36, v37, v28
    v_max3_f32 v28, v38, v39, v28
    v_max3_f32 v28, v40, v41, v28
    v_max3_f32 v28, v42, v43, v28
    v_max3_f32 v28, v44, v45, v28
    v_max3_f32 v28, v46, v47, v28
    v_mfma_f32_32x32x16_bf16 v[32:47], a[40:43], v[18:21], 0
    v_mfma_f32_32x32x8_bf16 v[32:47], a[84:85], v[22:23], v[32:47]
    s_nop 11
    v_max3_f32 v28, v32, v33, v28
    v_max3_f32 v28, v34, v35, v28
    v_max3_f32 v28, v36, v37, v28
    v_max3_f32 v28, v38, v39, v28
    v_max3_f32 v28, v40, v41, v28
    v_max3_f32 v28, v42, v43, v28
    v_max3_f32 v28, v44, v45, v28
    v_max3_f32 v28, v46, v47, v28
    v_mfma_f32_32x32x16_bf16 v[32:47], a[44:47], v[18:21], 0
    v_mfma_f32_32x32x8_bf16 v[32:47], a[86:87], v[22:23], v[32:47]
    s_nop 11
    v_max3_f32 v28, v32, v33, v28
    v_max3_f32 v28, v34, v35, v28
    v_max3_f32 v28, v36, v37, v28
    v_max3_f32 v28, v38, v39, v28
    v_max3_f32 v28, v40, v41, v28
    v_max3_f32 v28, v42, v43, v28
    v_max3_f32 v28, v44, v45, v28
    v_max3_f32 v28, v46, v47, v28
    v_mfma_f32_32x32x16_bf16 v[32:47], a[48:51], v[18:21], 0
    v_mfma_f32_32x32x8_bf16 v[32:47], a[88:89], v[22:23], v[32:47]
    s_nop 11
    v_max3_f32 v28, v32, v33, v28
    v_max3_f32 v28, v34, v35, v28
    v_max3_f32 v28, v36, v37, v28
    v_max3_f32 v28, v38, v39, v28
    v_max3_f32 v28, v40, v41, v28
    v_max3_f32 v28, v42, v43, v28
    v_max3_f32 v28, v44, v45, v28
    v_max3_f32 v28, v46, v47, v28
    v_mfma_f32_32x32x16_bf16 v[32:47], a[52:55], v[18:21], 0
    v_mfma_f32_32x32x8_bf16 v[32:47], a[90:91], v[22:23], v[32:47]
    s_nop 11
    v_max3_f32 v28, v32, v33, v28
    v_max3_f32 v28, v34, v35, v28
    v_max3_f32 v28, v36, v37, v28
    v_max3_f32 v28, v38, v39, v28
    v_max3_f32 v28, v40, v41, v28
    v_max3_f32 v28, v42, v43, v28
    v_max3_f32 v28, v44, v45, v28
    v_max3_f32 v28, v46, v47, v28
    v_mfma_f32_32x32x16_bf16 v[32:47], a[56:59], v[18:21], 0
    v_mfma_f32_32x32x8_bf16 v[32:47], a[92:93], v[22:23], v[32:47]
    s_nop 11
    v_max3_f32 v28, v32, v33, v28
    v_max3_f32 v28, v34, v35, v28
    v_max3_f32 v28, v36, v37, v28
    v_max3_f32 v28, v38, v39, v28
    v_max3_f32 v28, v40, v41, v28
    v_max3_f32 v28, v42, v43, v28
    v_max3_f32 v28, v44, v45, v28
    v_max3_f32 v28, v46, v47, v28
    v_mfma_f32_32x32x16_bf16 v[32:47], a[60:63], v[18:21], 0
    v_mfma_f32_32x32x8_bf16 v[32:47], a[94:95], v[22:23], v[32:47]
    s_nop 11
    v_max3_f32 v28, v32, v33, v28
    v_max3_f32 v28, v34, v35, v28
    v_max3_f32 v28, v36, v37, v28
    v_max3_f32 v28, v38, v39, v28
    v_max3_f32 v28, v40, v41, v28
    v_max3_f32 v28, v42, v43, v28
    v_max3_f32 v28, v44, v45, v28
    v_max3_f32 v28, v46, v47, v28
    v_mov_b32 v2, v28
    s_nop 1
    v_permlane32_swap_b32 v28, v2
    v_max_f32 v28, v28, v2
    s_lshl_b32 s34, s41, 10
    v_add_u32 v2, s34, v244
    ds_write_b32 v2, v28
    s_add_u32 s41, s41, 1
    s_cmp_lt_u32 s41, 8
    s_cbranch_scc1 K2_FB1
    s_mov_b32 s41, 0
K2_FB2:
    s_waitcnt lgkmcnt(0)
    s_barrier
    s_lshl_b32 s34, s40, 10
    v_add_u32 v2, s34, v245
    ds_read_b32 v28, v2
    ds_read_b32 v29, v2 offset:256
    ds_read_b32 v30, v2 offset:512
    ds_read_b32 v31, v2 offset:768
    s_lshl_b32 s35, s40, 12
    s_add_u32 s35, s35, 118528
    v_add_u32 v15, s35, v5
    v_mov_b32 v80, 0
    v_mov_b32 v81, 0
    v_mov_b32 v82, 0
    v_mov_b32 v83, 0
    v_mov_b32 v84, 0
    v_mov_b32 v85, 0
    v_mov_b32 v86, 0
    v_mov_b32 v87, 0
    v_mov_b32 v88, 0
    v_mov_b32 v89, 0
    v_mov_b32 v90, 0
    v_mov_b32 v91, 0
    v_mov_b32 v92, 0
    v_mov_b32 v93, 0
    v_mov_b32_e64 v94, 0
    v_mov_b32 v95, 0
    s_cmp_lt_u32 s41, 2
    s_nop 0
    s_cbranch_scc1 K2_FB3
    ds_read_b128 v[80:83], v15 offset:0
    ds_read_b128 v[84:87], v15 offset:1024
    ds_read_b128 v[88:91], v15 offset:2048
K2_FB3:
    s_lshl_b32 s34, s40, 3
    v_add_u32 v2, s34, v8
    v_add_u32_e64 v3, s34, v9
    ds_read2_b64 v[18:21], v2 offset0:0 offset1:8
    ds_read_b64 v[22:23], v3
    s_waitcnt lgkmcnt(0)
    v_and_b32 v22, v22, v243
    v_max3_f32 v28, v28, v29, v30
    v_max_f32_e64 v28, v28, v31
    v_mfma_f32_32x32x16_bf16 v[32:47], a[0:3], v[18:21], 0
    v_mfma_f32_32x32x8_bf16 v[32:47], a[64:65], v[22:23], v[32:47]
    s_nop 11
    v_sub_f32 v32, v32, v28
    v_sub_f32 v33, v33, v28
    v_sub_f32 v34, v34, v28
    v_sub_f32 v35, v35, v28
    v_sub_f32 v36, v36, v28
    v_sub_f32 v37, v37, v28
    v_sub_f32 v38, v38, v28
    v_sub_f32 v39, v39, v28
    v_sub_f32 v40, v40, v28
    v_sub_f32 v41, v41, v28
    v_sub_f32 v42, v42, v28
    v_sub_f32 v43, v43, v28
    v_sub_f32 v44, v44, v28
    v_sub_f32 v45, v45, v28
    v_sub_f32 v46, v46, v28
    v_sub_f32 v47, v47, v28
    v_exp_f32 v32, v32
    v_exp_f32 v33, v33
    v_exp_f32 v34, v34
    v_exp_f32 v35, v35
    v_exp_f32 v36, v36
    v_exp_f32 v37, v37
    v_exp_f32 v38, v38
    v_exp_f32 v39, v39
    v_exp_f32 v40, v40
    v_exp_f32 v41, v41
    v_exp_f32 v42, v42
    v_exp_f32 v43, v43
    v_exp_f32 v44, v44
    v_exp_f32 v45, v45
    v_exp_f32 v46, v46
    v_exp_f32_e64 v47, v47
    v_cvt_pk_bf16_f32 v64, v32, v33
    v_cvt_pk_bf16_f32 v65, v34, v35
    v_cvt_pk_bf16_f32 v66, v36, v37
    v_cvt_pk_bf16_f32 v67, v38, v39
    v_cvt_pk_bf16_f32 v68, v40, v41
    v_cvt_pk_bf16_f32 v69, v42, v43
    v_cvt_pk_bf16_f32 v70, v44, v45
    v_cvt_pk_bf16_f32 v71, v46, v47
    v_mfma_f32_32x32x16_bf16 v[80:95], a[96:99], v[64:67], v[80:95]
    s_nop 0
    v_mfma_f32_32x32x16_bf16 v[80:95], a[100:103], v[68:71], v[80:95]
    v_mfma_f32_32x32x16_bf16 v[48:63], a[4:7], v[18:21], 0
    v_mfma_f32_32x32x8_bf16 v[48:63], a[66:67], v[22:23], v[48:63]
    s_nop 11
    v_sub_f32 v48, v48, v28
    v_sub_f32 v49, v49, v28
    v_sub_f32 v50, v50, v28
    v_sub_f32 v51, v51, v28
    v_sub_f32 v52, v52, v28
    v_sub_f32 v53, v53, v28
    v_sub_f32 v54, v54, v28
    v_sub_f32 v55, v55, v28
    v_sub_f32 v56, v56, v28
    v_sub_f32 v57, v57, v28
    v_sub_f32 v58, v58, v28
    v_sub_f32 v59, v59, v28
    v_sub_f32 v60, v60, v28
    v_sub_f32 v61, v61, v28
    v_sub_f32 v62, v62, v28
    v_sub_f32 v63, v63, v28
    v_exp_f32 v48, v48
    v_exp_f32 v49, v49
    v_exp_f32 v50, v50
    v_exp_f32 v51, v51
    v_exp_f32 v52, v52
    v_exp_f32 v53, v53
    v_exp_f32 v54, v54
    v_exp_f32 v55, v55
    v_exp_f32 v56, v56
    v_exp_f32 v57, v57
    v_exp_f32 v58, v58
    v_exp_f32 v59, v59
    v_exp_f32 v60, v60
    v_exp_f32 v61, v61
    v_exp_f32 v62, v62
    v_exp_f32 v63, v63
    v_cvt_pk_bf16_f32 v72, v48, v49
    v_cvt_pk_bf16_f32 v73, v50, v51
    v_cvt_pk_bf16_f32 v74, v52, v53
    v_cvt_pk_bf16_f32 v75, v54, v55
    v_cvt_pk_bf16_f32 v76, v56, v57
    v_cvt_pk_bf16_f32 v77, v58, v59
    v_cvt_pk_bf16_f32 v78, v60, v61
    v_cvt_pk_bf16_f32 v79, v62, v63
    v_mfma_f32_32x32x16_bf16 v[80:95], a[104:107], v[72:75], v[80:95]
    s_nop 0
    v_mfma_f32_32x32x16_bf16 v[80:95], a[108:111], v[76:79], v[80:95]
    v_mfma_f32_32x32x16_bf16 v[32:47], a[8:11], v[18:21], 0
    v_mfma_f32_32x32x8_bf16 v[32:47], a[68:69], v[22:23], v[32:47]
    s_nop 11
    v_sub_f32 v32, v32, v28
    v_sub_f32 v33, v33, v28
    v_sub_f32 v34, v34, v28
    v_sub_f32 v35, v35, v28
    v_sub_f32 v36, v36, v28
    v_sub_f32 v37, v37, v28
    v_sub_f32 v38, v38, v28
    v_sub_f32 v39, v39, v28
    v_sub_f32 v40, v40, v28
    v_sub_f32 v41, v41, v28
    v_sub_f32 v42, v42, v28
    v_sub_f32 v43, v43, v28
    v_sub_f32 v44, v44, v28
    v_sub_f32 v45, v45, v28
    v_sub_f32 v46, v46, v28
    v_sub_f32 v47, v47, v28
    v_exp_f32 v32, v32
    v_exp_f32 v33, v33
    v_exp_f32 v34, v34
    v_exp_f32 v35, v35
    v_exp_f32 v36, v36
    v_exp_f32 v37, v37
    v_exp_f32 v38, v38
    v_exp_f32 v39, v39
    v_exp_f32 v40, v40
    v_exp_f32 v41, v41
    v_exp_f32 v42, v42
    v_exp_f32 v43, v43
    v_exp_f32 v44, v44
    v_exp_f32 v45, v45
    v_exp_f32 v46, v46
    v_exp_f32 v47, v47
    v_cvt_pk_bf16_f32 v64, v32, v33
    v_cvt_pk_bf16_f32 v65, v34, v35
    v_cvt_pk_bf16_f32 v66, v36, v37
    v_cvt_pk_bf16_f32 v67, v38, v39
    v_cvt_pk_bf16_f32 v68, v40, v41
    v_cvt_pk_bf16_f32 v69, v42, v43
    v_cvt_pk_bf16_f32 v70, v44, v45
    v_cvt_pk_bf16_f32 v71, v46, v47
    v_mfma_f32_32x32x16_bf16 v[80:95], a[112:115], v[64:67], v[80:95]
    s_nop 0
    v_mfma_f32_32x32x16_bf16 v[80:95], a[116:119], v[68:71], v[80:95]
    v_mfma_f32_32x32x16_bf16 v[48:63], a[12:15], v[18:21], 0
    v_mfma_f32_32x32x8_bf16 v[48:63], a[70:71], v[22:23], v[48:63]
    s_nop 11
    v_sub_f32 v48, v48, v28
    v_sub_f32 v49, v49, v28
    v_sub_f32 v50, v50, v28
    v_sub_f32 v51, v51, v28
    v_sub_f32 v52, v52, v28
    v_sub_f32 v53, v53, v28
    v_sub_f32 v54, v54, v28
    v_sub_f32 v55, v55, v28
    v_sub_f32 v56, v56, v28
    v_sub_f32 v57, v57, v28
    v_sub_f32 v58, v58, v28
    v_sub_f32 v59, v59, v28
    v_sub_f32 v60, v60, v28
    v_sub_f32 v61, v61, v28
    v_sub_f32 v62, v62, v28
    v_sub_f32 v63, v63, v28
    v_exp_f32 v48, v48
    v_exp_f32 v49, v49
    v_exp_f32 v50, v50
    v_exp_f32 v51, v51
    v_exp_f32 v52, v52
    v_exp_f32 v53, v53
    v_exp_f32 v54, v54
    v_exp_f32 v55, v55
    v_exp_f32 v56, v56
    v_exp_f32 v57, v57
    v_exp_f32 v58, v58
    v_exp_f32 v59, v59
    v_exp_f32 v60, v60
    v_exp_f32 v61, v61
    v_exp_f32 v62, v62
    v_exp_f32 v63, v63
    v_cvt_pk_bf16_f32 v72, v48, v49
    v_cvt_pk_bf16_f32 v73, v50, v51
    v_cvt_pk_bf16_f32 v74, v52, v53
    v_cvt_pk_bf16_f32 v75, v54, v55
    v_cvt_pk_bf16_f32 v76, v56, v57
    v_cvt_pk_bf16_f32 v77, v58, v59
    v_cvt_pk_bf16_f32 v78, v60, v61
    v_cvt_pk_bf16_f32 v79, v62, v63
    v_mfma_f32_32x32x16_bf16 v[80:95], a[120:123], v[72:75], v[80:95]
    s_nop 0
    v_mfma_f32_32x32x16_bf16 v[80:95], a[124:127], v[76:79], v[80:95]
    v_mfma_f32_32x32x16_bf16 v[32:47], a[16:19], v[18:21], 0
    v_mfma_f32_32x32x8_bf16 v[32:47], a[72:73], v[22:23], v[32:47]
    s_nop 11
    v_sub_f32 v32, v32, v28
    v_sub_f32 v33, v33, v28
    v_sub_f32 v34, v34, v28
    v_sub_f32 v35, v35, v28
    v_sub_f32 v36, v36, v28
    v_sub_f32 v37, v37, v28
    v_sub_f32 v38, v38, v28
    v_sub_f32 v39, v39, v28
    v_sub_f32 v40, v40, v28
    v_sub_f32 v41, v41, v28
    v_sub_f32 v42, v42, v28
    v_sub_f32 v43, v43, v28
    v_sub_f32 v44, v44, v28
    v_sub_f32 v45, v45, v28
    v_sub_f32 v46, v46, v28
    v_sub_f32 v47, v47, v28
    v_exp_f32 v32, v32
    v_exp_f32 v33, v33
    v_exp_f32 v34, v34
    v_exp_f32 v35, v35
    v_exp_f32 v36, v36
    v_exp_f32 v37, v37
    v_exp_f32 v38, v38
    v_exp_f32 v39, v39
    v_exp_f32 v40, v40
    v_exp_f32 v41, v41
    v_exp_f32 v42, v42
    v_exp_f32 v43, v43
    v_exp_f32 v44, v44
    v_exp_f32 v45, v45
    v_exp_f32 v46, v46
    v_exp_f32 v47, v47
    v_cvt_pk_bf16_f32 v64, v32, v33
    v_cvt_pk_bf16_f32 v65, v34, v35
    v_cvt_pk_bf16_f32 v66, v36, v37
    v_cvt_pk_bf16_f32 v67, v38, v39
    v_cvt_pk_bf16_f32 v68, v40, v41
    v_cvt_pk_bf16_f32 v69, v42, v43
    v_cvt_pk_bf16_f32 v70, v44, v45
    v_cvt_pk_bf16_f32 v71, v46, v47
    v_mfma_f32_32x32x16_bf16 v[80:95], a[128:131], v[64:67], v[80:95]
    s_nop 0
    v_mfma_f32_32x32x16_bf16 v[80:95], a[132:135], v[68:71], v[80:95]
    v_mfma_f32_32x32x16_bf16 v[48:63], a[20:23], v[18:21], 0
    v_mfma_f32_32x32x8_bf16 v[48:63], a[74:75], v[22:23], v[48:63]
    s_nop 11
    v_sub_f32 v48, v48, v28
    v_sub_f32 v49, v49, v28
    v_sub_f32 v50, v50, v28
    v_sub_f32 v51, v51, v28
    v_sub_f32 v52, v52, v28
    v_sub_f32 v53, v53, v28
    v_sub_f32 v54, v54, v28
    v_sub_f32 v55, v55, v28
    v_sub_f32 v56, v56, v28
    v_sub_f32 v57, v57, v28
    v_sub_f32 v58, v58, v28
    v_sub_f32 v59, v59, v28
    v_sub_f32 v60, v60, v28
    v_sub_f32 v61, v61, v28
    v_sub_f32 v62, v62, v28
    v_sub_f32 v63, v63, v28
    v_exp_f32 v48, v48
    v_exp_f32 v49, v49
    v_exp_f32 v50, v50
    v_exp_f32 v51, v51
    v_exp_f32 v52, v52
    v_exp_f32 v53, v53
    v_exp_f32 v54, v54
    v_exp_f32 v55, v55
    v_exp_f32 v56, v56
    v_exp_f32 v57, v57
    v_exp_f32 v58, v58
    v_exp_f32 v59, v59
    v_exp_f32 v60, v60
    v_exp_f32 v61, v61
    v_exp_f32 v62, v62
    v_exp_f32 v63, v63
    v_cvt_pk_bf16_f32 v72, v48, v49
    v_cvt_pk_bf16_f32 v73, v50, v51
    v_cvt_pk_bf16_f32 v74, v52, v53
    v_cvt_pk_bf16_f32 v75, v54, v55
    v_cvt_pk_bf16_f32 v76, v56, v57
    v_cvt_pk_bf16_f32 v77, v58, v59
    v_cvt_pk_bf16_f32 v78, v60, v61
    v_cvt_pk_bf16_f32 v79, v62, v63
    v_mfma_f32_32x32x16_bf16 v[80:95], a[136:139], v[72:75], v[80:95]
    s_nop 0
    v_mfma_f32_32x32x16_bf16 v[80:95], a[140:143], v[76:79], v[80:95]
    v_mfma_f32_32x32x16_bf16 v[32:47], a[24:27], v[18:21], 0
    v_mfma_f32_32x32x8_bf16 v[32:47], a[76:77], v[22:23], v[32:47]
    s_nop 11
    v_sub_f32 v32, v32, v28
    v_sub_f32 v33, v33, v28
    v_sub_f32 v34, v34, v28
    v_sub_f32 v35, v35, v28
    v_sub_f32 v36, v36, v28
    v_sub_f32 v37, v37, v28
    v_sub_f32 v38, v38, v28
    v_sub_f32 v39, v39, v28
    v_sub_f32 v40, v40, v28
    v_sub_f32 v41, v41, v28
    v_sub_f32 v42, v42, v28
    v_sub_f32 v43, v43, v28
    v_sub_f32 v44, v44, v28
    v_sub_f32 v45, v45, v28
    v_sub_f32 v46, v46, v28
    v_sub_f32 v47, v47, v28
    v_exp_f32 v32, v32
    v_exp_f32 v33, v33
    v_exp_f32 v34, v34
    v_exp_f32 v35, v35
    v_exp_f32 v36, v36
    v_exp_f32 v37, v37
    v_exp_f32 v38, v38
    v_exp_f32 v39, v39
    v_exp_f32 v40, v40
    v_exp_f32 v41, v41
    v_exp_f32 v42, v42
    v_exp_f32 v43, v43
    v_exp_f32 v44, v44
    v_exp_f32 v45, v45
    v_exp_f32 v46, v46
    v_exp_f32 v47, v47
    v_cvt_pk_bf16_f32 v64, v32, v33
    v_cvt_pk_bf16_f32 v65, v34, v35
    v_cvt_pk_bf16_f32 v66, v36, v37
    v_cvt_pk_bf16_f32 v67, v38, v39
    v_cvt_pk_bf16_f32 v68, v40, v41
    v_cvt_pk_bf16_f32 v69, v42, v43
    v_cvt_pk_bf16_f32 v70, v44, v45
    v_cvt_pk_bf16_f32 v71, v46, v47
    v_mfma_f32_32x32x16_bf16 v[80:95], a[144:147], v[64:67], v[80:95]
    s_nop 0
    v_mfma_f32_32x32x16_bf16 v[80:95], a[148:151], v[68:71], v[80:95]
    v_mfma_f32_32x32x16_bf16 v[48:63], a[28:31], v[18:21], 0
    v_mfma_f32_32x32x8_bf16 v[48:63], a[78:79], v[22:23], v[48:63]
    s_nop 11
    v_sub_f32 v48, v48, v28
    v_sub_f32 v49, v49, v28
    v_sub_f32 v50, v50, v28
    v_sub_f32 v51, v51, v28
    v_sub_f32 v52, v52, v28
    v_sub_f32 v53, v53, v28
    v_sub_f32 v54, v54, v28
    v_sub_f32 v55, v55, v28
    v_sub_f32 v56, v56, v28
    v_sub_f32 v57, v57, v28
    v_sub_f32 v58, v58, v28
    v_sub_f32 v59, v59, v28
    v_sub_f32 v60, v60, v28
    v_sub_f32 v61, v61, v28
    v_sub_f32 v62, v62, v28
    v_sub_f32 v63, v63, v28
    v_exp_f32 v48, v48
    v_exp_f32 v49, v49
    v_exp_f32 v50, v50
    v_exp_f32 v51, v51
    v_exp_f32 v52, v52
    v_exp_f32 v53, v53
    v_exp_f32 v54, v54
    v_exp_f32 v55, v55
    v_exp_f32 v56, v56
    v_exp_f32 v57, v57
    v_exp_f32 v58, v58
    v_exp_f32 v59, v59
    v_exp_f32 v60, v60
    v_exp_f32 v61, v61
    v_exp_f32 v62, v62
    v_exp_f32 v63, v63
    v_cvt_pk_bf16_f32 v72, v48, v49
    v_cvt_pk_bf16_f32 v73, v50, v51
    v_cvt_pk_bf16_f32 v74, v52, v53
    v_cvt_pk_bf16_f32 v75, v54, v55
    v_cvt_pk_bf16_f32 v76, v56, v57
    v_cvt_pk_bf16_f32 v77, v58, v59
    v_cvt_pk_bf16_f32 v78, v60, v61
    v_cvt_pk_bf16_f32 v79, v62, v63
    v_mfma_f32_32x32x16_bf16 v[80:95], a[152:155], v[72:75], v[80:95]
    s_nop 0
    v_mfma_f32_32x32x16_bf16 v[80:95], a[156:159], v[76:79], v[80:95]
    v_mfma_f32_32x32x16_bf16 v[32:47], a[32:35], v[18:21], 0
    v_mfma_f32_32x32x8_bf16 v[32:47], a[80:81], v[22:23], v[32:47]
    s_nop 11
    v_sub_f32 v32, v32, v28
    v_sub_f32 v33, v33, v28
    v_sub_f32 v34, v34, v28
    v_sub_f32 v35, v35, v28
    v_sub_f32 v36, v36, v28
    v_sub_f32 v37, v37, v28
    v_sub_f32 v38, v38, v28
    v_sub_f32 v39, v39, v28
    v_sub_f32 v40, v40, v28
    v_sub_f32 v41, v41, v28
    v_sub_f32 v42, v42, v28
    v_sub_f32 v43, v43, v28
    v_sub_f32 v44, v44, v28
    v_sub_f32 v45, v45, v28
    v_sub_f32 v46, v46, v28
    v_sub_f32 v47, v47, v28
    v_exp_f32 v32, v32
    v_exp_f32 v33, v33
    v_exp_f32 v34, v34
    v_exp_f32 v35, v35
    v_exp_f32 v36, v36
    v_exp_f32 v37, v37
    v_exp_f32 v38, v38
    v_exp_f32 v39, v39
    v_exp_f32 v40, v40
    v_exp_f32 v41, v41
    v_exp_f32 v42, v42
    v_exp_f32 v43, v43
    v_exp_f32 v44, v44
    v_exp_f32 v45, v45
    v_exp_f32 v46, v46
    v_exp_f32 v47, v47
    v_cvt_pk_bf16_f32 v64, v32, v33
    v_cvt_pk_bf16_f32 v65, v34, v35
    v_cvt_pk_bf16_f32 v66, v36, v37
    v_cvt_pk_bf16_f32 v67, v38, v39
    v_cvt_pk_bf16_f32 v68, v40, v41
    v_cvt_pk_bf16_f32 v69, v42, v43
    v_cvt_pk_bf16_f32 v70, v44, v45
    v_cvt_pk_bf16_f32 v71, v46, v47
    v_mfma_f32_32x32x16_bf16 v[96:111], a[160:163], v[64:67], v[80:95]
    s_nop 0
    v_mfma_f32_32x32x16_bf16 v[96:111], a[164:167], v[68:71], v[96:111]
    v_mfma_f32_32x32x16_bf16 v[48:63], a[36:39], v[18:21], 0
    v_mfma_f32_32x32x8_bf16 v[48:63], a[82:83], v[22:23], v[48:63]
    s_nop 11
    v_sub_f32 v48, v48, v28
    v_sub_f32 v49, v49, v28
    v_sub_f32 v50, v50, v28
    v_sub_f32 v51, v51, v28
    v_sub_f32 v52, v52, v28
    v_sub_f32 v53, v53, v28
    v_sub_f32 v54, v54, v28
    v_sub_f32 v55, v55, v28
    v_sub_f32 v56, v56, v28
    v_sub_f32 v57, v57, v28
    v_sub_f32 v58, v58, v28
    v_sub_f32 v59, v59, v28
    v_sub_f32 v60, v60, v28
    v_sub_f32 v61, v61, v28
    v_sub_f32 v62, v62, v28
    v_sub_f32 v63, v63, v28
    v_exp_f32 v48, v48
    v_exp_f32 v49, v49
    v_exp_f32 v50, v50
    v_exp_f32 v51, v51
    v_exp_f32 v52, v52
    v_exp_f32 v53, v53
    v_exp_f32 v54, v54
    v_exp_f32 v55, v55
    v_exp_f32 v56, v56
    v_exp_f32 v57, v57
    v_exp_f32 v58, v58
    v_exp_f32 v59, v59
    v_exp_f32 v60, v60
    v_exp_f32 v61, v61
    v_exp_f32 v62, v62
    v_exp_f32 v63, v63
    v_cvt_pk_bf16_f32 v72, v48, v49
    v_cvt_pk_bf16_f32 v73, v50, v51
    v_cvt_pk_bf16_f32 v74, v52, v53
    v_cvt_pk_bf16_f32 v75, v54, v55
    v_cvt_pk_bf16_f32 v76, v56, v57
    v_cvt_pk_bf16_f32 v77, v58, v59
    v_cvt_pk_bf16_f32 v78, v60, v61
    v_cvt_pk_bf16_f32 v79, v62, v63
    v_mfma_f32_32x32x16_bf16 v[96:111], a[168:171], v[72:75], v[96:111]
    s_nop 0
    v_mfma_f32_32x32x16_bf16 v[96:111], a[172:175], v[76:79], v[96:111]
    v_mfma_f32_32x32x16_bf16 v[32:47], a[40:43], v[18:21], 0
    v_mfma_f32_32x32x8_bf16 v[32:47], a[84:85], v[22:23], v[32:47]
    s_nop 11
    v_sub_f32 v32, v32, v28
    v_sub_f32 v33, v33, v28
    v_sub_f32 v34, v34, v28
    v_sub_f32 v35, v35, v28
    v_sub_f32 v36, v36, v28
    v_sub_f32 v37, v37, v28
    v_sub_f32 v38, v38, v28
    v_sub_f32 v39, v39, v28
    v_sub_f32 v40, v40, v28
    v_sub_f32 v41, v41, v28
    v_sub_f32 v42, v42, v28
    v_sub_f32 v43, v43, v28
    v_sub_f32 v44, v44, v28
    v_sub_f32 v45, v45, v28
    v_sub_f32 v46, v46, v28
    v_sub_f32 v47, v47, v28
    v_exp_f32 v32, v32
    v_exp_f32 v33, v33
    v_exp_f32 v34, v34
    v_exp_f32 v35, v35
    v_exp_f32 v36, v36
    v_exp_f32 v37, v37
    v_exp_f32 v38, v38
    v_exp_f32 v39, v39
    v_exp_f32 v40, v40
    v_exp_f32 v41, v41
    v_exp_f32 v42, v42
    v_exp_f32 v43, v43
    v_exp_f32 v44, v44
    v_exp_f32 v45, v45
    v_exp_f32 v46, v46
    v_exp_f32 v47, v47
    v_cvt_pk_bf16_f32 v64, v32, v33
    v_cvt_pk_bf16_f32 v65, v34, v35
    v_cvt_pk_bf16_f32 v66, v36, v37
    v_cvt_pk_bf16_f32 v67, v38, v39
    v_cvt_pk_bf16_f32 v68, v40, v41
    v_cvt_pk_bf16_f32 v69, v42, v43
    v_cvt_pk_bf16_f32 v70, v44, v45
    v_cvt_pk_bf16_f32 v71, v46, v47
    v_mfma_f32_32x32x16_bf16 v[96:111], a[176:179], v[64:67], v[96:111]
    s_nop 0
    v_mfma_f32_32x32x16_bf16 v[96:111], a[180:183], v[68:71], v[96:111]
    v_mfma_f32_32x32x16_bf16 v[48:63], a[44:47], v[18:21], 0
    v_mfma_f32_32x32x8_bf16 v[48:63], a[86:87], v[22:23], v[48:63]
    s_nop 11
    v_sub_f32 v48, v48, v28
    v_sub_f32 v49, v49, v28
    v_sub_f32 v50, v50, v28
    v_sub_f32 v51, v51, v28
    v_sub_f32 v52, v52, v28
    v_sub_f32 v53, v53, v28
    v_sub_f32 v54, v54, v28
    v_sub_f32 v55, v55, v28
    v_sub_f32 v56, v56, v28
    v_sub_f32 v57, v57, v28
    v_sub_f32 v58, v58, v28
    v_sub_f32 v59, v59, v28
    v_sub_f32 v60, v60, v28
    v_sub_f32 v61, v61, v28
    v_sub_f32 v62, v62, v28
    v_sub_f32 v63, v63, v28
    v_exp_f32 v48, v48
    v_exp_f32 v49, v49
    v_exp_f32 v50, v50
    v_exp_f32 v51, v51
    v_exp_f32 v52, v52
    v_exp_f32 v53, v53
    v_exp_f32 v54, v54
    v_exp_f32 v55, v55
    v_exp_f32 v56, v56
    v_exp_f32 v57, v57
    v_exp_f32 v58, v58
    v_exp_f32 v59, v59
    v_exp_f32 v60, v60
    v_exp_f32 v61, v61
    v_exp_f32 v62, v62
    v_exp_f32 v63, v63
    v_cvt_pk_bf16_f32 v72, v48, v49
    v_cvt_pk_bf16_f32 v73, v50, v51
    v_cvt_pk_bf16_f32 v74, v52, v53
    v_cvt_pk_bf16_f32 v75, v54, v55
    v_cvt_pk_bf16_f32 v76, v56, v57
    v_cvt_pk_bf16_f32 v77, v58, v59
    v_cvt_pk_bf16_f32 v78, v60, v61
    v_cvt_pk_bf16_f32 v79, v62, v63
    v_mfma_f32_32x32x16_bf16 v[96:111], a[184:187], v[72:75], v[96:111]
    s_nop 0
    v_mfma_f32_32x32x16_bf16 v[96:111], a[188:191], v[76:79], v[96:111]
    v_mfma_f32_32x32x16_bf16 v[32:47], a[48:51], v[18:21], 0
    v_mfma_f32_32x32x8_bf16 v[32:47], a[88:89], v[22:23], v[32:47]
    s_nop 11
    v_sub_f32 v32, v32, v28
    v_sub_f32 v33, v33, v28
    v_sub_f32 v34, v34, v28
    v_sub_f32 v35, v35, v28
    v_sub_f32 v36, v36, v28
    v_sub_f32 v37, v37, v28
    v_sub_f32 v38, v38, v28
    v_sub_f32 v39, v39, v28
    v_sub_f32 v40, v40, v28
    v_sub_f32 v41, v41, v28
    v_sub_f32 v42, v42, v28
    v_sub_f32 v43, v43, v28
    v_sub_f32 v44, v44, v28
    v_sub_f32 v45, v45, v28
    v_sub_f32 v46, v46, v28
    v_sub_f32 v47, v47, v28
    v_exp_f32 v32, v32
    v_exp_f32 v33, v33
    v_exp_f32 v34, v34
    v_exp_f32 v35, v35
    v_exp_f32 v36, v36
    v_exp_f32 v37, v37
    v_exp_f32 v38, v38
    v_exp_f32 v39, v39
    v_exp_f32 v40, v40
    v_exp_f32 v41, v41
    v_exp_f32 v42, v42
    v_exp_f32 v43, v43
    v_exp_f32 v44, v44
    v_exp_f32 v45, v45
    v_exp_f32 v46, v46
    v_exp_f32 v47, v47
    v_cvt_pk_bf16_f32 v64, v32, v33
    v_cvt_pk_bf16_f32 v65, v34, v35
    v_cvt_pk_bf16_f32 v66, v36, v37
    v_cvt_pk_bf16_f32 v67, v38, v39
    v_cvt_pk_bf16_f32 v68, v40, v41
    v_cvt_pk_bf16_f32 v69, v42, v43
    v_cvt_pk_bf16_f32 v70, v44, v45
    v_cvt_pk_bf16_f32 v71, v46, v47
    v_mfma_f32_32x32x16_bf16 v[96:111], a[192:195], v[64:67], v[96:111]
    s_nop 0
    v_mfma_f32_32x32x16_bf16 v[96:111], a[196:199], v[68:71], v[96:111]
    v_mfma_f32_32x32x16_bf16 v[48:63], a[52:55], v[18:21], 0
    v_mfma_f32_32x32x8_bf16 v[48:63], a[90:91], v[22:23], v[48:63]
    s_nop 11
    v_sub_f32 v48, v48, v28
    v_sub_f32 v49, v49, v28
    v_sub_f32 v50, v50, v28
    v_sub_f32 v51, v51, v28
    v_sub_f32 v52, v52, v28
    v_sub_f32 v53, v53, v28
    v_sub_f32 v54, v54, v28
    v_sub_f32 v55, v55, v28
    v_sub_f32 v56, v56, v28
    v_sub_f32 v57, v57, v28
    v_sub_f32 v58, v58, v28
    v_sub_f32 v59, v59, v28
    v_sub_f32 v60, v60, v28
    v_sub_f32 v61, v61, v28
    v_sub_f32 v62, v62, v28
    v_sub_f32 v63, v63, v28
    v_exp_f32 v48, v48
    v_exp_f32 v49, v49
    v_exp_f32 v50, v50
    v_exp_f32 v51, v51
    v_exp_f32 v52, v52
    v_exp_f32 v53, v53
    v_exp_f32 v54, v54
    v_exp_f32 v55, v55
    v_exp_f32 v56, v56
    v_exp_f32 v57, v57
    v_exp_f32 v58, v58
    v_exp_f32 v59, v59
    v_exp_f32 v60, v60
    v_exp_f32 v61, v61
    v_exp_f32 v62, v62
    v_exp_f32 v63, v63
    v_cvt_pk_bf16_f32 v72, v48, v49
    v_cvt_pk_bf16_f32 v73, v50, v51
    v_cvt_pk_bf16_f32 v74, v52, v53
    v_cvt_pk_bf16_f32 v75, v54, v55
    v_cvt_pk_bf16_f32 v76, v56, v57
    v_cvt_pk_bf16_f32 v77, v58, v59
    v_cvt_pk_bf16_f32 v78, v60, v61
    v_cvt_pk_bf16_f32 v79, v62, v63
    v_mfma_f32_32x32x16_bf16 v[96:111], a[200:203], v[72:75], v[96:111]
    s_nop 0
    v_mfma_f32_32x32x16_bf16 v[96:111], a[204:207], v[76:79], v[96:111]
    v_mfma_f32_32x32x16_bf16 v[32:47], a[56:59], v[18:21], 0
    v_mfma_f32_32x32x8_bf16 v[32:47], a[92:93], v[22:23], v[32:47]
    s_nop 11
    v_sub_f32 v32, v32, v28
    v_sub_f32 v33, v33, v28
    v_sub_f32 v34, v34, v28
    v_sub_f32 v35, v35, v28
    v_sub_f32 v36, v36, v28
    v_sub_f32 v37, v37, v28
    v_sub_f32 v38, v38, v28
    v_sub_f32 v39, v39, v28
    v_sub_f32 v40, v40, v28
    v_sub_f32 v41, v41, v28
    v_sub_f32 v42, v42, v28
    v_sub_f32 v43, v43, v28
    v_sub_f32 v44, v44, v28
    v_sub_f32 v45, v45, v28
    v_sub_f32 v46, v46, v28
    v_sub_f32 v47, v47, v28
    v_exp_f32 v32, v32
    v_exp_f32 v33, v33
    v_exp_f32 v34, v34
    v_exp_f32 v35, v35
    v_exp_f32 v36, v36
    v_exp_f32 v37, v37
    v_exp_f32 v38, v38
    v_exp_f32 v39, v39
    v_exp_f32 v40, v40
    v_exp_f32 v41, v41
    v_exp_f32 v42, v42
    v_exp_f32 v43, v43
    v_exp_f32 v44, v44
    v_exp_f32 v45, v45
    v_exp_f32 v46, v46
    v_exp_f32 v47, v47
    v_cvt_pk_bf16_f32 v64, v32, v33
    v_cvt_pk_bf16_f32 v65, v34, v35
    v_cvt_pk_bf16_f32 v66, v36, v37
    v_cvt_pk_bf16_f32 v67, v38, v39
    v_cvt_pk_bf16_f32 v68, v40, v41
    v_cvt_pk_bf16_f32 v69, v42, v43
    v_cvt_pk_bf16_f32 v70, v44, v45
    v_cvt_pk_bf16_f32 v71, v46, v47
    v_mfma_f32_32x32x16_bf16 v[96:111], a[208:211], v[64:67], v[96:111]
    s_nop 0
    v_mfma_f32_32x32x16_bf16 v[96:111], a[212:215], v[68:71], v[96:111]
    v_mfma_f32_32x32x16_bf16 v[48:63], a[60:63], v[18:21], 0
    v_mfma_f32_32x32x8_bf16 v[48:63], a[94:95], v[22:23], v[48:63]
    s_nop 11
    v_sub_f32 v48, v48, v28
    v_sub_f32 v49, v49, v28
    v_sub_f32 v50, v50, v28
    v_sub_f32 v51, v51, v28
    v_sub_f32 v52, v52, v28
    v_sub_f32 v53, v53, v28
    v_sub_f32 v54, v54, v28
    v_sub_f32 v55, v55, v28
    v_sub_f32 v56, v56, v28
    v_sub_f32 v57, v57, v28
    v_sub_f32 v58, v58, v28
    v_sub_f32 v59, v59, v28
    v_sub_f32 v60, v60, v28
    v_sub_f32 v61, v61, v28
    v_sub_f32 v62, v62, v28
    v_sub_f32 v63, v63, v28
    v_exp_f32 v48, v48
    v_exp_f32 v49, v49
    v_exp_f32 v50, v50
    v_exp_f32 v51, v51
    v_exp_f32 v52, v52
    v_exp_f32 v53, v53
    v_exp_f32 v54, v54
    v_exp_f32 v55, v55
    v_exp_f32 v56, v56
    v_exp_f32 v57, v57
    v_exp_f32 v58, v58
    v_exp_f32 v59, v59
    v_exp_f32 v60, v60
    v_exp_f32 v61, v61
    v_exp_f32 v62, v62
    v_exp_f32 v63, v63
    v_cvt_pk_bf16_f32 v72, v48, v49
    v_cvt_pk_bf16_f32 v73, v50, v51
    v_cvt_pk_bf16_f32 v74, v52, v53
    v_cvt_pk_bf16_f32 v75, v54, v55
    v_cvt_pk_bf16_f32 v76, v56, v57
    v_cvt_pk_bf16_f32 v77, v58, v59
    v_cvt_pk_bf16_f32 v78, v60, v61
    v_cvt_pk_bf16_f32 v79, v62, v63
    v_mfma_f32_32x32x16_bf16 v[96:111], a[216:219], v[72:75], v[96:111]
    s_nop 0
    v_mfma_f32_32x32x16_bf16 v[96:111], a[220:223], v[76:79], v[96:111]
    s_nop 11
    ds_write_b128 v15, v[96:99] offset:0
    ds_write_b128 v15, v[100:103] offset:1024
    ds_write_b128 v15, v[104:107] offset:2048
    s_add_u32 s40, s40, 1
    s_and_b32 s40, s40, 7
    s_add_u32 s41, s41, 1
    s_cmp_lt_u32 s41, 8
    s_cbranch_scc1 K2_FB2
    s_waitcnt lgkmcnt(0)
    s_barrier
    buffer_load_dword v240, v118, s[28:31], 0 offen sc1
    s_waitcnt vmcnt(0)
    v_cmp_ne_u32_e64 vcc, 64, v240
    s_cbranch_vccnz K2_PWb
K2_PRb:
    s_waitcnt vmcnt(0)
    buffer_load_dwordx4 v[132:135], v5, s[28:31], s61 offen offset:0 sc1
    buffer_load_dwordx4 v[136:139], v5, s[28:31], s61 offen offset:1024 sc1
    buffer_load_dwordx4 v[140:143], v5, s[28:31], s61 offen offset:2048 sc1
    buffer_load_dwordx4 v[144:147], v5, s[28:31], s61 offen offset:3072 sc1
    s_add_u32 s61, s61, 4096
    buffer_load_dwordx4 v[148:151], v5, s[28:31], s61 offen offset:0 sc1
    buffer_load_dwordx4 v[152:155], v5, s[28:31], s61 offen offset:1024 sc1
    buffer_load_dwordx4 v[156:159], v5, s[28:31], s61 offen offset:2048 sc1
    buffer_load_dwordx4 v[160:163], v5, s[28:31], s61 offen offset:3072 sc1
    s_add_u32 s61, s61, 4096
    buffer_load_dwordx4 v[164:167], v5, s[28:31], s61 offen offset:0 sc1
    buffer_load_dwordx4 v[168:171], v5, s[28:31], s61 offen offset:1024 sc1
    buffer_load_dwordx4 v[172:175], v5, s[28:31], s61 offen offset:2048 sc1
    buffer_load_dwordx4 v[176:179], v5, s[28:31], s61 offen offset:3072 sc1
    s_add_u32 s61, s61, 4096
    buffer_load_dwordx4 v[180:183], v5, s[28:31], s61 offen offset:0 sc1
    buffer_load_dwordx4 v[184:187], v5, s[28:31], s61 offen offset:1024 sc1
    buffer_load_dwordx4 v[188:191], v5, s[28:31], s61 offen offset:2048 sc1
    buffer_load_dwordx4 v[192:195], v5, s[28:31], s61 offen offset:3072 sc1
    s_add_u32 s61, s61, 4096
    buffer_load_dwordx4 v[196:199], v5, s[28:31], s61 offen offset:0 sc1
    buffer_load_dwordx4 v[200:203], v5, s[28:31], s61 offen offset:1024 sc1
    buffer_load_dwordx4 v[204:207], v5, s[28:31], s61 offen offset:2048 sc1
    buffer_load_dwordx4 v[208:211], v5, s[28:31], s61 offen offset:3072 sc1
    s_add_u32 s61, s61, 4096
    buffer_load_dwordx4 v[212:215], v5, s[28:31], s61 offen offset:0 sc1
    buffer_load_dwordx4 v[216:219], v5, s[28:31], s61 offen offset:1024 sc1
    buffer_load_dwordx4 v[220:223], v5, s[28:31], s61 offen offset:2048 sc1
    buffer_load_dwordx4 v[224:227], v5, s[28:31], s61 offen offset:3072 sc1
    s_add_u32 s61, s61, 4096
    buffer_load_dwordx4 v[228:231], v5, s[28:31], s61 offen offset:0 sc1
    buffer_load_dwordx4 v[232:235], v116, s[28:31], s38 offen offset:0 sc1
    buffer_load_dwordx4 v[236:239], v116, s[28:31], s38 offen offset:16 sc1
    buffer_load_dwordx4 v5, s[28:31], s62 offen offset:0 sc1 lds
    buffer_load_dwordx4 v5, s[28:31], s62 offen offset:1024 sc1 lds
    buffer_load_dwordx4 v5, s[28:31], s62 offen offset:2048 sc1 lds
    buffer_load_dwordx4 v5, s[28:31], s62 offen offset:3072 sc1 lds
    s_add_u32 s62, s62, 4096
    s_addk_i32 m0, 4096
    s_nop 0
    buffer_load_dwordx4 v5, s[28:31], s62 offen offset:0 sc1 lds
    buffer_load_dwordx4 v5, s[28:31], s62 offen offset:1024 sc1 lds
    buffer_load_dwordx4 v5, s[28:31], s62 offen offset:2048 sc1 lds
    buffer_load_dwordx4 v5, s[28:31], s62 offen offset:3072 sc1 lds
    s_add_u32 s62, s62, 4096
    s_addk_i32 m0, 4096
    s_nop 0
    buffer_load_dwordx4 v5, s[28:31], s62 offen offset:0 sc1 lds
    buffer_load_dwordx4 v5, s[28:31], s62 offen offset:1024 sc1 lds
    buffer_load_dwordx4 v5, s[28:31], s62 offen offset:2048 sc1 lds
    buffer_load_dwordx4 v5, s[28:31], s62 offen offset:3072 sc1 lds
    s_add_u32 s62, s62, 4096
    s_addk_i32 m0, 4096
    s_nop 0
    buffer_load_dwordx4 v5, s[28:31], s62 offen offset:0 sc1 lds
    buffer_load_dwordx4 v5, s[28:31], s62 offen offset:1024 sc1 lds
    buffer_load_dwordx4 v5, s[28:31], s62 offen offset:2048 sc1 lds
    buffer_load_dwordx4 v5, s[28:31], s62 offen offset:3072 sc1 lds
    s_add_u32 s62, s62, 4096
    s_addk_i32 m0, 4096
    s_nop 0
    buffer_load_dwordx4 v5, s[28:31], s62 offen offset:0 sc1 lds
    buffer_load_dwordx4 v5, s[28:31], s62 offen offset:1024 sc1 lds
    buffer_load_dwordx4 v5, s[28:31], s62 offen offset:2048 sc1 lds
    buffer_load_dwordx4 v5, s[28:31], s62 offen offset:3072 sc1 lds
    s_add_u32 s62, s62, 4096
    s_addk_i32 m0, 4096
    s_nop 0
    buffer_load_dwordx4 v5, s[28:31], s62 offen offset:0 sc1 lds
    buffer_load_dwordx4 v5, s[28:31], s62 offen offset:1024 sc1 lds
    buffer_load_dwordx4 v5, s[28:31], s62 offen offset:2048 sc1 lds
    buffer_load_dwordx4 v5, s[28:31], s62 offen offset:3072 sc1 lds
    s_add_u32 s62, s62, 4096
    s_addk_i32 m0, 4096
    s_nop 0
    buffer_load_dwordx4 v5, s[28:31], s62 offen offset:0 sc1 lds
    buffer_load_dwordx4 a[224:227], v5, s[28:31], s37 offen offset:0 sc1
    buffer_load_dwordx4 a[228:231], v5, s[28:31], s37 offen offset:1024 sc1
    buffer_load_dwordx4 a[232:235], v5, s[28:31], s37 offen offset:2048 sc1
    buffer_load_dwordx4 a[236:239], v5, s[28:31], s37 offen offset:3072 sc1
    s_add_u32 s37, s37, 4096
    buffer_load_dwordx4 a[240:243], v5, s[28:31], s37 offen offset:0 sc1
    buffer_load_dwordx4 a[244:247], v5, s[28:31], s37 offen offset:1024 sc1
    buffer_load_dwordx4 a[248:251], v5, s[28:31], s37 offen offset:2048 sc1
    buffer_load_dwordx4 a[252:255], v5, s[28:31], s37 offen offset:3072 sc1
    s_add_u32 s37, s37, 4096
    buffer_load_dwordx4 v[24:27], v5, s[28:31], s37 offen offset:0 sc1
    buffer_load_dwordx4 v[28:31], v5, s[28:31], s37 offen offset:1024 sc1
    s_waitcnt vmcnt(0)
    ds_read_b128 v[96:99], v248 offset:0
    ds_read_b128 v[100:103], v248 offset:1024
    ds_read_b128 v[104:107], v248 offset:2048
    s_waitcnt lgkmcnt(0)
    v_mov_b32 v112, v104
    v_mov_b32 v113, v104
    s_nop 1
    v_permlane32_swap_b32 v112, v113
    v_rcp_f32 v112, v113
    s_nop 0
    v_mul_f32 v96, v96, v112
    v_mul_f32 v97, v97, v112
    v_mul_f32 v98, v98, v112
    v_mul_f32 v99, v99, v112
    v_mul_f32 v100, v100, v112
    v_mul_f32 v101, v101, v112
    v_mul_f32 v102, v102, v112
    v_mul_f32 v103, v103, v112
    v_mul_f32 v104, v104, v112
    v_mul_f32 v105, v105, v112
    v_mul_f32 v106, v106, v112
    v_mul_f32 v107, v107, v112
    v_cvt_pk_bf16_f32 v114, v96, v97
    v_cvt_pk_bf16_f32 v115, v98, v99
    v_cvt_pk_bf16_f32 v116, v100, v101
    v_cvt_pk_bf16_f32 v117, v102, v103
    v_cvt_pk_bf16_f32 v118, v104, v105
    v_cvt_pk_bf16_f32 v119, v106, v107
    buffer_store_dwordx4 v[114:117], v13, s[28:31], s42 offen offset:0
    buffer_store_dwordx2 v[118:119], v14, s[28:31], s42 offen offset:0
    s_waitcnt vmcnt(0)
    ds_read_b128 v[96:99], v248 offset:4096
    ds_read_b128 v[100:103], v248 offset:5120
    ds_read_b128 v[104:107], v248 offset:6144
    s_waitcnt lgkmcnt(0)
    v_mov_b32 v112, v104
    v_mov_b32 v113, v104
    s_nop 1
    v_permlane32_swap_b32 v112, v113
    v_rcp_f32 v112, v113
    s_nop 0
    v_mul_f32 v96, v96, v112
    v_mul_f32 v97, v97, v112
    v_mul_f32 v98, v98, v112
    v_mul_f32 v99, v99, v112
    v_mul_f32 v100, v100, v112
    v_mul_f32 v101, v101, v112
    v_mul_f32 v102, v102, v112
    v_mul_f32 v103, v103, v112
    v_mul_f32 v104, v104, v112
    v_mul_f32 v105, v105, v112
    v_mul_f32 v106, v106, v112
    v_mul_f32 v107, v107, v112
    v_cvt_pk_bf16_f32 v114, v96, v97
    v_cvt_pk_bf16_f32 v115, v98, v99
    v_cvt_pk_bf16_f32 v116, v100, v101
    v_cvt_pk_bf16_f32 v117, v102, v103
    v_cvt_pk_bf16_f32 v118, v104, v105
    v_cvt_pk_bf16_f32 v119, v106, v107
    buffer_store_dwordx4 v[114:117], v13, s[28:31], s42 offen offset:16
    buffer_store_dwordx2 v[118:119], v14, s[28:31], s42 offen offset:16
    s_waitcnt vmcnt(0)
    s_cmp_eq_u32 s32, 3
    s_cselect_b32 s60, 0x7f000000, 0
    v_or_b32 v6, s60, v5
    s_nop 1
    s_branch K2_FINAL
.section .rodata,"a"
.p2align 6
.amdhsa_kernel sequential_preLN__grouped_kv_mqa__mixer_channel_mlp__prompt_kernel
  .amdhsa_next_free_vgpr 512
  .amdhsa_next_free_sgpr 82
  .amdhsa_accum_offset 256
  .amdhsa_group_segment_fixed_size 0
  .amdhsa_kernarg_size 104
  .amdhsa_user_sgpr_count 2
  .amdhsa_user_sgpr_kernarg_segment_ptr 1
  .amdhsa_system_sgpr_workgroup_id_x 1
.end_amdhsa_kernel
```
